```python
import torch

def _softmax(x, axis=-1):
    return torch.softmax(x, dim=axis)
def _gelu(x):
    return torch.nn.functional.gelu(x, approximate="tanh")
def _silu(x):
    return torch.nn.functional.silu(x)
def _sigmoid(x):
    return torch.sigmoid(x)
def _layernorm(x, axis=-1, eps=1e-5):
    m = x.mean(dim=axis, keepdim=True)
    v = x.var(dim=axis, keepdim=True, unbiased=False)
    return (x - m) / torch.sqrt(v + eps)
def _scatter_add(tgt, idx, src, axis=0):
    return tgt.clone().index_add_(axis, idx, src)
def _segment_sum(src, seg, n):
    out = torch.zeros((n,) + src.shape[1:], dtype=src.dtype)
    return out.index_add_(0, seg, src)
def _pad(x, pw):
    flat = tuple(v for pair in reversed(pw) for v in pair)
    return torch.nn.functional.pad(x, flat)

kernel_name = 'interleave_layers__spectral_fnet__swiglu_ffn__prompt'

def setup_inputs():

    _w = (lambda a: (lambda t: t.to(torch.bfloat16) if t.is_floating_point() else t)(torch.as_tensor(a)))
    def _A_setup():
        B, S, D = 1, 2048, 576
        ns = torch.arange(S)[:, None] * torch.arange(S)[None, :]
        nd = torch.arange(D)[:, None] * torch.arange(D)[None, :]
        Ws_re = torch.cos(-2.0 * torch.pi * ns / S).to(float)
        Ws_im = torch.sin(-2.0 * torch.pi * ns / S).to(float)
        Wd_re = torch.cos(-2.0 * torch.pi * nd / D).to(float)
        Wd_im = torch.sin(-2.0 * torch.pi * nd / D).to(float)
        return {
            "x": _w((lambda *s: torch.randn(*s, dtype=torch.bfloat16) * 0.05)(B, S, D)),
            "dft_seq_re": _w(Ws_re),
            "dft_seq_im": _w(Ws_im),
            "dft_hid_re": _w(Wd_re),
            "dft_hid_im": _w(Wd_im),
        }
    _A_in = _A_setup()

    def _B_setup():
        B, S, D, F = 1, 2048, 576, 4608
        return {
            "x": _w((lambda *s: torch.randn(*s, dtype=torch.bfloat16) * 0.05)(B, S, D)),
            "w_gate": _w((lambda *s: torch.randn(*s, dtype=torch.bfloat16) * 0.2)(D, F)),
            "w_up": _w((lambda *s: torch.randn(*s, dtype=torch.bfloat16) * 0.2)(D, F)),
            "w_down": _w((lambda *s: torch.randn(*s, dtype=torch.bfloat16) * 0.2)(F, D)),
        }
    _B_in = _B_setup()

    return {
        "A_x": _A_in["x"],
        "A_dft_seq_re": _A_in["dft_seq_re"],
        "A_dft_seq_im": _A_in["dft_seq_im"],
        "A_dft_hid_re": _A_in["dft_hid_re"],
        "A_dft_hid_im": _A_in["dft_hid_im"],
        "B_x": _B_in["x"],
        "B_w_gate": _B_in["w_gate"],
        "B_w_up": _B_in["w_up"],
        "B_w_down": _B_in["w_down"],
    }

def reference(A_x, A_dft_seq_re, A_dft_seq_im, A_dft_hid_re, A_dft_hid_im, B_x, B_w_gate, B_w_up, B_w_down):
    def _A_ref(x, dft_seq_re, dft_seq_im, dft_hid_re, dft_hid_im):
        a = torch.einsum("bsd,ed->bse", x, dft_hid_re)
        b = torch.einsum("bsd,ed->bse", x, dft_hid_im)
        y = torch.einsum("ts,bse->bte", dft_seq_re, a) - torch.einsum("ts,bse->bte", dft_seq_im, b)
        return y

    def _B_ref(x, w_gate, w_up, w_down):
        g = _silu(x @ w_gate)
        u = x @ w_up
        return (g * u) @ w_down

    x = A_x
    x = x + _A_ref(_layernorm(x, axis=-1), A_dft_seq_re, A_dft_seq_im, A_dft_hid_re, A_dft_hid_im)
    x = x + _B_ref(_layernorm(x, axis=-1), B_w_gate, B_w_up, B_w_down)
    x = x + _A_ref(_layernorm(x, axis=-1), A_dft_seq_re, A_dft_seq_im, A_dft_hid_re, A_dft_hid_im)
    x = x + _B_ref(_layernorm(x, axis=-1), B_w_gate, B_w_up, B_w_down)
    return x
```

```asm
; @launch grid=(256,1,1) block=(256,1,1) lds=163840
.amdgcn_target "amdgcn-amd-amdhsa--gfx950"
.text
.globl interleave_layers__spectral_fnet__swiglu_ffn__prompt_kernel
.p2align 8
.type interleave_layers__spectral_fnet__swiglu_ffn__prompt_kernel,@function
interleave_layers__spectral_fnet__swiglu_ffn__prompt_kernel:
    s_cmp_ge_u32 s2, 256
    s_cbranch_scc1 exit_1
    s_load_dwordx2 s[40:41], s[0:1], 0
    s_load_dwordx4 s[44:47], s[0:1], 24
    s_load_dwordx8 s[48:55], s[0:1], 48
    s_load_dwordx4 s[60:63], s[0:1], 80
    v_lshrrev_b32 v1, 6, v0
    v_and_b32 v0, 63, v0
    v_readfirstlane_b32 s23, v1
    s_getpc_b64 s[30:31]
pc_6:
    v_lshlrev_b32 v4, 4, v0
    v_lshrrev_b32 v2, 4, v0
    v_and_b32 v3, 15, v0
    s_lshr_b32 s32, s2, 3
    s_lshl_b32 s32, s32, 2
    s_add_u32 s32, s32, s23
    s_lshl_b32 s32, s32, 9
    v_lshl_add_u32 v11, v2, 7, s32
    v_add_u32 v11, pc_6-pc_6, v11
    v_min_u32 v11, code_end-pc_6-4, v11
    global_load_dword v11, v11, s[30:31]
    s_bfe_u32 s22, s2, 0x20003
    s_bfe_u32 s21, s2, 0x10005
    s_bfe_u32 s32, s2, 0x10002
    s_lshl_b32 s32, s32, 1
    s_add_u32 s21, s21, s32
    s_lshr_b32 s33, s2, 6
    s_lshl_b32 s20, s33, 2
    s_and_b32 s32, s2, 3
    s_add_u32 s20, s20, s32
    s_lshr_b32 s32, s23, 1
    s_lshl_b32 s24, s32, 5
    s_add_u32 s24, s24, s20
    s_and_b32 s25, s23, 1
    s_lshl_b32 s25, s25, 4
    s_cmp_lg_u32 s20, 0
    s_cbranch_scc1 rows_7
    s_lshl_b32 s24, s23, 5
    s_cmp_lg_u32 s32, 0
    s_cselect_b32 s24, 16, s24
    s_cmp_eq_u32 s23, 3
    s_cselect_b32 s25, 16, 0
rows_7:
    s_sub_u32 s34, s21, s33
    s_sub_u32 s34, s34, 1
    s_and_b32 s34, s34, 3
    s_add_u32 s34, s34, 4
    s_cmp_eq_u32 s22, 3
    s_cselect_b32 s34, s21, s34
    s_cmp_eq_u32 s34, 7
    s_cselect_b32 s96, 8, 9
    s_lshl_b32 s32, s21, 1
    s_add_u32 s32, s32, s22
    s_cmp_lt_u32 s22, 2
    s_cselect_b32 s96, s32, s96
    s_cmp_lt_u32 s96, 9
    s_cselect_b32 s100, 2, 0
    s_cselect_b32 s32, 24, 40
    s_mul_i32 s32, s32, s23
    s_add_u32 s100, s100, s32
    s_lshl_b32 s100, s100, 10
    v_and_b32 v49, 7, v0
    v_xor_b32 v49, v49, v2
    v_lshlrev_b32 v49, 4, v49
    v_lshrrev_b32 v48, 3, v0
    v_add_u32 v164, s25, v48
    v_lshlrev_b32 v164, 6, v164
    v_add_u32 v164, s24, v164
    v_cmp_eq_u32 s[56:57], 0, v164
    v_sub_u32 v166, 0x800, v164
    v_mov_b32 v50, 0x400
    v_cndmask_b32 v166, v166, v50, s[56:57]
    v_mul_u32_u24 v164, 1152, v164
    v_mul_u32_u24 v166, 1152, v166
    v_add_u32 v164, v164, v49
    v_add_u32 v166, v166, v49
    v_lshrrev_b32 v48, 3, v0
    v_add_u32 v48, 8, v48
    v_xor_b32 v49, 64, v49
    v_add_u32 v165, s25, v48
    v_lshlrev_b32 v165, 6, v165
    v_add_u32 v165, s24, v165
    v_cmp_eq_u32 s[56:57], 0, v165
    v_sub_u32 v167, 0x800, v165
    v_mov_b32 v50, 0x400
    v_cndmask_b32 v167, v167, v50, s[56:57]
    v_mul_u32_u24 v165, 1152, v165
    v_mul_u32_u24 v167, 1152, v167
    v_add_u32 v165, v165, v49
    v_add_u32 v167, v167, v49
    s_mov_b32 s3, 0
    s_mov_b32 s97, 17825792
    s_mov_b32 s98, 16908288
    s_waitcnt lgkmcnt(0)
    s_mov_b32 s4, s40
    s_and_b32 s5, s41, 0xffff
    s_mov_b32 s6, 2359296
    s_mov_b32 s7, 0x00020000
    s_mov_b32 s12, s62
    s_and_b32 s13, s63, 0xffff
    s_mov_b32 s14, 268435456
    s_mov_b32 s15, 0x00020000
    s_cmp_ge_u32 s23, 2
    s_cselect_b32 s44, s46, s44
    s_cselect_b32 s45, s47, s45
    s_mov_b32 s8, s44
    s_and_b32 s9, s45, 0xffff
    s_mov_b32 s10, 663552
    s_mov_b32 s11, 0x00020000
    s_mov_b32 s16, s54
    s_and_b32 s17, s55, 0xffff
    s_mov_b32 s18, 2359296
    s_mov_b32 s19, 0x00020000
    s_mov_b32 s92, s60
    s_and_b32 s93, s61, 0xffff
    s_mov_b32 s94, 256
    s_mov_b32 s95, 0x00020000
    s_mov_b32 s88, s52
    s_and_b32 s89, s53, 0xffff
    s_mov_b32 s90, 5308416
    s_mov_b32 s91, 0x00020000
    s_lshl_b32 s46, s20, 2
    s_add_u32 s46, s46, s23
    s_mul_i32 s46, s46, 36864
    s_add_u32 s46, s46, 23068672
    s_cmp_lt_u32 s96, 9
    s_cbranch_scc1 task_2
    s_mul_i32 s52, s20, 7
    s_add_u32 s52, s52, s34
    s_lshl_b32 s52, s52, 2
    s_add_u32 s52, s52, s23
    s_mov_b32 s39, s52
    s_cmp_ge_u32 s52, 432
    s_cselect_b32 s38, 432, 0
    s_sub_u32 s52, s52, s38
    s_lshl_b32 s38, s38, 21
    v_add_u32 v24, s38, v4
    s_cmp_lg_u32 s39, 447
    s_cbranch_scc1 noinit_8
    v_mov_b32 v54, 0
    v_lshlrev_b32 v53, 7, v0
    s_mov_b32 s41, 16908288
    buffer_store_dword v54, v53, s[12:15], s41 offen sc1
    s_mov_b32 s41, 16912384
    buffer_store_dword v54, v53, s[12:15], s41 offen sc1
    s_mov_b32 s41, 16920576
    buffer_store_dword v54, v53, s[12:15], s41 offen sc1
noinit_8:
    v_add_u32 v52, s25, v3
    v_lshlrev_b32 v52, 6, v52
    v_add_u32 v52, s24, v52
    v_cmp_eq_u32 s[56:57], 0, v52
    v_sub_u32 v53, 0x800, v52
    v_mov_b32 v54, 0x400
    v_cndmask_b32 v53, v53, v54, s[56:57]
    v_mul_u32_u24 v52, 1152, v52
    v_mul_u32_u24 v53, 1152, v53
    s_bitcmp1_b32 s22, 0
    s_cselect_b32 s41, 1, 3
    s_cselect_b32 s42, 2, 3
    s_bitcmp1_b32 s21, 0
    s_cselect_b32 s41, s42, s41
    s_lshl_b32 s41, s41, 7
    s_lshl_b32 s42, s41, 1
    s_sub_u32 s42, 1024, s42
    v_and_b32 v54, 1, v2
    v_cmp_eq_u32 vcc, 0, v54
    v_lshrrev_b32 v54, 1, v2
    s_nop 0
    v_cndmask_b32 v55, v53, v52, vcc
    v_mad_u32_u24 v54, v54, s42, v55
    buffer_load_dword v182, v54, s[4:7], s41 offen
    s_lshr_b32 s52, s52, 2
    s_mul_hi_u32 s53, s52, 0x0e38e38f
    s_mul_i32 s54, s53, 18
    s_sub_u32 s54, s52, s54
    s_mul_i32 s55, s23, 6
    s_add_u32 s53, s53, s55
    s_bitcmp1_b32 s53, 0
    s_cselect_b32 s48, s50, s48
    s_cselect_b32 s49, s51, s49
    s_cselect_b32 s36, 18, 0
    s_mov_b32 s88, s48
    s_and_b32 s89, s49, 0xffff
    s_mov_b32 s90, 5308416
    s_mov_b32 s91, 0x00020000
    s_and_b32 s53, s53, 30
    s_add_u32 s36, s36, s54
    s_lshl_b32 s36, s36, 10
    v_bfe_u32 v7, v0, 2, 1
    v_add_u32 v7, s53, v7
    v_mul_u32_u24 v8, 11, v7
    v_lshrrev_b32 v8, 5, v8
    v_lshrrev_b32 v9, 3, v0
    v_sub_u32 v9, v9, v8
    v_mad_i32_i24 v7, v9, 3, v7
    v_cmp_eq_u32 vcc, 8, v7
    v_lshlrev_b32 v7, 2, v7
    s_mov_b32 s55, 0x73261540
    v_bfe_u32 v7, s55, v7, 4
    v_cndmask_b32 v7, v7, 8, vcc
    v_mul_u32_u24 v25, 9, v8
    v_add_lshl_u32 v25, v25, v7, 7
    s_lshl_b32 s54, s54, 5
    s_mov_b32 s33, s100
    v_readlane_b32 s26, v25, 0
    v_readlane_b32 s27, v25, 4
    v_readlane_b32 s28, v25, 8
    v_readlane_b32 s29, v25, 12
    v_readlane_b32 s30, v25, 16
    v_readlane_b32 s31, v25, 20
    v_and_b32 v9, 3, v0
    v_lshl_add_u32 v7, v7, 2, v9
    v_cmp_lt_u32 vcc, 17, v7
    s_mov_b32 s55, 1990656
    v_mul_u32_u24 v7, 36864, v7
    v_mad_u32_u24 v7, v8, s55, v7
    v_mov_b32 v9, 331776
    v_cndmask_b32 v9, 0, v9, vcc
    v_add3_u32 v25, v7, v9, s36
    v_lshrrev_b32 v7, 3, v0
    v_add_u32 v7, s54, v7
    v_bfe_u32 v8, v0, 4, 1
    v_lshlrev_b32 v8, 1, v8
    v_and_b32 v9, 7, v0
    v_xor_b32 v8, v8, v9
    v_lshlrev_b32 v8, 4, v8
    v_xor_b32 v9, 64, v8
    s_movk_i32 s55, 9216
    v_cmp_lt_u32 vcc, 0x120, v7
    v_sub_u32 v10, 864, v7
    s_nop 0
    v_cndmask_b32 v10, v7, v10, vcc
    v_mad_u32_u24 v16, v10, s55, v8
    v_add_u32 v7, 8, v7
    v_cmp_lt_u32 vcc, 0x120, v7
    v_sub_u32 v10, 864, v7
    s_nop 0
    v_cndmask_b32 v10, v7, v10, vcc
    v_mad_u32_u24 v17, v10, s55, v9
    v_add_u32 v7, 8, v7
    v_cmp_lt_u32 vcc, 0x120, v7
    v_sub_u32 v10, 864, v7
    s_nop 0
    v_cndmask_b32 v10, v7, v10, vcc
    v_mad_u32_u24 v18, v10, s55, v8
    v_add_u32 v7, 8, v7
    v_cmp_lt_u32 vcc, 0x120, v7
    v_sub_u32 v10, 864, v7
    s_nop 0
    v_cndmask_b32 v10, v7, v10, vcc
    v_mad_u32_u24 v19, v10, s55, v9
    s_add_u32 m0, s33, 0
    s_nop 0
    buffer_load_dwordx4 v16, s[88:91], s26 offen nt lds
    s_add_u32 m0, s33, 1024
    s_nop 0
    buffer_load_dwordx4 v17, s[88:91], s26 offen nt lds
    s_add_u32 m0, s33, 2048
    s_nop 0
    buffer_load_dwordx4 v18, s[88:91], s26 offen nt lds
    s_add_u32 m0, s33, 3072
    s_nop 0
    buffer_load_dwordx4 v19, s[88:91], s26 offen nt lds
    s_add_u32 m0, s33, 4096
    s_nop 0
    buffer_load_dwordx4 v16, s[88:91], s27 offen nt lds
    s_add_u32 m0, s33, 5120
    s_nop 0
    buffer_load_dwordx4 v17, s[88:91], s27 offen nt lds
    s_add_u32 m0, s33, 6144
    s_nop 0
    buffer_load_dwordx4 v18, s[88:91], s27 offen nt lds
    s_add_u32 m0, s33, 7168
    s_nop 0
    buffer_load_dwordx4 v19, s[88:91], s27 offen nt lds
    s_add_u32 m0, s33, 8192
    s_nop 0
    buffer_load_dwordx4 v16, s[88:91], s28 offen nt lds
    s_add_u32 m0, s33, 9216
    s_nop 0
    buffer_load_dwordx4 v17, s[88:91], s28 offen nt lds
    s_add_u32 m0, s33, 10240
    s_nop 0
    buffer_load_dwordx4 v18, s[88:91], s28 offen nt lds
    s_add_u32 m0, s33, 11264
    s_nop 0
    buffer_load_dwordx4 v19, s[88:91], s28 offen nt lds
    s_add_u32 m0, s33, 12288
    s_nop 0
    buffer_load_dwordx4 v16, s[88:91], s29 offen nt lds
    s_add_u32 m0, s33, 13312
    s_nop 0
    buffer_load_dwordx4 v17, s[88:91], s29 offen nt lds
    s_add_u32 m0, s33, 14336
    s_nop 0
    buffer_load_dwordx4 v18, s[88:91], s29 offen nt lds
    s_add_u32 m0, s33, 15360
    s_nop 0
    buffer_load_dwordx4 v19, s[88:91], s29 offen nt lds
    s_add_u32 m0, s33, 16384
    s_nop 0
    buffer_load_dwordx4 v16, s[88:91], s30 offen nt lds
    s_add_u32 m0, s33, 17408
    s_nop 0
    buffer_load_dwordx4 v17, s[88:91], s30 offen nt lds
    s_add_u32 m0, s33, 18432
    s_nop 0
    buffer_load_dwordx4 v18, s[88:91], s30 offen nt lds
    s_add_u32 m0, s33, 19456
    s_nop 0
    buffer_load_dwordx4 v19, s[88:91], s30 offen nt lds
    s_add_u32 m0, s33, 20480
    s_nop 0
    buffer_load_dwordx4 v16, s[88:91], s31 offen nt lds
    s_add_u32 m0, s33, 21504
    s_nop 0
    buffer_load_dwordx4 v17, s[88:91], s31 offen nt lds
    s_add_u32 m0, s33, 22528
    s_nop 0
    buffer_load_dwordx4 v18, s[88:91], s31 offen nt lds
    s_add_u32 m0, s33, 23552
    s_nop 0
    buffer_load_dwordx4 v19, s[88:91], s31 offen nt lds
    v_bfe_u32 v7, v0, 2, 2
    v_and_b32 v8, 3, v0
    v_lshl_add_u32 v10, v2, 3, v7
    v_lshrrev_b32 v7, 1, v7
    v_and_b32 v9, 1, v2
    v_lshl_or_b32 v7, v9, 1, v7
    v_lshlrev_b32 v7, 5, v7
    v_lshl_add_u32 v7, v8, 3, v7
    v_lshl_add_u32 v7, v10, 7, v7
    v_xor_b32 v20, 0, v7
    v_add_u32 v20, s33, v20
    v_xor_b32 v21, 32, v7
    v_add_u32 v21, s33, v21
    v_xor_b32 v22, 64, v7
    v_add_u32 v22, s33, v22
    v_xor_b32 v23, 96, v7
    v_add_u32 v23, s33, v23
    v_lshrrev_b32 v48, 1, v3
    v_lshl_add_u32 v49, v3, 7, s100
    v_xor_b32 v170, v2, v48
    v_lshl_add_u32 v170, v170, 4, v49
    v_xor_b32 v171, 64, v170
    v_xor_b32 v172, 48, v170
    v_xor_b32 v173, 48, v171
    v_sub_u32 v50, 4, v2
    v_xor_b32 v174, v50, v48
    v_lshl_add_u32 v174, v174, 4, v49
    v_sub_u32 v50, 8, v2
    v_and_b32 v50, 7, v50
    v_xor_b32 v175, v50, v48
    v_lshl_add_u32 v175, v175, 4, v49
    v_cmp_eq_u32 s[58:59], 0, v2
    s_mov_b32 s45, 0xffff
    s_lshl_b32 s41, s2, 2
    s_add_u32 s41, s41, s23
    s_lshl_b32 s41, s41, 7
    s_add_u32 s41, s41, 16777216
    v_mov_b32 v54, 0
    v_and_b32 v53, 31, v0
    v_lshlrev_b32 v53, 2, v53
    buffer_store_dword v54, v53, s[12:15], s41 offen sc1
    s_waitcnt vmcnt(21)
    ds_read_b64_tr_b16 v[64:65], v20 offset:0
    ds_read_b64_tr_b16 v[66:67], v20 offset:512
    ds_read_b64_tr_b16 v[68:69], v21 offset:0
    ds_read_b64_tr_b16 v[70:71], v21 offset:512
    ds_read_b64_tr_b16 v[72:73], v22 offset:0
    ds_read_b64_tr_b16 v[74:75], v22 offset:512
    ds_read_b64_tr_b16 v[76:77], v23 offset:0
    ds_read_b64_tr_b16 v[78:79], v23 offset:512
    s_waitcnt vmcnt(17)
    ds_read_b64_tr_b16 v[80:81], v20 offset:4096
    ds_read_b64_tr_b16 v[82:83], v20 offset:4608
    ds_read_b64_tr_b16 v[84:85], v21 offset:4096
    ds_read_b64_tr_b16 v[86:87], v21 offset:4608
    ds_read_b64_tr_b16 v[88:89], v22 offset:4096
    ds_read_b64_tr_b16 v[90:91], v22 offset:4608
    ds_read_b64_tr_b16 v[92:93], v23 offset:4096
    ds_read_b64_tr_b16 v[94:95], v23 offset:4608
    s_waitcnt vmcnt(13)
    ds_read_b64_tr_b16 v[96:97], v20 offset:8192
    ds_read_b64_tr_b16 v[98:99], v20 offset:8704
    ds_read_b64_tr_b16 v[100:101], v21 offset:8192
    ds_read_b64_tr_b16 v[102:103], v21 offset:8704
    ds_read_b64_tr_b16 v[104:105], v22 offset:8192
    ds_read_b64_tr_b16 v[106:107], v22 offset:8704
    ds_read_b64_tr_b16 v[108:109], v23 offset:8192
    ds_read_b64_tr_b16 v[110:111], v23 offset:8704
    s_waitcnt vmcnt(9)
    ds_read_b64_tr_b16 v[112:113], v20 offset:12288
    ds_read_b64_tr_b16 v[114:115], v20 offset:12800
    ds_read_b64_tr_b16 v[116:117], v21 offset:12288
    ds_read_b64_tr_b16 v[118:119], v21 offset:12800
    ds_read_b64_tr_b16 v[120:121], v22 offset:12288
    ds_read_b64_tr_b16 v[122:123], v22 offset:12800
    ds_read_b64_tr_b16 v[124:125], v23 offset:12288
    ds_read_b64_tr_b16 v[126:127], v23 offset:12800
    s_waitcnt vmcnt(5)
    ds_read_b64_tr_b16 a[208:209], v20 offset:16384
    ds_read_b64_tr_b16 a[210:211], v20 offset:16896
    ds_read_b64_tr_b16 a[212:213], v21 offset:16384
    ds_read_b64_tr_b16 a[214:215], v21 offset:16896
    ds_read_b64_tr_b16 a[216:217], v22 offset:16384
    ds_read_b64_tr_b16 a[218:219], v22 offset:16896
    ds_read_b64_tr_b16 a[220:221], v23 offset:16384
    ds_read_b64_tr_b16 a[222:223], v23 offset:16896
    s_waitcnt vmcnt(1)
    ds_read_b64_tr_b16 a[224:225], v20 offset:20480
    ds_read_b64_tr_b16 a[226:227], v20 offset:20992
    ds_read_b64_tr_b16 a[228:229], v21 offset:20480
    ds_read_b64_tr_b16 a[230:231], v21 offset:20992
    ds_read_b64_tr_b16 a[232:233], v22 offset:20480
    ds_read_b64_tr_b16 a[234:235], v22 offset:20992
    ds_read_b64_tr_b16 a[236:237], v23 offset:20480
    ds_read_b64_tr_b16 a[238:239], v23 offset:20992
    s_cmp_lg_u32 s39, 447
    s_cbranch_scc1 noinit_9
    v_mov_b32 v53, 1
    s_mov_b64 exec, 1
    buffer_store_dword v53, off, s[92:95], 0 sc1
    s_mov_b64 exec, -1
noinit_9:
    v_readlane_b32 s34, v25, 0
    v_readlane_b32 s35, v25, 1
    v_readlane_b32 s36, v25, 2
    v_readlane_b32 s37, v25, 3
    s_waitcnt lgkmcnt(15)
    s_nop 0
    buffer_store_dwordx4 v[64:67], v24, s[12:15], s34 offen sc1
    buffer_store_dwordx4 v[68:71], v24, s[12:15], s35 offen sc1
    buffer_store_dwordx4 v[72:75], v24, s[12:15], s36 offen sc1
    buffer_store_dwordx4 v[76:79], v24, s[12:15], s37 offen sc1
    v_readlane_b32 s34, v25, 4
    v_readlane_b32 s35, v25, 5
    v_readlane_b32 s36, v25, 6
    v_readlane_b32 s37, v25, 7
    s_nop 1
    buffer_store_dwordx4 v[80:83], v24, s[12:15], s34 offen sc1
    buffer_store_dwordx4 v[84:87], v24, s[12:15], s35 offen sc1
    buffer_store_dwordx4 v[88:91], v24, s[12:15], s36 offen sc1
    buffer_store_dwordx4 v[92:95], v24, s[12:15], s37 offen sc1
    v_add_u32 v52, s25, v3
    v_lshlrev_b32 v52, 6, v52
    v_add_u32 v52, s24, v52
    v_cmp_eq_u32 s[56:57], 0, v52
    v_sub_u32 v53, 0x800, v52
    v_mov_b32 v54, 0x400
    v_cndmask_b32 v53, v53, v54, s[56:57]
    v_mul_u32_u24 v52, 1152, v52
    v_mul_u32_u24 v53, 1152, v53
    s_mov_b64 exec, 0xffff
    buffer_load_ushort v178, v52, s[4:7], 0 offen offset:576
    buffer_load_ushort v179, v53, s[4:7], 0 offen offset:576
    s_mov_b64 exec, -1
    s_add_u32 m0, s100, 24576
    s_nop 0
    buffer_load_dwordx4 v164, s[4:7], 0 offen offset:0 lds
    s_add_u32 m0, s100, 25600
    s_nop 0
    buffer_load_dwordx4 v165, s[4:7], 0 offen offset:0 lds
    s_add_u32 m0, s100, 26624
    s_nop 0
    buffer_load_dwordx4 v166, s[4:7], 0 offen offset:0 lds
    s_add_u32 m0, s100, 27648
    s_nop 0
    buffer_load_dwordx4 v167, s[4:7], 0 offen offset:0 lds
    s_add_u32 m0, s100, 27648
    s_nop 0
    buffer_load_dwordx4 v164, s[4:7], 0 offen offset:1024 lds
    s_add_u32 m0, s100, 28672
    s_nop 0
    buffer_load_dwordx4 v165, s[4:7], 0 offen offset:1024 lds
    s_add_u32 m0, s100, 29696
    s_nop 0
    buffer_load_dwordx4 v166, s[4:7], 0 offen offset:1024 lds
    s_add_u32 m0, s100, 30720
    s_nop 0
    buffer_load_dwordx4 v167, s[4:7], 0 offen offset:1024 lds
    s_add_u32 m0, s100, 32640
    s_nop 0
    buffer_load_dwordx4 v164, s[4:7], 0 offen offset:128 lds
    s_add_u32 m0, s100, 33664
    s_nop 0
    buffer_load_dwordx4 v165, s[4:7], 0 offen offset:128 lds
    s_add_u32 m0, s100, 34688
    s_nop 0
    buffer_load_dwordx4 v166, s[4:7], 0 offen offset:128 lds
    s_add_u32 m0, s100, 35712
    s_nop 0
    buffer_load_dwordx4 v167, s[4:7], 0 offen offset:128 lds
    s_add_u32 m0, s100, 35968
    s_nop 0
    buffer_load_dwordx4 v164, s[4:7], 0 offen offset:896 lds
    s_add_u32 m0, s100, 36992
    s_nop 0
    buffer_load_dwordx4 v165, s[4:7], 0 offen offset:896 lds
    s_add_u32 m0, s100, 38016
    s_nop 0
    buffer_load_dwordx4 v166, s[4:7], 0 offen offset:896 lds
    s_add_u32 m0, s100, 39040
    s_nop 0
    buffer_load_dwordx4 v167, s[4:7], 0 offen offset:896 lds
    s_waitcnt lgkmcnt(0)
    s_add_u32 m0, s100, 3840
    s_nop 0
    buffer_load_dwordx4 v164, s[4:7], 0 offen offset:256 lds
    s_add_u32 m0, s100, 4864
    s_nop 0
    buffer_load_dwordx4 v165, s[4:7], 0 offen offset:256 lds
    s_add_u32 m0, s100, 5888
    s_nop 0
    buffer_load_dwordx4 v166, s[4:7], 0 offen offset:256 lds
    s_add_u32 m0, s100, 6912
    s_nop 0
    buffer_load_dwordx4 v167, s[4:7], 0 offen offset:256 lds
    s_add_u32 m0, s100, 7424
    s_nop 0
    buffer_load_dwordx4 v164, s[4:7], 0 offen offset:768 lds
    s_add_u32 m0, s100, 8448
    s_nop 0
    buffer_load_dwordx4 v165, s[4:7], 0 offen offset:768 lds
    s_add_u32 m0, s100, 9472
    s_nop 0
    buffer_load_dwordx4 v166, s[4:7], 0 offen offset:768 lds
    s_add_u32 m0, s100, 10496
    s_nop 0
    buffer_load_dwordx4 v167, s[4:7], 0 offen offset:768 lds
    s_add_u32 m0, s100, 11904
    s_nop 0
    buffer_load_dwordx4 v164, s[4:7], 0 offen offset:384 lds
    s_add_u32 m0, s100, 12928
    s_nop 0
    buffer_load_dwordx4 v165, s[4:7], 0 offen offset:384 lds
    s_add_u32 m0, s100, 13952
    s_nop 0
    buffer_load_dwordx4 v166, s[4:7], 0 offen offset:384 lds
    s_add_u32 m0, s100, 14976
    s_nop 0
    buffer_load_dwordx4 v167, s[4:7], 0 offen offset:384 lds
    s_add_u32 m0, s100, 15744
    s_nop 0
    buffer_load_dwordx4 v164, s[4:7], 0 offen offset:640 lds
    s_add_u32 m0, s100, 16768
    s_nop 0
    buffer_load_dwordx4 v165, s[4:7], 0 offen offset:640 lds
    s_add_u32 m0, s100, 17792
    s_nop 0
    buffer_load_dwordx4 v166, s[4:7], 0 offen offset:640 lds
    s_add_u32 m0, s100, 18816
    s_nop 0
    buffer_load_dwordx4 v167, s[4:7], 0 offen offset:640 lds
    s_add_u32 m0, s100, 19968
    s_nop 0
    buffer_load_dwordx4 v164, s[4:7], 0 offen offset:512 lds
    s_add_u32 m0, s100, 20992
    s_nop 0
    buffer_load_dwordx4 v165, s[4:7], 0 offen offset:512 lds
    s_add_u32 m0, s100, 22016
    s_nop 0
    buffer_load_dwordx4 v166, s[4:7], 0 offen offset:512 lds
    s_add_u32 m0, s100, 23040
    s_nop 0
    buffer_load_dwordx4 v167, s[4:7], 0 offen offset:512 lds
    v_readlane_b32 s34, v25, 8
    v_readlane_b32 s35, v25, 9
    v_readlane_b32 s36, v25, 10
    v_readlane_b32 s37, v25, 11
    s_nop 1
    buffer_store_dwordx4 v[96:99], v24, s[12:15], s34 offen sc1
    buffer_store_dwordx4 v[100:103], v24, s[12:15], s35 offen sc1
    buffer_store_dwordx4 v[104:107], v24, s[12:15], s36 offen sc1
    buffer_store_dwordx4 v[108:111], v24, s[12:15], s37 offen sc1
    buffer_load_dword v183, off, s[92:95], 0 sc1
    v_readlane_b32 s34, v25, 12
    v_readlane_b32 s35, v25, 13
    v_readlane_b32 s36, v25, 14
    v_readlane_b32 s37, v25, 15
    s_nop 1
    buffer_store_dwordx4 v[112:115], v24, s[12:15], s34 offen sc1
    buffer_store_dwordx4 v[116:119], v24, s[12:15], s35 offen sc1
    buffer_store_dwordx4 v[120:123], v24, s[12:15], s36 offen sc1
    buffer_store_dwordx4 v[124:127], v24, s[12:15], s37 offen sc1
    s_waitcnt vmcnt(37)
    ds_read_b128 v[144:147], v173 offset:28672
    ds_read_u16 v180, v175 offset:28672
    ds_read_b128 v[148:151], v173 offset:30720
    ds_read_u16 v181, v175 offset:30720
    ds_read_b128 a[0:3], v170 offset:24576
    ds_read_b128 a[4:7], v170 offset:26624
    ds_read_b128 v[152:155], v172 offset:28672
    ds_read_u16 v162, v174 offset:28672
    ds_read_b128 v[156:159], v172 offset:30720
    ds_read_u16 v163, v174 offset:30720
    ds_read_b128 a[8:11], v171 offset:24576
    ds_read_b128 a[12:15], v171 offset:26624
    s_waitcnt lgkmcnt(8)
    v_cndmask_b32 v160, v180, v178, s[58:59]
    v_bfi_b32 v184, s45, v160, v147
    v_bfi_b32 v185, s45, v147, v146
    v_bfi_b32 v186, s45, v146, v145
    v_bfi_b32 v187, s45, v145, v144
    v_cndmask_b32 v161, v181, v179, s[58:59]
    v_bfi_b32 v188, s45, v161, v151
    v_bfi_b32 v189, s45, v151, v150
    v_bfi_b32 v190, s45, v150, v149
    v_bfi_b32 v191, s45, v149, v148
    s_waitcnt vmcnt(29)
    ds_read_b128 v[144:147], v173 offset:36864
    ds_read_u16 v178, v175 offset:36864
    ds_read_b128 v[148:151], v173 offset:38912
    ds_read_u16 v179, v175 offset:38912
    ds_read_b128 a[16:19], v170 offset:32768
    ds_read_b128 a[20:23], v170 offset:34816
    s_waitcnt lgkmcnt(8)
    v_bfi_b32 v192, s45, v162, v155
    v_bfi_b32 v193, s45, v155, v154
    v_bfi_b32 v194, s45, v154, v153
    v_bfi_b32 v195, s45, v153, v152
    v_bfi_b32 v196, s45, v163, v159
    v_bfi_b32 v197, s45, v159, v158
    v_bfi_b32 v198, s45, v158, v157
    v_bfi_b32 v199, s45, v157, v156
    ds_read_b128 v[152:155], v172 offset:36864
    ds_read_u16 v162, v174 offset:36864
    ds_read_b128 v[156:159], v172 offset:38912
    ds_read_u16 v163, v174 offset:38912
    ds_read_b128 a[24:27], v171 offset:32768
    ds_read_b128 a[28:31], v171 offset:34816
    s_waitcnt lgkmcnt(8)
    v_cndmask_b32 v160, v178, v180, s[58:59]
    v_bfi_b32 v200, s45, v160, v147
    v_bfi_b32 v201, s45, v147, v146
    v_bfi_b32 v202, s45, v146, v145
    v_bfi_b32 v203, s45, v145, v144
    v_cndmask_b32 v161, v179, v181, s[58:59]
    v_bfi_b32 v204, s45, v161, v151
    v_bfi_b32 v205, s45, v151, v150
    v_bfi_b32 v206, s45, v150, v149
    v_bfi_b32 v207, s45, v149, v148
    s_waitcnt vmcnt(21)
    ds_read_b128 v[144:147], v173 offset:8192
    ds_read_u16 v180, v175 offset:8192
    ds_read_b128 v[148:151], v173 offset:10240
    ds_read_u16 v181, v175 offset:10240
    ds_read_b128 a[32:35], v170 offset:4096
    ds_read_b128 a[36:39], v170 offset:6144
    s_waitcnt lgkmcnt(8)
    v_bfi_b32 v208, s45, v162, v155
    v_bfi_b32 v209, s45, v155, v154
    v_bfi_b32 v210, s45, v154, v153
    v_bfi_b32 v211, s45, v153, v152
    v_bfi_b32 v212, s45, v163, v159
    v_bfi_b32 v213, s45, v159, v158
    v_bfi_b32 v214, s45, v158, v157
    v_bfi_b32 v215, s45, v157, v156
    ds_read_b128 v[152:155], v172 offset:8192
    ds_read_u16 v162, v174 offset:8192
    ds_read_b128 v[156:159], v172 offset:10240
    ds_read_u16 v163, v174 offset:10240
    ds_read_b128 a[40:43], v171 offset:4096
    ds_read_b128 a[44:47], v171 offset:6144
    s_waitcnt lgkmcnt(8)
    v_cndmask_b32 v160, v180, v178, s[58:59]
    v_bfi_b32 v216, s45, v160, v147
    v_bfi_b32 v217, s45, v147, v146
    v_bfi_b32 v218, s45, v146, v145
    v_bfi_b32 v219, s45, v145, v144
    v_cndmask_b32 v161, v181, v179, s[58:59]
    v_bfi_b32 v220, s45, v161, v151
    v_bfi_b32 v221, s45, v151, v150
    v_bfi_b32 v222, s45, v150, v149
    v_bfi_b32 v223, s45, v149, v148
    s_waitcnt vmcnt(13)
    ds_read_b128 v[144:147], v173 offset:16384
    ds_read_u16 v178, v175 offset:16384
    ds_read_b128 v[148:151], v173 offset:18432
    ds_read_u16 v179, v175 offset:18432
    ds_read_b128 a[48:51], v170 offset:12288
    ds_read_b128 a[52:55], v170 offset:14336
    s_waitcnt lgkmcnt(8)
    v_bfi_b32 v224, s45, v162, v155
    v_bfi_b32 v225, s45, v155, v154
    v_bfi_b32 v226, s45, v154, v153
    v_bfi_b32 v227, s45, v153, v152
    v_bfi_b32 v228, s45, v163, v159
    v_bfi_b32 v229, s45, v159, v158
    v_bfi_b32 v230, s45, v158, v157
    v_bfi_b32 v231, s45, v157, v156
    ds_read_b128 v[152:155], v172 offset:16384
    ds_read_u16 v162, v174 offset:16384
    ds_read_b128 v[156:159], v172 offset:18432
    ds_read_u16 v163, v174 offset:18432
    ds_read_b128 a[56:59], v171 offset:12288
    ds_read_b128 a[60:63], v171 offset:14336
    s_waitcnt lgkmcnt(8)
    v_cndmask_b32 v160, v178, v180, s[58:59]
    v_bfi_b32 v232, s45, v160, v147
    v_bfi_b32 v233, s45, v147, v146
    v_bfi_b32 v234, s45, v146, v145
    v_bfi_b32 v235, s45, v145, v144
    v_cndmask_b32 v161, v179, v181, s[58:59]
    v_bfi_b32 v236, s45, v161, v151
    v_bfi_b32 v237, s45, v151, v150
    v_bfi_b32 v238, s45, v150, v149
    v_bfi_b32 v239, s45, v149, v148
    s_waitcnt vmcnt(9)
    ds_read_b128 v[144:147], v173 offset:20480
    ds_read_u16 v180, v175 offset:20480
    ds_read_b128 v[148:151], v173 offset:22528
    ds_read_u16 v181, v175 offset:22528
    ds_read_b128 a[64:67], v170 offset:20480
    ds_read_b128 a[68:71], v170 offset:22528
    s_waitcnt lgkmcnt(8)
    v_bfi_b32 v240, s45, v162, v155
    v_bfi_b32 v241, s45, v155, v154
    v_bfi_b32 v242, s45, v154, v153
    v_bfi_b32 v243, s45, v153, v152
    v_bfi_b32 v244, s45, v163, v159
    v_bfi_b32 v245, s45, v159, v158
    v_bfi_b32 v246, s45, v158, v157
    v_bfi_b32 v247, s45, v157, v156
    s_waitcnt lgkmcnt(2)
    v_cndmask_b32 v160, v180, v178, s[58:59]
    v_bfi_b32 v248, s45, v160, v147
    v_bfi_b32 v249, s45, v147, v146
    v_bfi_b32 v250, s45, v146, v145
    v_bfi_b32 v251, s45, v145, v144
    v_cndmask_b32 v161, v181, v179, s[58:59]
    v_bfi_b32 v252, s45, v161, v151
    v_bfi_b32 v253, s45, v151, v150
    v_bfi_b32 v254, s45, v150, v149
    v_bfi_b32 v255, s45, v149, v148
    v_readlane_b32 s0, v25, 16
    v_readlane_b32 s1, v25, 17
    v_readlane_b32 s4, v25, 18
    v_readlane_b32 s5, v25, 19
    v_readlane_b32 s6, v25, 20
    v_readlane_b32 s7, v25, 21
    v_readlane_b32 s50, v25, 22
    v_readlane_b32 s51, v25, 23
    s_and_b32 s99, s20, 7
    s_lshl_b32 s99, s99, 8
    s_add_u32 s99, s99, 16877568
    s_mov_b32 s100, 1
    s_mov_b32 s101, 16910336
    s_branch wait_4
.p2align 12
page0:
task_2:
    s_add_u32 m0, s100, 0
    s_nop 0
    buffer_load_dwordx4 v164, s[4:7], 0 offen offset:0 lds
    s_add_u32 m0, s100, 1024
    s_nop 0
    buffer_load_dwordx4 v165, s[4:7], 0 offen offset:0 lds
    s_add_u32 m0, s100, 2048
    s_nop 0
    buffer_load_dwordx4 v166, s[4:7], 0 offen offset:0 lds
    s_add_u32 m0, s100, 3072
    s_nop 0
    buffer_load_dwordx4 v167, s[4:7], 0 offen offset:0 lds
    s_add_u32 m0, s100, 3072
    s_nop 0
    buffer_load_dwordx4 v164, s[4:7], 0 offen offset:1024 lds
    s_add_u32 m0, s100, 4096
    s_nop 0
    buffer_load_dwordx4 v165, s[4:7], 0 offen offset:1024 lds
    s_add_u32 m0, s100, 5120
    s_nop 0
    buffer_load_dwordx4 v166, s[4:7], 0 offen offset:1024 lds
    s_add_u32 m0, s100, 6144
    s_nop 0
    buffer_load_dwordx4 v167, s[4:7], 0 offen offset:1024 lds
    s_and_b32 s41, s23, 1
    s_lshl_b32 s41, s41, 3
    s_lshl_b32 s42, s96, 5
    s_add_u32 s41, s41, s42
    v_and_b32 v57, 7, v0
    v_xor_b32 v57, v57, v2
    v_lshlrev_b32 v57, 4, v57
    v_lshrrev_b32 v56, 5, v0
    v_lshlrev_b32 v56, 4, v56
    v_bfe_u32 v58, v0, 3, 2
    v_add3_u32 v56, v56, v58, s41
    v_cmp_eq_u32 vcc, 0, v56
    v_add_u32 v59, 4, v56
    v_mov_b32 v58, 0x120
    v_cndmask_b32 v56, v56, v58, vcc
    s_movk_i32 s41, 1152
    v_mad_u32_u24 v168, v56, s41, v57
    v_xor_b32 v57, 64, v57
    v_mad_u32_u24 v169, v59, s41, v57
    s_lshl_b32 s55, s23, 11
    s_add_u32 m0, s55, 110592
    s_nop 0
    buffer_load_dwordx4 v168, s[8:11], 0 offen offset:0 lds
    s_add_u32 m0, s55, 111616
    s_nop 0
    buffer_load_dwordx4 v169, s[8:11], 0 offen offset:0 lds
    s_add_u32 m0, s55, 118656
    s_nop 0
    buffer_load_dwordx4 v168, s[8:11], 0 offen offset:128 lds
    s_add_u32 m0, s55, 119680
    s_nop 0
    buffer_load_dwordx4 v169, s[8:11], 0 offen offset:128 lds
    v_add_u32 v52, s25, v3
    v_lshlrev_b32 v52, 6, v52
    v_add_u32 v52, s24, v52
    v_cmp_eq_u32 s[56:57], 0, v52
    v_sub_u32 v53, 0x800, v52
    v_mov_b32 v54, 0x400
    v_cndmask_b32 v53, v53, v54, s[56:57]
    v_mul_u32_u24 v52, 1152, v52
    v_mul_u32_u24 v53, 1152, v53
    s_mov_b64 exec, 0xffff
    buffer_load_ushort v178, v52, s[4:7], 0 offen offset:576
    buffer_load_ushort v179, v53, s[4:7], 0 offen offset:576
    s_mov_b64 exec, -1
    s_mul_i32 s34, s20, 9
    s_add_u32 s34, s34, s96
    s_mul_hi_u32 s36, s34, 0x1c71c71d
    s_mul_i32 s37, s36, 9
    s_sub_u32 s37, s34, s37
    s_lshr_b32 s38, s36, 2
    s_and_b32 s36, s36, 3
    s_mul_i32 s45, s37, 11
    s_lshr_b32 s45, s45, 5
    s_mul_i32 s47, s45, 3
    s_sub_u32 s47, s37, s47
    s_cmp_ge_u32 s37, 6
    s_cselect_b32 s45, 9, s45
    s_cmp_ge_u32 s37, 7
    s_cselect_b32 s39, 3, 2
    s_add_u32 s39, s39, s37
    s_add_u32 s41, s38, 1
    s_mul_i32 s42, s38, 3981312
    s_add_u32 s42, s42, 663552
    s_mov_b32 s44, 995328
    v_mov_b32 v23, s45
    v_mov_b32 v24, s47
    v_mov_b32 v25, s39
    s_sub_u32 s43, s23, 1
    s_mul_i32 s43, s43, 6
    v_cmp_lt_u32 vcc, 5, v0
    v_add_u32 v16, s43, v0
    v_add_u32 v17, 12, v16
    v_cndmask_b32 v16, v16, v17, vcc
    v_lshrrev_b32 v17, 1, v16
    v_and_b32 v18, 1, v16
    v_mul_u32_u24 v19, 57, v16
    v_lshrrev_b32 v19, 9, v19
    v_mul_u32_u24 v20, 9, v19
    v_add_u32 v20, 1, v20
    v_lshrrev_b32 v20, 1, v20
    v_sub_u32 v20, v17, v20
    v_cmp_lt_u32 vcc, 3, v20
    v_subrev_u32 v20, s41, v20
    v_and_b32 v20, 3, v20
    v_lshl_add_u32 v20, v20, 1, v18
    v_add_u32 v20, 1, v20
    v_cndmask_b32 v20, v20, 0, vcc
    v_sub_u32 v21, s36, v19
    v_and_b32 v21, 3, v21
    v_cmp_eq_u32 vcc, 0, v21
    v_subrev_u32 v21, 1, v21
    s_nop 0
    v_cndmask_b32 v21, v21, v24, vcc
    v_cndmask_b32 v22, v25, v23, vcc
    v_cmp_gt_u32 vcc, 9, v22
    v_mad_u32_u24 v26, v22, 3, v20
    v_mul_u32_u24 v27, 9, v20
    v_cndmask_b32 v26, v26, v27, vcc
    v_cmp_gt_u32 vcc, 4, v20
    v_mul_u32_u24 v27, 12, v20
    s_nop 0
    v_cndmask_b32 v26, v27, v26, vcc
    v_add_u32 v26, v26, v22
    v_mad_u32_u24 v20, v26, 3, v21
    v_lshlrev_b32 v20, 10, v20
    v_mad_u32_u24 v20, v19, s44, v20
    v_add_u32 v182, s42, v20
    s_lshl_b32 s99, s38, 8
    s_add_u32 s99, s99, 16875520
    s_lshl_b32 s31, s23, 2
    v_lshrrev_b32 v48, 2, v3
    v_add_u32 v48, s31, v48
    v_cmp_eq_u32 s[42:43], 0, v48
    v_and_b32 v49, 2, v3
    v_lshl_add_u32 v48, v49, 4, v48
    v_and_b32 v50, 1, v3
    v_cmp_eq_u32 s[58:59], 1, v50
    v_sub_u32 v51, 64, v48
    v_lshlrev_b32 v49, 3, v49
    v_cndmask_b32 v48, v48, v51, s[58:59]
    v_lshl_add_u32 v49, v50, 5, v49
    v_cndmask_b32 v48, v48, v49, s[42:43]
    v_cmp_eq_u32 s[42:43], s20, 0
    v_lshlrev_b32 v49, 9, v2
    v_add_u32 v49, s20, v49
    v_cndmask_b32 v50, 32, 16, s[42:43]
    v_add_u32 v50, v50, v49
    v_and_b32 v52, 1, v2
    v_lshlrev_b32 v52, 9, v52
    v_lshrrev_b32 v51, 1, v2
    v_lshl_add_u32 v52, v51, 5, v52
    v_cndmask_b32 v49, v49, v52, s[42:43]
    v_cvt_f32_u32 v51, v48
    v_mul_f32 v51, 0x3d000000, v51
    v_mul_u32_u24 v52, v48, v49
    v_and_b32 v52, 0x7ff, v52
    v_cvt_f32_u32 v52, v52
    v_mul_f32 v52, 0x3a000000, v52
    v_cos_f32 v54, v52
    v_sin_f32 v56, v52
    v_add_f32 v52, v52, v51
    v_cos_f32 v55, v52
    v_sin_f32 v57, v52
    v_add_f32 v52, v52, v51
    v_cvt_pk_bf16_f32 v16, v54, v55
    v_cvt_pk_bf16_f32 v24, v56, v57
    v_cvt_pk_bf16_f32 v32, -v56, -v57
    v_mov_b32 v40, v16
    v_cos_f32 v54, v52
    v_sin_f32 v56, v52
    v_add_f32 v52, v52, v51
    v_cos_f32 v55, v52
    v_sin_f32 v57, v52
    v_add_f32 v52, v52, v51
    v_cvt_pk_bf16_f32 v17, v54, v55
    v_cvt_pk_bf16_f32 v25, v56, v57
    v_cvt_pk_bf16_f32 v33, -v56, -v57
    v_mov_b32 v41, v17
    v_cos_f32 v54, v52
    v_sin_f32 v56, v52
    v_add_f32 v52, v52, v51
    v_cos_f32 v55, v52
    v_sin_f32 v57, v52
    v_add_f32 v52, v52, v51
    v_cvt_pk_bf16_f32 v18, v54, v55
    v_cvt_pk_bf16_f32 v26, v56, v57
    v_cvt_pk_bf16_f32 v34, -v56, -v57
    v_mov_b32 v42, v18
    v_cos_f32 v54, v52
    v_sin_f32 v56, v52
    v_add_f32 v52, v52, v51
    v_cos_f32 v55, v52
    v_sin_f32 v57, v52
    v_cvt_pk_bf16_f32 v19, v54, v55
    v_cvt_pk_bf16_f32 v27, v56, v57
    v_cvt_pk_bf16_f32 v35, -v56, -v57
    v_mov_b32 v43, v19
    v_mul_u32_u24 v52, v48, v50
    v_and_b32 v52, 0x7ff, v52
    v_cvt_f32_u32 v52, v52
    v_mul_f32 v52, 0x3a000000, v52
    v_cos_f32 v54, v52
    v_sin_f32 v56, v52
    v_add_f32 v52, v52, v51
    v_cos_f32 v55, v52
    v_sin_f32 v57, v52
    v_add_f32 v52, v52, v51
    v_cvt_pk_bf16_f32 v20, v54, v55
    v_cvt_pk_bf16_f32 v28, v56, v57
    v_cvt_pk_bf16_f32 v36, -v56, -v57
    v_mov_b32 v44, v20
    v_cos_f32 v54, v52
    v_sin_f32 v56, v52
    v_add_f32 v52, v52, v51
    v_cos_f32 v55, v52
    v_sin_f32 v57, v52
    v_add_f32 v52, v52, v51
    v_cvt_pk_bf16_f32 v21, v54, v55
    v_cvt_pk_bf16_f32 v29, v56, v57
    v_cvt_pk_bf16_f32 v37, -v56, -v57
    v_mov_b32 v45, v21
    v_cos_f32 v54, v52
    v_sin_f32 v56, v52
    v_add_f32 v52, v52, v51
    v_cos_f32 v55, v52
    v_sin_f32 v57, v52
    v_add_f32 v52, v52, v51
    v_cvt_pk_bf16_f32 v22, v54, v55
    v_cvt_pk_bf16_f32 v30, v56, v57
    v_cvt_pk_bf16_f32 v38, -v56, -v57
    v_mov_b32 v46, v22
    v_cos_f32 v54, v52
    v_sin_f32 v56, v52
    v_add_f32 v52, v52, v51
    v_cos_f32 v55, v52
    v_sin_f32 v57, v52
    v_cvt_pk_bf16_f32 v23, v54, v55
    v_cvt_pk_bf16_f32 v31, v56, v57
    v_cvt_pk_bf16_f32 v39, -v56, -v57
    v_mov_b32 v47, v23
    s_cmp_lg_u32 s20, 0
    s_cbranch_scc1 nsp_10
    v_mov_b32 v36, v20
    v_mov_b32 v44, v28
    v_mov_b32 v20, 0
    v_mov_b32 v28, 0
    v_mov_b32 v32, 0
    v_mov_b32 v40, 0
    v_mov_b32 v37, v21
    v_mov_b32 v45, v29
    v_mov_b32 v21, 0
    v_mov_b32 v29, 0
    v_mov_b32 v33, 0
    v_mov_b32 v41, 0
    v_mov_b32 v38, v22
    v_mov_b32 v46, v30
    v_mov_b32 v22, 0
    v_mov_b32 v30, 0
    v_mov_b32 v34, 0
    v_mov_b32 v42, 0
    v_mov_b32 v39, v23
    v_mov_b32 v47, v31
    v_mov_b32 v23, 0
    v_mov_b32 v31, 0
    v_mov_b32 v35, 0
    v_mov_b32 v43, 0
    v_and_b32 v53, 1, v48
    v_lshlrev_b32 v53, 15, v53
    v_or_b32 v53, 0x3f80, v53
    v_and_b32 v54, 0xffff0000, v24
    v_or_b32 v53, v53, v54
    v_cmp_eq_u32 s[42:43], 0, v2
    s_nop 1
    v_cndmask_b32 v24, v24, v53, s[42:43]
nsp_10:
    v_lshrrev_b32 v48, 1, v3
    v_lshl_add_u32 v49, v3, 7, s100
    v_xor_b32 v170, v2, v48
    v_lshl_add_u32 v170, v170, 4, v49
    v_xor_b32 v171, 64, v170
    v_xor_b32 v172, 48, v170
    v_xor_b32 v173, 48, v171
    v_sub_u32 v50, 4, v2
    v_xor_b32 v174, v50, v48
    v_lshl_add_u32 v174, v174, 4, v49
    v_sub_u32 v50, 8, v2
    v_and_b32 v50, 7, v50
    v_xor_b32 v175, v50, v48
    v_lshl_add_u32 v175, v175, 4, v49
    v_cmp_eq_u32 s[58:59], 0, v2
    s_mov_b32 s45, 0xffff
    v_mov_b32 v12, 0x3f803f80
    v_mov_b32 v13, 0x3f803f80
    v_mov_b32 v14, 0x3f803f80
    v_mov_b32 v15, 0x3f803f80
    v_lshrrev_b32 v48, 1, v3
    v_xor_b32 v48, v48, v2
    v_lshlrev_b32 v48, 4, v48
    v_lshl_add_u32 v48, v3, 7, v48
    v_add_u32 v176, 110592, v48
    v_xor_b32 v177, 64, v176
    v_mul_u32_u24 v7, 80, v2
    v_mul_u32_u24 v8, 144, v3
    v_add_u32 v8, 151552, v8
    s_lshl_b32 s41, s23, 5
    v_lshl_add_u32 v9, v2, 3, v8
    v_add_u32 v9, s41, v9
    v_lshl_add_u32 v8, v2, 4, v8
    v_cmp_eq_u32 vcc, 0, v2
    v_mov_b32 v53, 0x3f80
    v_accvgpr_write_b32 a89, 0
    v_accvgpr_write_b32 a90, 0
    v_accvgpr_write_b32 a91, 0
    v_cndmask_b32 v53, 0, v53, vcc
    v_accvgpr_write_b32 a88, v53
    v_and_b32 v10, 1, v3
    v_lshlrev_b32 v53, 15, v10
    v_cndmask_b32 v5, 0, v53, vcc
    v_lshlrev_b32 v10, 30, v10
    s_mov_b32 s47, 0x80008000
    s_lshl_b32 s41, s2, 2
    s_add_u32 s41, s41, s23
    s_lshl_b32 s41, s41, 7
    s_add_u32 s41, s41, 16777216
    v_mov_b32 v54, 0
    v_and_b32 v53, 31, v0
    v_lshlrev_b32 v53, 2, v53
    buffer_store_dword v54, v53, s[12:15], s41 offen sc1
    s_add_u32 m0, s100, 8064
    s_nop 0
    buffer_load_dwordx4 v164, s[4:7], 0 offen offset:128 lds
    s_add_u32 m0, s100, 9088
    s_nop 0
    buffer_load_dwordx4 v165, s[4:7], 0 offen offset:128 lds
    s_add_u32 m0, s100, 10112
    s_nop 0
    buffer_load_dwordx4 v166, s[4:7], 0 offen offset:128 lds
    s_add_u32 m0, s100, 11136
    s_nop 0
    buffer_load_dwordx4 v167, s[4:7], 0 offen offset:128 lds
    s_add_u32 m0, s100, 11392
    s_nop 0
    buffer_load_dwordx4 v164, s[4:7], 0 offen offset:896 lds
    s_add_u32 m0, s100, 12416
    s_nop 0
    buffer_load_dwordx4 v165, s[4:7], 0 offen offset:896 lds
    s_add_u32 m0, s100, 13440
    s_nop 0
    buffer_load_dwordx4 v166, s[4:7], 0 offen offset:896 lds
    s_add_u32 m0, s100, 14464
    s_nop 0
    buffer_load_dwordx4 v167, s[4:7], 0 offen offset:896 lds
    s_waitcnt vmcnt(9)
    ds_read_b128 v[144:147], v173 offset:4096
    ds_read_u16 v180, v175 offset:4096
    ds_read_b128 v[148:151], v173 offset:6144
    ds_read_u16 v181, v175 offset:6144
    ds_read_b128 a[0:3], v170 offset:0
    ds_read_b128 a[4:7], v170 offset:2048
    s_waitcnt lgkmcnt(2)
    v_cndmask_b32 v160, v180, v178, s[58:59]
    v_bfi_b32 v184, s45, v160, v147
    v_bfi_b32 v185, s45, v147, v146
    v_bfi_b32 v186, s45, v146, v145
    v_bfi_b32 v187, s45, v145, v144
    v_cndmask_b32 v161, v181, v179, s[58:59]
    v_bfi_b32 v188, s45, v161, v151
    v_bfi_b32 v189, s45, v151, v150
    v_bfi_b32 v190, s45, v150, v149
    v_bfi_b32 v191, s45, v149, v148
    s_waitcnt lgkmcnt(0)
    v_mfma_f32_16x16x32_bf16 v[88:91], a[0:3], a[0:3], 0
    ds_read_b128 v[152:155], v172 offset:4096
    s_add_u32 m0, s100, 16128
    v_mfma_f32_16x16x32_bf16 v[88:91], v[184:187], v[184:187], v[88:91]
    ds_read_u16 v162, v174 offset:4096
    v_mfma_f32_16x16x32_bf16 v[92:95], a[4:7], a[4:7], 0
    ds_read_b128 v[156:159], v172 offset:6144
    buffer_load_dwordx4 v164, s[4:7], 0 offen offset:256 lds
    v_mfma_f32_16x16x32_bf16 v[92:95], v[188:191], v[188:191], v[92:95]
    ds_read_u16 v163, v174 offset:6144
    s_add_u32 m0, s100, 17152
    v_mfma_f32_16x16x32_bf16 v[80:83], a[0:3], v[12:15], 0
    ds_read_b128 a[8:11], v171 offset:0
    v_mfma_f32_16x16x32_bf16 v[80:83], v[184:187], v[12:15], v[80:83]
    ds_read_b128 a[12:15], v171 offset:2048
    buffer_load_dwordx4 v165, s[4:7], 0 offen offset:256 lds
    v_mfma_f32_16x16x32_bf16 a[92:95], a[0:3], a[88:91], 0
    s_barrier
    ds_read_b128 v[128:131], v176 offset:0
    v_mfma_f32_16x16x32_bf16 v[84:87], a[4:7], v[12:15], 0
    ds_read_b128 v[132:135], v176 offset:2048
    s_waitcnt lgkmcnt(4)
    v_bfi_b32 v192, s45, v162, v155
    v_bfi_b32 v193, s45, v155, v154
    s_add_u32 m0, s100, 18176
    v_mfma_f32_16x16x32_bf16 v[84:87], v[188:191], v[12:15], v[84:87]
    ds_read_b128 a[72:75], v176 offset:0
    v_bfi_b32 v194, s45, v154, v153
    v_bfi_b32 v195, s45, v153, v152
    v_bfi_b32 v196, s45, v163, v159
    v_bfi_b32 v197, s45, v159, v158
    v_bfi_b32 v198, s45, v158, v157
    v_bfi_b32 v199, s45, v157, v156
    buffer_load_dwordx4 v166, s[4:7], 0 offen offset:256 lds
    v_mfma_f32_16x16x32_bf16 a[96:99], a[4:7], a[88:91], 0
    ds_read_b128 a[76:79], v176 offset:2048
    s_waitcnt lgkmcnt(4)
    v_mfma_f32_16x16x32_bf16 v[88:91], a[8:11], a[8:11], v[88:91]
    ds_read_b128 v[104:107], v176 offset:4096
    s_add_u32 m0, s100, 19200
    v_mfma_f32_16x16x32_bf16 v[88:91], v[192:195], v[192:195], v[88:91]
    ds_read_b128 v[108:111], v176 offset:6144
    s_waitcnt vmcnt(3)
    ds_read_b128 v[144:147], v173 offset:12288
    ds_read_u16 v178, v175 offset:12288
    buffer_load_dwordx4 v167, s[4:7], 0 offen offset:256 lds
    v_mfma_f32_16x16x32_bf16 v[92:95], a[12:15], a[12:15], v[92:95]
    ds_read_b128 v[148:151], v173 offset:14336
    s_add_u32 m0, s100, 19712
    v_mfma_f32_16x16x32_bf16 v[92:95], v[196:199], v[196:199], v[92:95]
    ds_read_u16 v179, v175 offset:14336
    v_mfma_f32_16x16x32_bf16 v[80:83], a[8:11], v[12:15], v[80:83]
    ds_read_b128 a[16:19], v170 offset:8192
    buffer_load_dwordx4 v164, s[4:7], 0 offen offset:768 lds
    v_mfma_f32_16x16x32_bf16 v[80:83], v[192:195], v[12:15], v[80:83]
    ds_read_b128 a[20:23], v170 offset:10240
    s_add_u32 m0, s100, 20736
    v_mfma_f32_16x16x32_bf16 v[84:87], a[12:15], v[12:15], v[84:87]
    buffer_load_dwordx4 v165, s[4:7], 0 offen offset:768 lds
    v_mfma_f32_16x16x32_bf16 v[84:87], v[196:199], v[12:15], v[84:87]
    s_waitcnt lgkmcnt(6)
    v_xor_b32 v128, v128, v5
    v_xor_b32 v132, v132, v5
    v_mfma_f32_16x16x32_bf16 v[96:99], v[12:15], a[72:75], 0
    ds_read_b128 a[80:83], v177 offset:0
    s_add_u32 m0, s100, 21760
    v_mfma_f32_16x16x32_bf16 v[100:103], v[12:15], a[76:79], 0
    buffer_load_dwordx4 v166, s[4:7], 0 offen offset:768 lds
    v_mfma_f32_16x16x32_bf16 v[48:51], a[0:3], a[72:75], 0
    ds_read_b128 a[84:87], v177 offset:2048
    v_xor_b32 v120, s47, v104
    v_mfma_f32_16x16x32_bf16 v[48:51], v[184:187], v[128:131], v[48:51]
    s_waitcnt lgkmcnt(4)
    v_xor_b32 v121, s47, v105
    v_xor_b32 v122, s47, v106
    v_mfma_f32_16x16x32_bf16 v[64:67], a[4:7], a[72:75], 0
    ds_read_b128 v[112:115], v177 offset:4096
    s_add_u32 m0, s100, 22784
    v_mfma_f32_16x16x32_bf16 v[64:67], v[188:191], v[128:131], v[64:67]
    buffer_load_dwordx4 v167, s[4:7], 0 offen offset:768 lds
    v_cndmask_b32 v160, v178, v180, s[58:59]
    v_xor_b32 v123, s47, v107
    v_mfma_f32_16x16x32_bf16 v[52:55], a[0:3], a[76:79], 0
    ds_read_b128 v[116:119], v177 offset:6144
    v_bfi_b32 v200, s45, v160, v147
    v_xor_b32 v124, s47, v108
    v_mfma_f32_16x16x32_bf16 v[52:55], v[184:187], v[132:135], v[52:55]
    s_add_u32 m0, s55, 126720
    v_bfi_b32 v201, s45, v147, v146
    v_xor_b32 v125, s47, v109
    v_mfma_f32_16x16x32_bf16 v[68:71], a[4:7], a[76:79], 0
    buffer_load_dwordx4 v168, s[8:11], 0 offen offset:256 lds
    v_xor_b32 v126, s47, v110
    v_mfma_f32_16x16x32_bf16 v[68:71], v[188:191], v[132:135], v[68:71]
    s_add_u32 m0, s55, 127744
    v_bfi_b32 v202, s45, v146, v145
    v_xor_b32 v127, s47, v111
    v_mfma_f32_16x16x32_bf16 v[56:59], a[0:3], v[104:107], 0
    v_bfi_b32 v203, s45, v145, v144
    v_cndmask_b32 v161, v179, v181, s[58:59]
    v_mfma_f32_16x16x32_bf16 v[72:75], a[4:7], v[104:107], 0
    buffer_load_dwordx4 v169, s[8:11], 0 offen offset:256 lds
    v_mfma_f32_16x16x32_bf16 v[60:63], a[0:3], v[108:111], 0
    s_add_u32 m0, s55, 134784
    v_bfi_b32 v204, s45, v161, v151
    v_bfi_b32 v205, s45, v151, v150
    v_mfma_f32_16x16x32_bf16 v[76:79], a[4:7], v[108:111], 0
    buffer_load_dwordx4 v168, s[8:11], 0 offen offset:384 lds
    v_mfma_f32_16x16x32_bf16 v[56:59], v[184:187], v[120:123], v[56:59]
    s_add_u32 m0, s55, 135808
    v_bfi_b32 v206, s45, v150, v149
    v_bfi_b32 v207, s45, v149, v148
    v_mfma_f32_16x16x32_bf16 v[72:75], v[188:191], v[120:123], v[72:75]
    buffer_load_dwordx4 v169, s[8:11], 0 offen offset:384 lds
    v_mfma_f32_16x16x32_bf16 v[60:63], v[184:187], v[124:127], v[60:63]
    s_add_u32 m0, s55, 142848
    v_mfma_f32_16x16x32_bf16 v[76:79], v[188:191], v[124:127], v[76:79]
    s_waitcnt lgkmcnt(4)
    v_mfma_f32_16x16x32_bf16 v[88:91], a[16:19], a[16:19], v[88:91]
    ds_read_b128 v[152:155], v172 offset:12288
    v_mfma_f32_16x16x32_bf16 v[88:91], v[200:203], v[200:203], v[88:91]
    ds_read_u16 v162, v174 offset:12288
    v_mfma_f32_16x16x32_bf16 v[92:95], a[20:23], a[20:23], v[92:95]
    ds_read_b128 v[156:159], v172 offset:14336
    buffer_load_dwordx4 v168, s[8:11], 0 offen offset:512 lds
    v_mfma_f32_16x16x32_bf16 v[92:95], v[204:207], v[204:207], v[92:95]
    ds_read_u16 v163, v174 offset:14336
    s_add_u32 m0, s55, 143872
    v_mfma_f32_16x16x32_bf16 v[80:83], a[16:19], v[12:15], v[80:83]
    ds_read_b128 a[24:27], v171 offset:8192
    v_mfma_f32_16x16x32_bf16 v[80:83], v[200:203], v[12:15], v[80:83]
    ds_read_b128 a[28:31], v171 offset:10240
    buffer_load_dwordx4 v169, s[8:11], 0 offen offset:512 lds
    s_add_u32 m0, s100, -384
    s_nop 0
    buffer_load_dwordx4 v164, s[4:7], 0 offen offset:384 lds
    s_add_u32 m0, s100, 640
    s_nop 0
    buffer_load_dwordx4 v165, s[4:7], 0 offen offset:384 lds
    v_mfma_f32_16x16x32_bf16 v[84:87], a[20:23], v[12:15], v[84:87]
    s_add_u32 m0, s100, 1664
    v_mfma_f32_16x16x32_bf16 v[84:87], v[204:207], v[12:15], v[84:87]
    s_waitcnt lgkmcnt(6)
    buffer_load_dwordx4 v166, s[4:7], 0 offen offset:384 lds
    v_mfma_f32_16x16x32_bf16 v[96:99], v[12:15], a[80:83], v[96:99]
    ds_read_b128 a[72:75], v176 offset:8192
    s_add_u32 m0, s100, 2688
    v_mfma_f32_16x16x32_bf16 v[100:103], v[12:15], a[84:87], v[100:103]
    buffer_load_dwordx4 v167, s[4:7], 0 offen offset:384 lds
    v_mfma_f32_16x16x32_bf16 v[48:51], a[8:11], a[80:83], v[48:51]
    ds_read_b128 a[76:79], v176 offset:10240
    v_xor_b32 v120, s47, v112
    v_mfma_f32_16x16x32_bf16 v[48:51], v[192:195], a[80:83], v[48:51]
    s_waitcnt lgkmcnt(4)
    v_xor_b32 v121, s47, v113
    v_xor_b32 v122, s47, v114
    v_mfma_f32_16x16x32_bf16 v[64:67], a[12:15], a[80:83], v[64:67]
    ds_read_b128 v[104:107], v176 offset:12288
    s_add_u32 m0, s100, 3456
    v_mfma_f32_16x16x32_bf16 v[64:67], v[196:199], a[80:83], v[64:67]
    buffer_load_dwordx4 v164, s[4:7], 0 offen offset:640 lds
    v_bfi_b32 v208, s45, v162, v155
    v_xor_b32 v123, s47, v115
    v_mfma_f32_16x16x32_bf16 v[52:55], a[8:11], a[84:87], v[52:55]
    ds_read_b128 v[108:111], v176 offset:14336
    v_xor_b32 v124, s47, v116
    v_mfma_f32_16x16x32_bf16 v[52:55], v[192:195], a[84:87], v[52:55]
    s_add_u32 m0, s100, 4480
    v_bfi_b32 v209, s45, v155, v154
    v_xor_b32 v125, s47, v117
    v_mfma_f32_16x16x32_bf16 v[68:71], a[12:15], a[84:87], v[68:71]
    buffer_load_dwordx4 v165, s[4:7], 0 offen offset:640 lds
    v_bfi_b32 v210, s45, v154, v153
    v_xor_b32 v126, s47, v118
    v_mfma_f32_16x16x32_bf16 v[68:71], v[196:199], a[84:87], v[68:71]
    s_add_u32 m0, s100, 5504
    v_xor_b32 v127, s47, v119
    v_bfi_b32 v211, s45, v153, v152
    v_mfma_f32_16x16x32_bf16 v[56:59], a[8:11], v[112:115], v[56:59]
    buffer_load_dwordx4 v166, s[4:7], 0 offen offset:640 lds
    v_mfma_f32_16x16x32_bf16 v[72:75], a[12:15], v[112:115], v[72:75]
    s_add_u32 m0, s100, 6528
    v_bfi_b32 v212, s45, v163, v159
    v_bfi_b32 v213, s45, v159, v158
    v_mfma_f32_16x16x32_bf16 v[60:63], a[8:11], v[116:119], v[60:63]
    buffer_load_dwordx4 v167, s[4:7], 0 offen offset:640 lds
    v_mfma_f32_16x16x32_bf16 v[76:79], a[12:15], v[116:119], v[76:79]
    v_bfi_b32 v214, s45, v158, v157
    v_bfi_b32 v215, s45, v157, v156
    v_mfma_f32_16x16x32_bf16 v[56:59], v[192:195], v[120:123], v[56:59]
    v_mfma_f32_16x16x32_bf16 v[72:75], v[196:199], v[120:123], v[72:75]
    v_mfma_f32_16x16x32_bf16 v[60:63], v[192:195], v[124:127], v[60:63]
    v_mfma_f32_16x16x32_bf16 v[76:79], v[196:199], v[124:127], v[76:79]
    s_waitcnt lgkmcnt(4)
    s_add_u32 m0, s100, 7680
    v_mfma_f32_16x16x32_bf16 v[88:91], a[24:27], a[24:27], v[88:91]
    s_waitcnt vmcnt(14)
    ds_read_b128 v[144:147], v173 offset:20480
    v_mfma_f32_16x16x32_bf16 v[88:91], v[208:211], v[208:211], v[88:91]
    ds_read_u16 v180, v175 offset:20480
    v_mfma_f32_16x16x32_bf16 v[92:95], a[28:31], a[28:31], v[92:95]
    ds_read_b128 v[148:151], v173 offset:22528
    v_mfma_f32_16x16x32_bf16 v[92:95], v[212:215], v[212:215], v[92:95]
    ds_read_u16 v181, v175 offset:22528
    v_mfma_f32_16x16x32_bf16 v[80:83], a[24:27], v[12:15], v[80:83]
    ds_read_b128 a[32:35], v170 offset:16384
    v_mfma_f32_16x16x32_bf16 v[80:83], v[208:211], v[12:15], v[80:83]
    ds_read_b128 a[36:39], v170 offset:18432
    v_mfma_f32_16x16x32_bf16 v[84:87], a[28:31], v[12:15], v[84:87]
    v_mfma_f32_16x16x32_bf16 v[84:87], v[212:215], v[12:15], v[84:87]
    s_waitcnt lgkmcnt(6)
    v_mfma_f32_16x16x32_bf16 v[96:99], v[12:15], a[72:75], v[96:99]
    ds_read_b128 a[80:83], v177 offset:8192
    v_xor_b32 v120, s47, v104
    v_mfma_f32_16x16x32_bf16 v[100:103], v[12:15], a[76:79], v[100:103]
    buffer_load_dwordx4 v164, s[4:7], 0 offen offset:512 lds
    v_mfma_f32_16x16x32_bf16 v[48:51], a[16:19], a[72:75], v[48:51]
    ds_read_b128 a[84:87], v177 offset:10240
    v_xor_b32 v121, s47, v105
    v_mfma_f32_16x16x32_bf16 v[48:51], v[200:203], a[72:75], v[48:51]
    s_waitcnt lgkmcnt(4)
    v_xor_b32 v122, s47, v106
    v_cndmask_b32 v160, v180, v178, s[58:59]
    v_mfma_f32_16x16x32_bf16 v[64:67], a[20:23], a[72:75], v[64:67]
    ds_read_b128 v[112:115], v177 offset:12288
    v_xor_b32 v123, s47, v107
    v_mfma_f32_16x16x32_bf16 v[64:67], v[204:207], a[72:75], v[64:67]
    s_add_u32 m0, s100, 8704
    v_bfi_b32 v216, s45, v160, v147
    v_xor_b32 v124, s47, v108
    v_mfma_f32_16x16x32_bf16 v[52:55], a[16:19], a[76:79], v[52:55]
    ds_read_b128 v[116:119], v177 offset:14336
    v_bfi_b32 v217, s45, v147, v146
    v_mfma_f32_16x16x32_bf16 v[52:55], v[200:203], a[76:79], v[52:55]
    v_xor_b32 v125, s47, v109
    v_xor_b32 v126, s47, v110
    v_mfma_f32_16x16x32_bf16 v[68:71], a[20:23], a[76:79], v[68:71]
    buffer_load_dwordx4 v165, s[4:7], 0 offen offset:512 lds
    v_mfma_f32_16x16x32_bf16 v[68:71], v[204:207], a[76:79], v[68:71]
    s_add_u32 m0, s100, 9728
    v_bfi_b32 v218, s45, v146, v145
    v_xor_b32 v127, s47, v111
    v_mfma_f32_16x16x32_bf16 v[56:59], a[16:19], v[104:107], v[56:59]
    v_bfi_b32 v219, s45, v145, v144
    v_cndmask_b32 v161, v181, v179, s[58:59]
    v_mfma_f32_16x16x32_bf16 v[72:75], a[20:23], v[104:107], v[72:75]
    buffer_load_dwordx4 v166, s[4:7], 0 offen offset:512 lds
    v_mfma_f32_16x16x32_bf16 v[60:63], a[16:19], v[108:111], v[60:63]
    s_add_u32 m0, s100, 10752
    v_bfi_b32 v220, s45, v161, v151
    v_bfi_b32 v221, s45, v151, v150
    v_mfma_f32_16x16x32_bf16 v[76:79], a[20:23], v[108:111], v[76:79]
    buffer_load_dwordx4 v167, s[4:7], 0 offen offset:512 lds
    v_mfma_f32_16x16x32_bf16 v[56:59], v[200:203], v[120:123], v[56:59]
    v_bfi_b32 v222, s45, v150, v149
    v_bfi_b32 v223, s45, v149, v148
    v_mfma_f32_16x16x32_bf16 v[72:75], v[204:207], v[120:123], v[72:75]
    v_mfma_f32_16x16x32_bf16 v[60:63], v[200:203], v[124:127], v[60:63]
    v_mfma_f32_16x16x32_bf16 v[76:79], v[204:207], v[124:127], v[76:79]
    s_waitcnt lgkmcnt(4)
    v_mfma_f32_16x16x32_bf16 v[88:91], a[32:35], a[32:35], v[88:91]
    ds_read_b128 v[152:155], v172 offset:20480
    v_mfma_f32_16x16x32_bf16 v[88:91], v[216:219], v[216:219], v[88:91]
    ds_read_u16 v162, v174 offset:20480
    v_mfma_f32_16x16x32_bf16 v[92:95], a[36:39], a[36:39], v[92:95]
    ds_read_b128 v[156:159], v172 offset:22528
    v_mfma_f32_16x16x32_bf16 v[92:95], v[220:223], v[220:223], v[92:95]
    ds_read_u16 v163, v174 offset:22528
    v_mfma_f32_16x16x32_bf16 v[80:83], a[32:35], v[12:15], v[80:83]
    ds_read_b128 a[40:43], v171 offset:16384
    v_mfma_f32_16x16x32_bf16 v[80:83], v[216:219], v[12:15], v[80:83]
    ds_read_b128 a[44:47], v171 offset:18432
    v_mfma_f32_16x16x32_bf16 v[84:87], a[36:39], v[12:15], v[84:87]
    v_mfma_f32_16x16x32_bf16 v[84:87], v[220:223], v[12:15], v[84:87]
    s_waitcnt lgkmcnt(6)
    v_mfma_f32_16x16x32_bf16 v[96:99], v[12:15], a[80:83], v[96:99]
    s_waitcnt vmcnt(12)
    s_barrier
    ds_read_b128 a[72:75], v176 offset:16384
    v_mfma_f32_16x16x32_bf16 v[100:103], v[12:15], a[84:87], v[100:103]
    v_xor_b32 v120, s47, v112
    v_xor_b32 v121, s47, v113
    v_mfma_f32_16x16x32_bf16 v[48:51], a[24:27], a[80:83], v[48:51]
    ds_read_b128 a[76:79], v176 offset:18432
    s_waitcnt lgkmcnt(4)
    v_mfma_f32_16x16x32_bf16 v[48:51], v[208:211], a[80:83], v[48:51]
    v_xor_b32 v122, s47, v114
    v_bfi_b32 v224, s45, v162, v155
    v_mfma_f32_16x16x32_bf16 v[64:67], a[28:31], a[80:83], v[64:67]
    ds_read_b128 v[104:107], v176 offset:20480
    v_xor_b32 v123, s47, v115
    v_mfma_f32_16x16x32_bf16 v[64:67], v[212:215], a[80:83], v[64:67]
    v_xor_b32 v124, s47, v116
    v_bfi_b32 v225, s45, v155, v154
    v_mfma_f32_16x16x32_bf16 v[52:55], a[24:27], a[84:87], v[52:55]
    ds_read_b128 v[108:111], v176 offset:22528
    v_xor_b32 v125, s47, v117
    v_mfma_f32_16x16x32_bf16 v[52:55], v[208:211], a[84:87], v[52:55]
    v_bfi_b32 v226, s45, v154, v153
    v_xor_b32 v126, s47, v118
    v_mfma_f32_16x16x32_bf16 v[68:71], a[28:31], a[84:87], v[68:71]
    v_xor_b32 v127, s47, v119
    v_bfi_b32 v227, s45, v153, v152
    v_mfma_f32_16x16x32_bf16 v[68:71], v[212:215], a[84:87], v[68:71]
    v_bfi_b32 v228, s45, v163, v159
    v_bfi_b32 v229, s45, v159, v158
    v_mfma_f32_16x16x32_bf16 v[56:59], a[24:27], v[112:115], v[56:59]
    v_bfi_b32 v230, s45, v158, v157
    v_bfi_b32 v231, s45, v157, v156
    v_mfma_f32_16x16x32_bf16 v[72:75], a[28:31], v[112:115], v[72:75]
    v_mfma_f32_16x16x32_bf16 v[60:63], a[24:27], v[116:119], v[60:63]
    v_mfma_f32_16x16x32_bf16 v[76:79], a[28:31], v[116:119], v[76:79]
    v_mfma_f32_16x16x32_bf16 v[56:59], v[208:211], v[120:123], v[56:59]
    v_mfma_f32_16x16x32_bf16 v[72:75], v[212:215], v[120:123], v[72:75]
    v_mfma_f32_16x16x32_bf16 v[60:63], v[208:211], v[124:127], v[60:63]
    v_mfma_f32_16x16x32_bf16 v[76:79], v[212:215], v[124:127], v[76:79]
    s_waitcnt lgkmcnt(4)
    v_mfma_f32_16x16x32_bf16 v[88:91], a[40:43], a[40:43], v[88:91]
    s_waitcnt vmcnt(4)
    ds_read_b128 v[144:147], v173 offset:4096
    v_mfma_f32_16x16x32_bf16 v[88:91], v[224:227], v[224:227], v[88:91]
    ds_read_u16 v178, v175 offset:4096
    s_mul_i32 s52, s20, 9
    v_mfma_f32_16x16x32_bf16 v[92:95], a[44:47], a[44:47], v[92:95]
    ds_read_b128 v[148:151], v173 offset:6144
    s_add_u32 s52, s52, s96
    v_mfma_f32_16x16x32_bf16 v[92:95], v[228:231], v[228:231], v[92:95]
    ds_read_u16 v179, v175 offset:6144
    s_lshl_b32 s52, s52, 2
    v_mfma_f32_16x16x32_bf16 v[80:83], a[40:43], v[12:15], v[80:83]
    ds_read_b128 a[48:51], v170 offset:0
    s_add_u32 s52, s52, s23
    v_mfma_f32_16x16x32_bf16 v[80:83], v[224:227], v[12:15], v[80:83]
    ds_read_b128 a[52:55], v170 offset:2048
    s_mul_i32 s52, s52, 9216
    v_mfma_f32_16x16x32_bf16 v[84:87], a[44:47], v[12:15], v[84:87]
    s_add_u32 m0, s100, 12288
    v_mfma_f32_16x16x32_bf16 v[84:87], v[228:231], v[12:15], v[84:87]
    s_waitcnt lgkmcnt(6)
    v_mfma_f32_16x16x32_bf16 v[96:99], v[12:15], a[72:75], v[96:99]
    ds_read_b128 a[80:83], v177 offset:16384
    v_xor_b32 v120, s47, v104
    v_mfma_f32_16x16x32_bf16 v[100:103], v[12:15], a[76:79], v[100:103]
    buffer_load_dwordx4 v4, s[88:91], s52 offen offset:0 nt lds
    v_mfma_f32_16x16x32_bf16 v[48:51], a[32:35], a[72:75], v[48:51]
    ds_read_b128 a[84:87], v177 offset:18432
    v_xor_b32 v121, s47, v105
    v_mfma_f32_16x16x32_bf16 v[48:51], v[216:219], a[72:75], v[48:51]
    buffer_load_dwordx4 v4, s[88:91], s52 offen offset:1024 nt lds
    v_mfma_f32_16x16x32_bf16 v[64:67], a[36:39], a[72:75], v[64:67]
    ds_read_b128 v[112:115], v177 offset:20480
    s_waitcnt lgkmcnt(5)
    v_xor_b32 v122, s47, v106
    v_mfma_f32_16x16x32_bf16 v[64:67], v[220:223], a[72:75], v[64:67]
    v_cndmask_b32 v160, v178, v180, s[58:59]
    v_xor_b32 v123, s47, v107
    v_mfma_f32_16x16x32_bf16 v[52:55], a[32:35], a[76:79], v[52:55]
    ds_read_b128 v[116:119], v177 offset:22528
    v_bfi_b32 v232, s45, v160, v147
    v_xor_b32 v124, s47, v108
    v_mfma_f32_16x16x32_bf16 v[52:55], v[216:219], a[76:79], v[52:55]
    v_bfi_b32 v233, s45, v147, v146
    v_xor_b32 v125, s47, v109
    v_mfma_f32_16x16x32_bf16 v[68:71], a[36:39], a[76:79], v[68:71]
    v_xor_b32 v126, s47, v110
    v_bfi_b32 v234, s45, v146, v145
    v_mfma_f32_16x16x32_bf16 v[68:71], v[220:223], a[76:79], v[68:71]
    v_xor_b32 v127, s47, v111
    v_bfi_b32 v235, s45, v145, v144
    v_mfma_f32_16x16x32_bf16 v[56:59], a[32:35], v[104:107], v[56:59]
    buffer_load_dwordx4 v4, s[88:91], s52 offen offset:2048 nt lds
    v_mfma_f32_16x16x32_bf16 v[72:75], a[36:39], v[104:107], v[72:75]
    v_cndmask_b32 v161, v179, v181, s[58:59]
    v_bfi_b32 v236, s45, v161, v151
    v_mfma_f32_16x16x32_bf16 v[60:63], a[32:35], v[108:111], v[60:63]
    buffer_load_dwordx4 v4, s[88:91], s52 offen offset:3072 nt lds
    v_mfma_f32_16x16x32_bf16 v[76:79], a[36:39], v[108:111], v[76:79]
    s_add_u32 m0, s100, 16384
    v_bfi_b32 v237, s45, v151, v150
    v_bfi_b32 v238, s45, v150, v149
    v_mfma_f32_16x16x32_bf16 v[56:59], v[216:219], v[120:123], v[56:59]
    s_add_u32 s52, s52, 4096
    v_bfi_b32 v239, s45, v149, v148
    v_mfma_f32_16x16x32_bf16 v[72:75], v[220:223], v[120:123], v[72:75]
    buffer_load_dwordx4 v4, s[88:91], s52 offen offset:0 nt lds
    v_mfma_f32_16x16x32_bf16 v[60:63], v[216:219], v[124:127], v[60:63]
    buffer_load_dwordx4 v4, s[88:91], s52 offen offset:1024 nt lds
    v_mfma_f32_16x16x32_bf16 v[76:79], v[220:223], v[124:127], v[76:79]
    s_waitcnt lgkmcnt(4)
    v_mfma_f32_16x16x32_bf16 v[88:91], a[48:51], a[48:51], v[88:91]
    ds_read_b128 v[152:155], v172 offset:4096
    v_mfma_f32_16x16x32_bf16 v[88:91], v[232:235], v[232:235], v[88:91]
    ds_read_u16 v162, v174 offset:4096
    v_mfma_f32_16x16x32_bf16 v[92:95], a[52:55], a[52:55], v[92:95]
    ds_read_b128 v[156:159], v172 offset:6144
    v_mfma_f32_16x16x32_bf16 v[92:95], v[236:239], v[236:239], v[92:95]
    ds_read_u16 v163, v174 offset:6144
    v_mfma_f32_16x16x32_bf16 v[80:83], a[48:51], v[12:15], v[80:83]
    ds_read_b128 a[56:59], v171 offset:0
    v_mfma_f32_16x16x32_bf16 v[80:83], v[232:235], v[12:15], v[80:83]
    ds_read_b128 a[60:63], v171 offset:2048
    v_mfma_f32_16x16x32_bf16 v[84:87], a[52:55], v[12:15], v[84:87]
    buffer_load_dwordx4 v4, s[88:91], s52 offen offset:2048 nt lds
    v_mfma_f32_16x16x32_bf16 v[84:87], v[236:239], v[12:15], v[84:87]
    s_waitcnt lgkmcnt(6)
    v_mfma_f32_16x16x32_bf16 v[96:99], v[12:15], a[80:83], v[96:99]
    ds_read_b128 a[72:75], v176 offset:24576
    v_xor_b32 v120, s47, v112
    v_mfma_f32_16x16x32_bf16 v[100:103], v[12:15], a[84:87], v[100:103]
    buffer_load_dwordx4 v4, s[88:91], s52 offen offset:3072 nt lds
    v_mfma_f32_16x16x32_bf16 v[48:51], a[40:43], a[80:83], v[48:51]
    ds_read_b128 a[76:79], v176 offset:26624
    v_xor_b32 v121, s47, v113
    v_mfma_f32_16x16x32_bf16 v[48:51], v[224:227], a[80:83], v[48:51]
    s_waitcnt lgkmcnt(4)
    v_xor_b32 v122, s47, v114
    s_add_u32 m0, s100, 20480
    v_mfma_f32_16x16x32_bf16 v[64:67], a[44:47], a[80:83], v[64:67]
    ds_read_b128 v[104:107], v176 offset:28672
    s_add_u32 s52, s52, 4096
    v_mfma_f32_16x16x32_bf16 v[64:67], v[228:231], a[80:83], v[64:67]
    buffer_load_dwordx4 v4, s[88:91], s52 offen offset:0 nt lds
    v_bfi_b32 v240, s45, v162, v155
    v_xor_b32 v123, s47, v115
    v_mfma_f32_16x16x32_bf16 v[52:55], a[40:43], a[84:87], v[52:55]
    ds_read_b128 v[108:111], v176 offset:30720
    v_xor_b32 v124, s47, v116
    v_mfma_f32_16x16x32_bf16 v[52:55], v[224:227], a[84:87], v[52:55]
    v_bfi_b32 v241, s45, v155, v154
    v_xor_b32 v125, s47, v117
    v_mfma_f32_16x16x32_bf16 v[68:71], a[44:47], a[84:87], v[68:71]
    v_bfi_b32 v242, s45, v154, v153
    v_xor_b32 v126, s47, v118
    v_mfma_f32_16x16x32_bf16 v[68:71], v[228:231], a[84:87], v[68:71]
    v_xor_b32 v127, s47, v119
    v_bfi_b32 v243, s45, v153, v152
    v_mfma_f32_16x16x32_bf16 v[56:59], a[40:43], v[112:115], v[56:59]
    v_bfi_b32 v244, s45, v163, v159
    v_bfi_b32 v245, s45, v159, v158
    v_mfma_f32_16x16x32_bf16 v[72:75], a[44:47], v[112:115], v[72:75]
    v_bfi_b32 v246, s45, v158, v157
    v_bfi_b32 v247, s45, v157, v156
    v_mfma_f32_16x16x32_bf16 v[60:63], a[40:43], v[116:119], v[60:63]
    v_mfma_f32_16x16x32_bf16 v[76:79], a[44:47], v[116:119], v[76:79]
    v_mfma_f32_16x16x32_bf16 v[56:59], v[224:227], v[120:123], v[56:59]
    v_mfma_f32_16x16x32_bf16 v[72:75], v[228:231], v[120:123], v[72:75]
    v_mfma_f32_16x16x32_bf16 v[60:63], v[224:227], v[124:127], v[60:63]
    v_mfma_f32_16x16x32_bf16 v[76:79], v[228:231], v[124:127], v[76:79]
    s_waitcnt lgkmcnt(4)
    v_mfma_f32_16x16x32_bf16 v[88:91], a[56:59], a[56:59], v[88:91]
    s_waitcnt vmcnt(9)
    ds_read_b128 v[144:147], v173 offset:8192
    v_mfma_f32_16x16x32_bf16 v[88:91], v[240:243], v[240:243], v[88:91]
    ds_read_u16 v180, v175 offset:8192
    v_mfma_f32_16x16x32_bf16 v[92:95], a[60:63], a[60:63], v[92:95]
    ds_read_b128 v[148:151], v173 offset:10240
    v_mfma_f32_16x16x32_bf16 v[92:95], v[244:247], v[244:247], v[92:95]
    ds_read_u16 v181, v175 offset:10240
    v_mfma_f32_16x16x32_bf16 v[80:83], a[56:59], v[12:15], v[80:83]
    ds_read_b128 a[64:67], v170 offset:8192
    v_mfma_f32_16x16x32_bf16 v[80:83], v[240:243], v[12:15], v[80:83]
    ds_read_b128 a[68:71], v170 offset:10240
    v_mfma_f32_16x16x32_bf16 v[84:87], a[60:63], v[12:15], v[84:87]
    v_mfma_f32_16x16x32_bf16 v[84:87], v[244:247], v[12:15], v[84:87]
    s_waitcnt lgkmcnt(6)
    v_mfma_f32_16x16x32_bf16 v[96:99], v[12:15], a[72:75], v[96:99]
    ds_read_b128 a[80:83], v177 offset:24576
    v_xor_b32 v120, s47, v104
    v_mfma_f32_16x16x32_bf16 v[100:103], v[12:15], a[76:79], v[100:103]
    v_xor_b32 v121, s47, v105
    v_xor_b32 v122, s47, v106
    v_mfma_f32_16x16x32_bf16 v[48:51], a[48:51], a[72:75], v[48:51]
    ds_read_b128 a[84:87], v177 offset:26624
    s_waitcnt lgkmcnt(4)
    v_mfma_f32_16x16x32_bf16 v[48:51], v[232:235], a[72:75], v[48:51]
    v_cndmask_b32 v160, v180, v178, s[58:59]
    v_xor_b32 v123, s47, v107
    v_mfma_f32_16x16x32_bf16 v[64:67], a[52:55], a[72:75], v[64:67]
    ds_read_b128 v[112:115], v177 offset:28672
    v_bfi_b32 v248, s45, v160, v147
    v_mfma_f32_16x16x32_bf16 v[64:67], v[236:239], a[72:75], v[64:67]
    v_xor_b32 v124, s47, v108
    v_bfi_b32 v249, s45, v147, v146
    v_mfma_f32_16x16x32_bf16 v[52:55], a[48:51], a[76:79], v[52:55]
    ds_read_b128 v[116:119], v177 offset:30720
    v_xor_b32 v125, s47, v109
    v_mfma_f32_16x16x32_bf16 v[52:55], v[232:235], a[76:79], v[52:55]
    v_xor_b32 v126, s47, v110
    v_bfi_b32 v250, s45, v146, v145
    v_mfma_f32_16x16x32_bf16 v[68:71], a[52:55], a[76:79], v[68:71]
    v_xor_b32 v127, s47, v111
    v_bfi_b32 v251, s45, v145, v144
    v_mfma_f32_16x16x32_bf16 v[68:71], v[236:239], a[76:79], v[68:71]
    v_cndmask_b32 v161, v181, v179, s[58:59]
    v_bfi_b32 v252, s45, v161, v151
    v_mfma_f32_16x16x32_bf16 v[56:59], a[48:51], v[104:107], v[56:59]
    v_bfi_b32 v253, s45, v151, v150
    v_bfi_b32 v254, s45, v150, v149
    v_mfma_f32_16x16x32_bf16 v[72:75], a[52:55], v[104:107], v[72:75]
    v_bfi_b32 v255, s45, v149, v148
    v_mfma_f32_16x16x32_bf16 v[60:63], a[48:51], v[108:111], v[60:63]
    v_mfma_f32_16x16x32_bf16 v[76:79], a[52:55], v[108:111], v[76:79]
    v_mfma_f32_16x16x32_bf16 v[56:59], v[232:235], v[120:123], v[56:59]
    v_mfma_f32_16x16x32_bf16 v[72:75], v[236:239], v[120:123], v[72:75]
    v_mfma_f32_16x16x32_bf16 v[60:63], v[232:235], v[124:127], v[60:63]
    v_mfma_f32_16x16x32_bf16 v[76:79], v[236:239], v[124:127], v[76:79]
    s_waitcnt lgkmcnt(4)
    v_mfma_f32_16x16x32_bf16 v[88:91], a[64:67], a[64:67], v[88:91]
    v_mfma_f32_16x16x32_bf16 v[88:91], v[248:251], v[248:251], v[88:91]
    v_mfma_f32_16x16x32_bf16 v[92:95], a[68:71], a[68:71], v[92:95]
    ds_read_b128 a[72:75], v176 offset:32768
    v_mfma_f32_16x16x32_bf16 v[92:95], v[252:255], v[252:255], v[92:95]
    v_mfma_f32_16x16x32_bf16 v[80:83], a[64:67], v[12:15], v[80:83]
    ds_read_b128 a[76:79], v176 offset:34816
    v_mfma_f32_16x16x32_bf16 v[80:83], v[248:251], v[12:15], v[80:83]
    v_mfma_f32_16x16x32_bf16 v[84:87], a[68:71], v[12:15], v[84:87]
    ds_read_b128 v[104:107], v176 offset:36864
    v_mfma_f32_16x16x32_bf16 v[84:87], v[252:255], v[12:15], v[84:87]
    s_waitcnt lgkmcnt(3)
    v_mfma_f32_16x16x32_bf16 v[96:99], v[12:15], a[80:83], v[96:99]
    ds_read_b128 v[108:111], v176 offset:38912
    v_xor_b32 v120, s47, v112
    v_mfma_f32_16x16x32_bf16 v[100:103], v[12:15], a[84:87], v[100:103]
    ds_bpermute_b32 v128, v7, v88 offset:0
    v_xor_b32 v121, s47, v113
    v_mfma_f32_16x16x32_bf16 v[48:51], a[56:59], a[80:83], v[48:51]
    v_xor_b32 v122, s47, v114
    v_xor_b32 v123, s47, v115
    v_mfma_f32_16x16x32_bf16 v[48:51], v[240:243], a[80:83], v[48:51]
    s_mov_b32 s44, 0x3ae38e39
    ds_bpermute_b32 v129, v7, v89 offset:4
    v_mfma_f32_16x16x32_bf16 v[64:67], a[60:63], a[80:83], v[64:67]
    v_xor_b32 v124, s47, v116
    v_xor_b32 v125, s47, v117
    v_mfma_f32_16x16x32_bf16 v[64:67], v[244:247], a[80:83], v[64:67]
    ds_bpermute_b32 v130, v7, v90 offset:8
    v_xor_b32 v126, s47, v118
    v_mfma_f32_16x16x32_bf16 v[52:55], a[56:59], a[84:87], v[52:55]
    v_xor_b32 v127, s47, v119
    v_mov_b32 v11, 0x3727c5ac
    v_mfma_f32_16x16x32_bf16 v[52:55], v[240:243], a[84:87], v[52:55]
    ds_bpermute_b32 v131, v7, v91 offset:12
    v_mul_f32 v80, s44, v80
    v_mfma_f32_16x16x32_bf16 v[68:71], a[60:63], a[84:87], v[68:71]
    v_mul_f32 v81, s44, v81
    v_mul_f32 v82, s44, v82
    v_mfma_f32_16x16x32_bf16 v[68:71], v[244:247], a[84:87], v[68:71]
    ds_bpermute_b32 v132, v7, v92 offset:0
    v_mul_f32 v83, s44, v83
    v_mfma_f32_16x16x32_bf16 v[56:59], a[56:59], v[112:115], v[56:59]
    v_mul_f32 v84, s44, v84
    v_mul_f32 v85, s44, v85
    v_mfma_f32_16x16x32_bf16 v[72:75], a[60:63], v[112:115], v[72:75]
    ds_bpermute_b32 v133, v7, v93 offset:4
    v_mul_f32 v86, s44, v86
    v_mfma_f32_16x16x32_bf16 v[60:63], a[56:59], v[116:119], v[60:63]
    v_mul_f32 v87, s44, v87
    v_fma_f32 v136, -v80, v80, v11
    v_mfma_f32_16x16x32_bf16 v[76:79], a[60:63], v[116:119], v[76:79]
    ds_bpermute_b32 v134, v7, v94 offset:8
    v_fma_f32 v137, -v81, v81, v11
    v_mfma_f32_16x16x32_bf16 v[56:59], v[240:243], v[120:123], v[56:59]
    v_fma_f32 v138, -v82, v82, v11
    v_fma_f32 v139, -v83, v83, v11
    v_mfma_f32_16x16x32_bf16 v[72:75], v[244:247], v[120:123], v[72:75]
    ds_bpermute_b32 v135, v7, v95 offset:12
    v_fma_f32 v140, -v84, v84, v11
    v_mfma_f32_16x16x32_bf16 v[60:63], v[240:243], v[124:127], v[60:63]
    v_fma_f32 v141, -v85, v85, v11
    v_fma_f32 v142, -v86, v86, v11
    v_mfma_f32_16x16x32_bf16 v[76:79], v[244:247], v[124:127], v[76:79]
    s_waitcnt lgkmcnt(8)
    v_fma_f32 v143, -v87, v87, v11
    v_mfma_f32_16x16x32_bf16 v[96:99], v[12:15], a[72:75], v[96:99]
    v_xor_b32 v120, s47, v104
    v_xor_b32 v121, s47, v105
    v_mfma_f32_16x16x32_bf16 v[100:103], v[12:15], a[76:79], v[100:103]
    s_waitcnt lgkmcnt(0)
    v_xor_b32 v122, s47, v106
    v_xor_b32 v123, s47, v107
    v_mfma_f32_16x16x32_bf16 v[48:51], a[64:67], a[72:75], v[48:51]
    v_xor_b32 v124, s47, v108
    v_xor_b32 v125, s47, v109
    v_mfma_f32_16x16x32_bf16 v[48:51], v[248:251], a[72:75], v[48:51]
    v_xor_b32 v126, s47, v110
    v_xor_b32 v127, s47, v111
    v_mfma_f32_16x16x32_bf16 v[64:67], a[68:71], a[72:75], v[64:67]
    v_fma_f32 v128, v128, s44, v136
    v_max_f32 v128, v128, v11
    v_mfma_f32_16x16x32_bf16 v[64:67], v[252:255], a[72:75], v[64:67]
    v_rsq_f32 v128, v128
    v_mfma_f32_16x16x32_bf16 v[52:55], a[64:67], a[76:79], v[52:55]
    v_fma_f32 v129, v129, s44, v137
    v_max_f32 v129, v129, v11
    v_mfma_f32_16x16x32_bf16 v[52:55], v[248:251], a[76:79], v[52:55]
    v_rsq_f32 v129, v129
    v_mfma_f32_16x16x32_bf16 v[68:71], a[68:71], a[76:79], v[68:71]
    v_fma_f32 v130, v130, s44, v138
    v_max_f32 v130, v130, v11
    v_mfma_f32_16x16x32_bf16 v[68:71], v[252:255], a[76:79], v[68:71]
    v_rsq_f32 v130, v130
    v_mfma_f32_16x16x32_bf16 v[56:59], a[64:67], v[104:107], v[56:59]
    v_fma_f32 v131, v131, s44, v139
    v_max_f32 v131, v131, v11
    v_mfma_f32_16x16x32_bf16 v[72:75], a[68:71], v[104:107], v[72:75]
    v_rsq_f32 v131, v131
    v_mfma_f32_16x16x32_bf16 v[60:63], a[64:67], v[108:111], v[60:63]
    v_fma_f32 v132, v132, s44, v140
    v_max_f32 v132, v132, v11
    v_mfma_f32_16x16x32_bf16 v[76:79], a[68:71], v[108:111], v[76:79]
    v_rsq_f32 v132, v132
    v_mfma_f32_16x16x32_bf16 v[56:59], v[248:251], v[120:123], v[56:59]
    v_fma_f32 v133, v133, s44, v141
    v_max_f32 v133, v133, v11
    v_fma_f32 v96, v96, 2.0, -v10
    v_mfma_f32_16x16x32_bf16 v[72:75], v[252:255], v[120:123], v[72:75]
    v_rsq_f32 v133, v133
    v_mfma_f32_16x16x32_bf16 v[60:63], v[248:251], v[124:127], v[60:63]
    v_fma_f32 v97, v100, 2.0, -v10
    v_mul_f32 v144, v128, v48
    v_mfma_f32_16x16x32_bf16 v[76:79], v[252:255], v[124:127], v[76:79]
    v_mul_f32 v145, v129, v49
    v_mul_f32 v146, v130, v50
    v_mul_f32 v147, v131, v51
    v_fma_f32 v144, v132, v64, v144
    v_fma_f32 v145, v133, v65, v145
    v_fma_f32 v134, v134, s44, v142
    v_max_f32 v134, v134, v11
    v_rsq_f32 v134, v134
    s_nop 0
    v_fma_f32 v146, v134, v66, v146
    v_fma_f32 v135, v135, s44, v143
    v_mul_f32 v148, v128, v52
    v_mul_f32 v149, v129, v53
    v_mul_f32 v150, v130, v54
    v_mul_f32 v151, v131, v55
    v_max_f32 v135, v135, v11
    v_rsq_f32 v135, v135
    s_nop 0
    v_fma_f32 v147, v135, v67, v147
    v_fma_f32 v148, v132, v68, v148
    v_mul_f32 v88, v80, v128
    v_fma_f32 v149, v133, v69, v149
    v_mul_f32 v89, v81, v129
    v_mul_f32 v90, v82, v130
    v_fma_f32 v150, v134, v70, v150
    v_mul_f32 v91, v83, v131
    v_fma_f32 v151, v135, v71, v151
    v_mul_f32 v92, v84, v132
    v_mul_f32 v93, v85, v133
    v_mul_f32 v94, v86, v134
    v_mul_f32 v95, v87, v135
    v_add_f32 v136, v88, v92
    v_fma_f32 v144, -v136, v96, v144
    v_fma_f32 v148, -v136, v97, v148
    v_add_f32 v137, v89, v93
    v_fma_f32 v145, -v137, v96, v145
    v_fma_f32 v149, -v137, v97, v149
    v_add_f32 v138, v90, v94
    v_fma_f32 v146, -v138, v96, v146
    v_fma_f32 v150, -v138, v97, v150
    v_add_f32 v139, v91, v95
    v_fma_f32 v147, -v139, v96, v147
    v_fma_f32 v151, -v139, v97, v151
    buffer_load_dword v183, off, s[92:95], 0 sc1
    s_cmp_lg_u32 s23, 0
    s_cselect_b32 s100, 2, 0
tail_5:
    s_nop 4
    v_mul_f32 v152, v128, v56
    v_mul_f32 v153, v129, v57
    v_mul_f32 v154, v130, v58
    v_mul_f32 v155, v131, v59
    v_fma_f32 v152, -v132, v72, v152
    v_fma_f32 v153, -v133, v73, v153
    v_fma_f32 v154, -v134, v74, v154
    v_fma_f32 v155, -v135, v75, v155
    v_mul_f32 v156, v128, v60
    v_mul_f32 v157, v129, v61
    v_mul_f32 v158, v130, v62
    v_mul_f32 v159, v131, v63
    v_fma_f32 v156, -v132, v76, v156
    v_fma_f32 v157, -v133, v77, v157
    v_fma_f32 v158, -v134, v78, v158
    v_fma_f32 v159, -v135, v79, v159
    s_add_u32 s44, s20, s23
    s_cmp_lg_u32 s44, 0
    s_cbranch_scc0 nps_11_do
nps_11:
    v_cvt_pk_bf16_f32 v144, v144, v145
    v_cvt_pk_bf16_f32 v145, v146, v147
    ds_write_b64 v9, v[144:145] offset:0
    v_cvt_pk_bf16_f32 v148, v148, v149
    v_cvt_pk_bf16_f32 v149, v150, v151
    ds_write_b64 v9, v[148:149] offset:2304
    v_cvt_pk_bf16_f32 v152, v152, v153
    v_cvt_pk_bf16_f32 v153, v154, v155
    ds_write_b64 v9, v[152:153] offset:4608
    v_cvt_pk_bf16_f32 v156, v156, v157
    v_cvt_pk_bf16_f32 v157, v158, v159
    ds_write_b64 v9, v[156:157] offset:6912
    s_cmp_lg_u32 s96, 0
    s_cbranch_scc0 mean_12_do
mean_12:
    v_mov_b32 v7, 160768
    v_lshl_add_u32 v7, v2, 4, v7
    s_waitcnt lgkmcnt(0)
    s_barrier
    ds_read_b128 a[108:111], v8 offset:0
    ds_read_b128 a[116:119], v8 offset:2304
    ds_read_b128 a[112:115], v8 offset:64
    ds_read_b128 a[120:123], v8 offset:2368
    ds_read_b128 a[124:127], v8 offset:4608
    ds_read_b128 a[132:135], v8 offset:6912
    ds_read_b128 a[128:131], v8 offset:4672
    ds_read_b128 a[136:139], v8 offset:6976
    ds_read_b128 v[104:107], v7 offset:0
    ds_read_b128 v[108:111], v7 offset:64
    ds_read_b128 v[112:115], v7 offset:128
    v_mov_b32 v98, 147456
    v_lshl_add_u32 v98, v3, 3, v98
    ds_write_b64 v98, v[96:97]
    s_and_b32 s41, s20, 2
    v_xor_b32 v120, s41, v2
    s_and_b32 s41, s20, 1
    s_lshl_b32 s41, s41, 1
    v_xor_b32 v121, s41, v3
    v_and_b32 v121, 3, v121
    v_lshl_add_u32 v120, v120, 2, v121
    v_lshlrev_b32 v120, 4, v120
    v_lshrrev_b32 v121, 2, v3
    s_mov_b32 s41, 73728
    v_mad_u32_u24 v120, v121, s41, v120
    v_xor_b32 v121, 16, v120
    s_waitcnt lgkmcnt(11)
    v_mfma_f32_16x16x32_bf16 v[48:51], a[108:111], v[16:19], 0
    s_mul_i32 s41, s23, 294912
    v_mfma_f32_16x16x32_bf16 v[56:59], a[108:111], v[32:35], 0
    s_lshl_b32 s42, s96, 13
    s_waitcnt lgkmcnt(10)
    v_mfma_f32_16x16x32_bf16 v[52:55], a[116:119], v[16:19], 0
    s_add_u32 s41, s41, s42
    v_mfma_f32_16x16x32_bf16 v[60:63], a[116:119], v[32:35], 0
    s_lshl_b32 s42, s20, 9
    s_waitcnt lgkmcnt(9)
    v_mfma_f32_16x16x32_bf16 v[48:51], a[112:115], v[20:23], v[48:51]
    s_add_u32 s41, s41, s42
    v_mfma_f32_16x16x32_bf16 v[56:59], a[112:115], v[36:39], v[56:59]
    s_add_u32 s41, s41, s97
    s_waitcnt lgkmcnt(8)
    v_mfma_f32_16x16x32_bf16 v[52:55], a[120:123], v[20:23], v[52:55]
    s_lshl_b32 s43, s20, 2
    v_mfma_f32_16x16x32_bf16 v[60:63], a[120:123], v[36:39], v[60:63]
    s_add_u32 s43, s43, s23
    s_waitcnt lgkmcnt(7)
    v_mfma_f32_16x16x32_bf16 v[48:51], a[124:127], v[24:27], v[48:51]
    s_lshl_b32 s42, s43, 6
    v_mfma_f32_16x16x32_bf16 v[56:59], a[124:127], v[40:43], v[56:59]
    s_add_u32 s42, s42, s97
    s_waitcnt lgkmcnt(6)
    v_mfma_f32_16x16x32_bf16 v[52:55], a[132:135], v[24:27], v[52:55]
    s_add_u32 s42, s42, 1179648
    v_mfma_f32_16x16x32_bf16 v[60:63], a[132:135], v[40:43], v[60:63]
    s_lshl_b32 s43, s43, 7
    s_waitcnt lgkmcnt(5)
    v_mfma_f32_16x16x32_bf16 v[48:51], a[128:131], v[28:31], v[48:51]
    s_add_u32 s43, s43, s97
    v_mfma_f32_16x16x32_bf16 v[56:59], a[128:131], v[44:47], v[56:59]
    s_add_u32 s43, s43, 1183744
    s_waitcnt lgkmcnt(4)
    v_mfma_f32_16x16x32_bf16 v[52:55], a[136:139], v[28:31], v[52:55]
    v_lshlrev_b32 v8, 2, v3
    v_mfma_f32_16x16x32_bf16 v[60:63], a[136:139], v[44:47], v[60:63]
    v_lshlrev_b32 v9, 4, v2
    s_waitcnt lgkmcnt(1)
    v_mfma_f32_16x16x32_bf16 v[64:67], v[104:107], v[16:19], 0
    v_mfma_f32_16x16x32_bf16 v[68:71], v[104:107], v[32:35], 0
    v_mfma_f32_16x16x32_bf16 v[64:67], v[108:111], v[20:23], v[64:67]
    v_cvt_pk_bf16_f32 v144, v48, v49
    v_cvt_pk_bf16_f32 v145, v50, v51
    v_cvt_pk_bf16_f32 v146, v52, v53
    v_cvt_pk_bf16_f32 v147, v54, v55
    v_mfma_f32_16x16x32_bf16 v[68:71], v[108:111], v[36:39], v[68:71]
    buffer_store_dwordx4 v[144:147], v120, s[12:15], s41 offen offset:0 sc1
    v_cvt_pk_bf16_f32 v148, v56, v57
    v_cvt_pk_bf16_f32 v149, v58, v59
    v_cvt_pk_bf16_f32 v150, v60, v61
    v_cvt_pk_bf16_f32 v151, v62, v63
    v_mfma_f32_16x16x32_bf16 v[64:67], v[112:115], v[24:27], v[64:67]
    buffer_store_dwordx4 v[148:151], v121, s[12:15], s41 offen offset:256 sc1
    s_cmp_gt_u32 s96, 1
    s_cbranch_scc1 done_14
    s_cmp_eq_u32 s96, 1
    s_cbranch_scc1 s1_13
    s_nop 2
    v_cvt_pk_bf16_f32 v7, v64, v68
    s_mov_b64 exec, 0xffff
    buffer_store_dword v7, v8, s[12:15], s42 offen sc1
    s_mov_b64 exec, -1
    s_branch done_14
s1_13:
    s_mov_b32 exec_lo, 0x00010001
    s_mov_b32 exec_hi, 0x00010001
    buffer_store_dwordx4 v[80:83], v9, s[12:15], s43 offen offset:0 sc1
    buffer_store_dwordx4 v[84:87], v9, s[12:15], s43 offen offset:64 sc1
    s_mov_b64 exec, -1
done_14:
    s_mov_b32 s101, s98
    s_branch wait_4
nps_11_do:
    v_cmp_eq_u32 vcc, 0, v2
    v_mul_f32 v120, v128, v48
    v_fma_f32 v120, -v88, v96, v120
    v_cndmask_b32 v144, v144, v120, vcc
    v_mul_f32 v120, v132, v64
    v_fma_f32 v120, -v92, v96, v120
    v_cndmask_b32 v152, v152, v120, vcc
    v_mul_f32 v120, v128, v52
    v_fma_f32 v120, -v88, v97, v120
    v_cndmask_b32 v148, v148, v120, vcc
    v_mul_f32 v120, v132, v68
    v_fma_f32 v120, -v92, v97, v120
    v_cndmask_b32 v156, v156, v120, vcc
    s_branch nps_11
mean_12_do:
    v_accvgpr_read_b32 v104, a92
    v_accvgpr_read_b32 v105, a93
    v_accvgpr_read_b32 v106, a94
    v_accvgpr_read_b32 v107, a95
    v_accvgpr_read_b32 v108, a96
    v_accvgpr_read_b32 v109, a97
    v_accvgpr_read_b32 v110, a98
    v_accvgpr_read_b32 v111, a99
    v_or_b32 v7, s44, v2
    v_cmp_eq_u32 vcc, 0, v7
    v_fma_f32 v112, -v108, v132, v92
    v_fma_f32 v104, -v104, v128, v136
    v_fma_f32 v105, -v105, v129, v137
    v_fma_f32 v106, -v106, v130, v138
    v_fma_f32 v107, -v107, v131, v139
    v_cndmask_b32 v112, 0, v112, vcc
    v_fma_f32 v104, -v108, v132, v104
    v_fma_f32 v105, -v109, v133, v105
    v_fma_f32 v106, -v110, v134, v106
    v_fma_f32 v107, -v111, v135, v107
    s_lshl_b32 s41, s23, 5
    s_add_u32 s41, s41, 160768
    v_lshl_add_u32 v7, v2, 3, s41
    v_sub_f32 v104, v104, v112
    v_cvt_pk_bf16_f32 v104, v104, v105
    v_cvt_pk_bf16_f32 v105, v106, v107
    v_cvt_pk_bf16_f32 v106, v112, 0
    v_mov_b32 v107, 0
    ds_write_b64 v7, v[104:105] offset:0
    ds_write_b64 v7, v[106:107] offset:128
    s_branch mean_12
wait_4:
    s_and_b32 s44, s23, 2
    s_add_u32 s45, s44, 1
    s_add_u32 s43, s20, s44
    s_cmp_lg_u32 s43, 0
    s_cselect_b32 s44, s44, s23
    s_cselect_b32 s45, s45, s23
    s_lshl_b32 s43, s23, 11
    s_mul_i32 s42, s20, 73728
    s_add_u32 s42, s42, s43
    s_add_u32 s42, s42, s97
    s_add_u32 s43, s43, 73728
    v_lshrrev_b32 v52, 2, v0
    v_lshlrev_b32 v52, 8, v52
    v_and_b32 v53, 1, v0
    v_lshl_add_u32 v52, v53, 3, v52
    v_bfe_u32 v53, v0, 1, 1
    v_lshl_add_u32 v52, v53, 6, v52
    v_and_b32 v53, 1, v2
    v_lshl_add_u32 v52, v53, 7, v52
    v_add_u32 v52, 81920, v52
    v_bfe_u32 v53, v0, 2, 2
    v_xor_b32 v54, s44, v53
    v_lshl_add_u32 v12, v54, 4, v52
    v_xor_b32 v13, 0x80, v12
    v_xor_b32 v54, s45, v53
    v_lshl_add_u32 v14, v54, 4, v52
    v_xor_b32 v15, 0x80, v14
    v_add_u32 v40, -8192, v12
    v_add_u32 v41, -8192, v13
    v_add_u32 v42, -8192, v14
    v_add_u32 v43, -8192, v15
    v_mov_b32 v96, 0
    v_mov_b32 v97, 0
    v_mov_b32 v100, 0
    v_mov_b32 v101, 0
    v_and_b32 v52, 1, v3
    v_lshlrev_b32 v52, 4, v52
    v_mov_b32 v53, 0x3f80
    v_lshlrev_b32 v52, v52, v53
    v_lshrrev_b32 v53, 1, v3
    v_lshlrev_b32 v54, 1, v2
    v_sub_u32 v53, v53, v54
    v_cmp_eq_u32 vcc, 0, v53
    s_nop 1
    v_cndmask_b32 v98, 0, v52, vcc
    v_cmp_eq_u32 vcc, 1, v53
    s_nop 1
    v_cndmask_b32 v99, 0, v52, vcc
    v_add_u32 v52, s25, v3
    v_lshlrev_b32 v53, 6, v52
    v_add_u32 v53, s24, v53
    v_cmp_eq_u32 s[56:57], 0, v53
    v_sub_u32 v53, 0x800, v53
    v_lshrrev_b32 v53, 6, v53
    v_cndmask_b32 v53, v53, 16, s[56:57]
    v_cmp_eq_u32 vcc, 0, v2
    v_cvt_f32_u32 v54, v2
    v_add_f32 v54, v54, v54
    v_cvt_f32_u32 v62, v52
    v_mul_f32 v62, 0x3d000000, v62
    v_cvt_f32_u32 v63, v53
    v_mul_f32 v63, 0x3d000000, v63
    v_mul_f32 v55, v54, v62
    v_mul_f32 v56, v54, v63
    v_sin_f32 v59, v55
    v_sin_f32 v60, v56
    v_cos_f32 v57, v55
    v_cos_f32 v58, v56
    v_lshlrev_b32 v61, 31, v52
    v_or_b32 v61, 1.0, v61
    v_cndmask_b32 v59, v59, v61, vcc
    v_lshlrev_b32 v61, 31, v53
    v_or_b32 v61, 1.0, v61
    v_cndmask_b32 v60, v60, v61, vcc
    v_cvt_pk_bf16_f32 v84, v57, v59
    v_cvt_pk_bf16_f32 v92, v58, v60
    v_add_f32 v54, 1.0, v54
    v_mul_f32 v55, v54, v62
    v_mul_f32 v56, v54, v63
    v_sin_f32 v59, v55
    v_sin_f32 v60, v56
    v_cos_f32 v57, v55
    v_cos_f32 v58, v56
    v_cvt_pk_bf16_f32 v85, v57, v59
    v_cvt_pk_bf16_f32 v93, v58, v60
    v_add_f32 v54, 0x40e00000, v54
    v_mul_f32 v55, v54, v62
    v_mul_f32 v56, v54, v63
    v_sin_f32 v59, v55
    v_sin_f32 v60, v56
    v_cos_f32 v57, v55
    v_cos_f32 v58, v56
    s_cmp_eq_u32 s101, 0
    s_cbranch_scc1 noarr_15
    s_waitcnt vmcnt(0) lgkmcnt(0)
    s_barrier
    s_cmp_lg_u32 s23, 0
    s_cbranch_scc1 noarr_15
    v_cmp_gt_u32 vcc, 1, v183
    s_cbranch_vccz clean_16
    s_mov_b32 s40, 0
spin_17:
    buffer_load_dword v11, off, s[92:95], 0 sc1
    s_add_u32 s40, s40, 1
    s_waitcnt vmcnt(0)
    v_cmp_gt_u32 vcc, 1, v11
    s_cbranch_vccz spin_17_x
    s_cmp_lt_u32 s40, 2097152
    s_cbranch_scc1 spin_17
spin_17_x:
clean_16:
    s_and_b32 s40, s20, 7
    s_lshl_b32 s40, s40, 8
    s_add_u32 s40, s40, s101
    v_mov_b32 v183, 1
    s_mov_b64 exec, 1
    buffer_atomic_add v183, off, s[12:15], s40 sc0 sc1
    s_mov_b64 exec, -1
noarr_15:
    v_cvt_pk_bf16_f32 v86, v57, v59
    v_cvt_pk_bf16_f32 v94, v58, v60
    v_add_f32 v54, 1.0, v54
    v_mul_f32 v55, v54, v62
    v_mul_f32 v56, v54, v63
    v_sin_f32 v59, v55
    v_sin_f32 v60, v56
    v_cos_f32 v57, v55
    v_cos_f32 v58, v56
    v_cvt_pk_bf16_f32 v87, v57, v59
    v_cvt_pk_bf16_f32 v95, v58, v60
    v_cndmask_b32 v88, v92, v84, s[56:57]
    v_cndmask_b32 v104, v84, v92, s[56:57]
    v_cndmask_b32 v89, v93, v85, s[56:57]
    v_cndmask_b32 v105, v85, v93, s[56:57]
    v_cndmask_b32 v90, v94, v86, s[56:57]
    v_cndmask_b32 v106, v86, v94, s[56:57]
    v_cndmask_b32 v91, v95, v87, s[56:57]
    v_cndmask_b32 v107, v87, v95, s[56:57]
    v_cmp_eq_u32 s[58:59], 0, v3
    s_mul_i32 s41, s23, 3072
    s_add_u32 s41, s41, 151552
    v_add_u32 v1, s41, v4
    v_add_u32 v5, 0x10000, v4
    v_add_u32 v6, 0x20000, v4
    s_lshl_b32 s55, s3, 15
    s_add_u32 s55, s55, 16777216
    s_lshl_b32 s41, s21, 2
    s_add_u32 s41, s41, s22
    s_mul_i32 s26, s41, 995328
    s_cmp_eq_u32 s101, 0
    s_cbranch_scc1 norel_18
    s_cmp_lg_u32 s23, 0
    s_cbranch_scc1 norel_18
    s_cmp_eq_u32 s96, 9
    s_cselect_b32 vcc_lo, 13, 17
    s_cselect_b32 vcc_hi, 10, 4
    s_lshl_b32 vcc_hi, vcc_hi, 10
    s_add_u32 s101, s101, vcc_hi
    s_and_b32 vcc_hi, s20, 7
    s_lshl_b32 vcc_hi, vcc_hi, 7
    s_add_u32 s101, s101, vcc_hi
    v_mov_b32 v10, 1
    v_lshlrev_b32 v9, 10, v0
    s_waitcnt vmcnt(0)
    v_readfirstlane_b32 s40, v183
    s_nop 0
    s_cmp_lg_u32 s40, vcc_lo
    s_cbranch_scc1 norel_18
    s_mov_b64 exec, 0xff
    buffer_store_dword v10, v9, s[12:15], s101 offen sc1
    s_mov_b64 exec, -1
norel_18:
    s_mul_i32 s27, s23, 9216
    s_add_u32 s26, s26, s27
    s_sub_u32 s26, s26, 28672
    s_lshl_b32 s41, s20, 2
    s_add_u32 s52, s41, s21
    s_lshl_b32 s52, s52, 2
    s_add_u32 s52, s52, s23
    s_lshl_b32 s32, s52, 6
    s_add_u32 s32, s32, s55
    s_lshl_b32 s54, s52, 2
    s_add_u32 s53, s22, 0
    s_and_b32 s53, s53, 3
    s_add_u32 s53, s53, s54
    s_mul_i32 s53, s53, 18432
    s_add_u32 s28, s53, 37748736
    s_add_u32 s53, s22, 1
    s_and_b32 s53, s53, 3
    s_add_u32 s53, s53, s54
    s_mul_i32 s53, s53, 18432
    s_add_u32 s29, s53, 37748736
    s_add_u32 s53, s22, 2
    s_and_b32 s53, s53, 3
    s_add_u32 s53, s53, s54
    s_mul_i32 s53, s53, 18432
    s_add_u32 s30, s53, 37748736
    s_add_u32 s53, s22, 3
    s_and_b32 s53, s53, 3
    s_add_u32 s53, s53, s54
    s_mul_i32 s53, s53, 18432
    s_add_u32 s31, s53, 37748736
    s_add_u32 s41, s41, s22
    s_lshl_b32 s41, s41, 2
    s_add_u32 s52, s41, s23
    s_lshl_b32 s33, s52, 6
    s_add_u32 s33, s33, s55
    s_add_u32 s33, s33, 16384
    s_lshl_b32 s39, s52, 12
    s_add_u32 s39, s39, 35651584
    s_add_u32 s53, s21, 1
    s_and_b32 s53, s53, 3
    s_add_u32 s53, s53, s41
    s_lshl_b32 s53, s53, 2
    s_add_u32 s53, s53, s23
    s_mul_i32 s53, s53, 6144
    s_add_u32 s35, s53, 29360128
    s_add_u32 s53, s21, 2
    s_and_b32 s53, s53, 3
    s_add_u32 s53, s53, s41
    s_lshl_b32 s53, s53, 2
    s_add_u32 s53, s53, s23
    s_mul_i32 s53, s53, 6144
    s_add_u32 s36, s53, 29362176
    s_add_u32 s53, s21, 3
    s_and_b32 s53, s53, 3
    s_add_u32 s53, s53, s41
    s_lshl_b32 s53, s53, 2
    s_add_u32 s53, s53, s23
    s_mul_i32 s53, s53, 6144
    s_add_u32 s37, s53, 29364224
    s_add_u32 s53, s21, 4
    s_and_b32 s53, s53, 3
    s_add_u32 s53, s53, s41
    s_lshl_b32 s53, s53, 2
    s_add_u32 s53, s53, s23
    s_mul_i32 s53, s53, 6144
    s_add_u32 s38, s53, 29360128
    s_mul_i32 s34, s22, 9
    s_add_u32 s34, s34, 1
    s_lshr_b32 s34, s34, 1
    s_add_u32 s34, s34, s21
    s_sub_u32 s49, s21, s23
    s_sub_u32 s49, s49, 1
    s_and_b32 s49, s49, 3
    s_lshl_b32 s49, s49, 10
    s_add_u32 s49, s49, s39
    v_min_u32 v52, 2, v0
    v_add_u32 v52, 1, v52
    v_add_u32 v102, s22, v52
    v_and_b32 v102, 3, v102
    v_lshlrev_b32 v102, 2, v102
    v_add_u32 v103, s21, v52
    v_and_b32 v103, 3, v103
    v_lshlrev_b32 v103, 2, v103
    s_lshl_b32 s47, s20, 2
    s_add_u32 s47, s47, s44
    s_lshl_b32 s47, s47, 2
    s_add_u32 s47, s47, s97
    s_add_u32 s47, s47, 1179648
    v_lshlrev_b32 v7, 9, v2
    s_lshl_b32 s48, s20, 2
    s_add_u32 s48, s48, s23
    s_lshl_b32 s48, s48, 7
    s_add_u32 s48, s48, s97
    s_add_u32 s48, s48, 1183744
    v_lshlrev_b32 v8, 2, v3
    s_cmp_lg_u32 s100, 2
    s_cbranch_scc1 noturn_19
    v_readlane_b32 s0, v182, 0
    v_readlane_b32 s1, v182, 1
    v_readlane_b32 s4, v182, 2
    v_readlane_b32 s5, v182, 3
    v_readlane_b32 s6, v182, 4
    v_readlane_b32 s7, v182, 5
    v_readlane_b32 s50, v182, 6
    v_readlane_b32 s51, v182, 7
    v_readlane_b32 s60, v182, 8
    v_readlane_b32 s61, v182, 9
    v_readlane_b32 s62, v182, 10
    v_readlane_b32 s63, v182, 11
    s_sub_u32 s52, s23, 1
    s_mul_i32 s52, s52, 192
    v_bfe_u32 v115, v0, 2, 3
    v_mul_u32_u24 v115, 1152, v115
    v_lshrrev_b32 v116, 5, v0
    v_mul_u32_u24 v116, 24576, v116
    v_add_u32 v115, 14336, v115
    v_add_u32 v115, v115, v116
    v_and_b32 v116, 3, v0
    v_sub_u32 v113, 63, v116
    v_lshl_add_u32 v113, v113, 4, v115
    v_subrev_u32 v113, s52, v113
    v_lshl_add_u32 v112, v116, 4, v115
    v_or_b32 v116, s52, v116
    v_cmp_eq_u32 vcc, 0, v116
    v_add_u32 v112, s52, v112
    v_add_u32 v114, 144, v113
    v_add_u32 v115, 576, v115
    v_cndmask_b32 v114, v114, v115, vcc
    ds_read_b64_tr_b16 v[120:121], v114 offset:0
    ds_read_b64_tr_b16 v[122:123], v114 offset:49152
    ds_read_b64_tr_b16 v[124:125], v113 offset:136
    ds_read_b64_tr_b16 v[126:127], v113 offset:49288
    ds_read_b64_tr_b16 v[128:129], v113 offset:128
    ds_read_b64_tr_b16 v[130:131], v113 offset:49280
    s_mov_b32 vcc_lo, 0x11111111
    s_mov_b32 vcc_hi, 0x11111111
    ds_read_b64_tr_b16 v[132:133], v113 offset:80
    ds_read_b64_tr_b16 v[134:135], v113 offset:49232
    ds_read_b64_tr_b16 v[136:137], v113 offset:72
    ds_read_b64_tr_b16 v[138:139], v113 offset:49224
    ds_read_b64_tr_b16 v[140:141], v113 offset:64
    ds_read_b64_tr_b16 v[142:143], v113 offset:49216
    ds_read_b64_tr_b16 a[208:209], v112 offset:0
    ds_read_b64_tr_b16 a[210:211], v112 offset:49152
    ds_read_b64_tr_b16 a[212:213], v112 offset:8
    ds_read_b64_tr_b16 a[214:215], v112 offset:49160
    ds_read_b64_tr_b16 a[216:217], v112 offset:64
    ds_read_b64_tr_b16 a[218:219], v112 offset:49216
    s_waitcnt lgkmcnt(12)
    v_cndmask_b32_dpp v120, v124, v120, vcc quad_perm:[0,3,2,1] row_mask:0xf bank_mask:0xf
    v_cndmask_b32_dpp v121, v125, v121, vcc quad_perm:[0,3,2,1] row_mask:0xf bank_mask:0xf
    v_cndmask_b32_dpp v122, v126, v122, vcc quad_perm:[0,3,2,1] row_mask:0xf bank_mask:0xf
    v_cndmask_b32_dpp v123, v127, v123, vcc quad_perm:[0,3,2,1] row_mask:0xf bank_mask:0xf
    v_accvgpr_write_b32 a232, v120
    v_accvgpr_write_b32 a233, v121
    v_accvgpr_write_b32 a234, v122
    v_accvgpr_write_b32 a235, v123
    v_cndmask_b32_dpp v124, v128, v124, vcc quad_perm:[0,3,2,1] row_mask:0xf bank_mask:0xf
    v_cndmask_b32_dpp v125, v129, v125, vcc quad_perm:[0,3,2,1] row_mask:0xf bank_mask:0xf
    v_cndmask_b32_dpp v126, v130, v126, vcc quad_perm:[0,3,2,1] row_mask:0xf bank_mask:0xf
    v_cndmask_b32_dpp v127, v131, v127, vcc quad_perm:[0,3,2,1] row_mask:0xf bank_mask:0xf
    v_accvgpr_write_b32 a236, v124
    v_accvgpr_write_b32 a237, v125
    v_accvgpr_write_b32 a238, v126
    v_accvgpr_write_b32 a239, v127
    ds_read_b64_tr_b16 v[120:121], v113 offset:16
    ds_read_b64_tr_b16 v[122:123], v113 offset:49168
    ds_read_b64_tr_b16 v[124:125], v113 offset:8
    ds_read_b64_tr_b16 v[126:127], v113 offset:49160
    ds_read_b64_tr_b16 v[128:129], v113 offset:0
    ds_read_b64_tr_b16 v[130:131], v113 offset:49152
    ds_read_b64_tr_b16 a[220:221], v112 offset:72
    ds_read_b64_tr_b16 a[222:223], v112 offset:49224
    ds_read_b64_tr_b16 a[224:225], v112 offset:128
    ds_read_b64_tr_b16 a[226:227], v112 offset:49280
    ds_read_b64_tr_b16 a[228:229], v112 offset:136
    ds_read_b64_tr_b16 a[230:231], v112 offset:49288
    s_waitcnt lgkmcnt(12)
    v_cndmask_b32_dpp v132, v136, v132, vcc quad_perm:[0,3,2,1] row_mask:0xf bank_mask:0xf
    v_cndmask_b32_dpp v133, v137, v133, vcc quad_perm:[0,3,2,1] row_mask:0xf bank_mask:0xf
    v_cndmask_b32_dpp v134, v138, v134, vcc quad_perm:[0,3,2,1] row_mask:0xf bank_mask:0xf
    v_cndmask_b32_dpp v135, v139, v135, vcc quad_perm:[0,3,2,1] row_mask:0xf bank_mask:0xf
    v_accvgpr_write_b32 a240, v132
    v_accvgpr_write_b32 a241, v133
    v_accvgpr_write_b32 a242, v134
    v_accvgpr_write_b32 a243, v135
    v_cndmask_b32_dpp v136, v140, v136, vcc quad_perm:[0,3,2,1] row_mask:0xf bank_mask:0xf
    v_cndmask_b32_dpp v137, v141, v137, vcc quad_perm:[0,3,2,1] row_mask:0xf bank_mask:0xf
    v_cndmask_b32_dpp v138, v142, v138, vcc quad_perm:[0,3,2,1] row_mask:0xf bank_mask:0xf
    v_cndmask_b32_dpp v139, v143, v139, vcc quad_perm:[0,3,2,1] row_mask:0xf bank_mask:0xf
    v_accvgpr_write_b32 a244, v136
    v_accvgpr_write_b32 a245, v137
    v_accvgpr_write_b32 a246, v138
    v_accvgpr_write_b32 a247, v139
    s_waitcnt lgkmcnt(0)
    v_cndmask_b32_dpp v120, v124, v120, vcc quad_perm:[0,3,2,1] row_mask:0xf bank_mask:0xf
    v_cndmask_b32_dpp v121, v125, v121, vcc quad_perm:[0,3,2,1] row_mask:0xf bank_mask:0xf
    v_cndmask_b32_dpp v122, v126, v122, vcc quad_perm:[0,3,2,1] row_mask:0xf bank_mask:0xf
    v_cndmask_b32_dpp v123, v127, v123, vcc quad_perm:[0,3,2,1] row_mask:0xf bank_mask:0xf
    v_accvgpr_write_b32 a248, v120
    v_accvgpr_write_b32 a249, v121
    v_accvgpr_write_b32 a250, v122
    v_accvgpr_write_b32 a251, v123
    v_cndmask_b32_dpp v124, v128, v124, vcc quad_perm:[0,3,2,1] row_mask:0xf bank_mask:0xf
    v_cndmask_b32_dpp v125, v129, v125, vcc quad_perm:[0,3,2,1] row_mask:0xf bank_mask:0xf
    v_cndmask_b32_dpp v126, v130, v126, vcc quad_perm:[0,3,2,1] row_mask:0xf bank_mask:0xf
    v_cndmask_b32_dpp v127, v131, v127, vcc quad_perm:[0,3,2,1] row_mask:0xf bank_mask:0xf
    v_accvgpr_write_b32 a252, v124
    v_accvgpr_write_b32 a253, v125
    v_accvgpr_write_b32 a254, v126
    v_accvgpr_write_b32 a255, v127
noturn_19:
    s_cmp_lg_u32 s100, 3
    s_cbranch_scc1 nopatch_20
    v_mov_b32_dpp v112, v178 row_ror:15 row_mask:0xf bank_mask:0xf
    v_mov_b32_dpp v113, v179 row_ror:15 row_mask:0xf bank_mask:0xf
    v_mov_b32_dpp v114, v180 row_ror:15 row_mask:0xf bank_mask:0xf
    v_mov_b32_dpp v115, v181 row_ror:15 row_mask:0xf bank_mask:0xf
    v_accvgpr_write_b32 a212, v182
    v_accvgpr_write_b32 a208, v112
    v_accvgpr_write_b32 a209, v113
    v_accvgpr_write_b32 a210, v114
    v_accvgpr_write_b32 a211, v115
nopatch_20:
    s_cmp_lg_u32 s23, 0
    s_cbranch_scc1 nopoll_21
    s_and_b32 s41, s2, 7
    s_lshl_b32 s41, s41, 10
    s_add_u32 s41, s41, s98
    s_add_u32 s41, s41, 4096
    v_lshlrev_b32 v9, 7, v0
    s_cmp_lg_u32 s3, 0
    s_cbranch_scc1 plain_22
    s_bitcmp1_b32 s2, 5
    s_cbranch_scc1 plain_22_b
    s_mov_b64 exec, 0xff
    buffer_load_dword v11, v9, s[12:15], s41 offen sc1
    s_mov_b64 exec, 0
    s_branch hop_0
back_0:
    s_mov_b64 exec, 0xff
    s_waitcnt vmcnt(0)
    v_cmp_gt_u32 vcc, 1, v11
    s_mov_b64 exec, -1
    s_cbranch_vccz nopoll_21
    s_mov_b64 exec, 0xff
    buffer_load_dword v11, v9, s[12:15], s41 offen sc1
    s_mov_b64 exec, 0
    s_branch hop_1
back_1:
    s_mov_b64 exec, 0xff
    s_waitcnt vmcnt(0)
    v_cmp_gt_u32 vcc, 1, v11
    s_mov_b64 exec, -1
    s_cbranch_vccz nopoll_21
    s_mov_b64 exec, 0xff
    buffer_load_dword v11, v9, s[12:15], s41 offen sc1
    s_mov_b64 exec, 0
    s_branch hop_2
back_2:
    s_mov_b64 exec, 0xff
    s_waitcnt vmcnt(0)
    v_cmp_gt_u32 vcc, 1, v11
    s_mov_b64 exec, -1
    s_cbranch_vccz nopoll_21
    s_mov_b64 exec, 0xff
    buffer_load_dword v11, v9, s[12:15], s41 offen sc1
    s_mov_b64 exec, 0
    s_branch hop_3
back_3:
    s_mov_b64 exec, 0xff
    s_waitcnt vmcnt(0)
    v_cmp_gt_u32 vcc, 1, v11
    s_mov_b64 exec, -1
    s_cbranch_vccz nopoll_21
    s_mov_b64 exec, 0xff
    buffer_load_dword v11, v9, s[12:15], s41 offen sc1
    s_mov_b64 exec, 0
    s_branch hop_4
back_4:
    s_mov_b64 exec, 0xff
    s_waitcnt vmcnt(0)
    v_cmp_gt_u32 vcc, 1, v11
    s_mov_b64 exec, -1
    s_cbranch_vccz nopoll_21
plain_22_b:
    s_mov_b64 exec, 0xff
    buffer_load_dword v11, v9, s[12:15], s41 offen sc1
    s_mov_b64 exec, 0
    s_branch hop_5
back_5:
    s_mov_b64 exec, 0xff
    s_waitcnt vmcnt(0)
    v_cmp_gt_u32 vcc, 1, v11
    s_mov_b64 exec, -1
    s_cbranch_vccz nopoll_21
    s_mov_b64 exec, 0xff
    buffer_load_dword v11, v9, s[12:15], s41 offen sc1
    s_mov_b64 exec, 0
    s_branch hop_6
back_6:
    s_mov_b64 exec, 0xff
    s_waitcnt vmcnt(0)
    v_cmp_gt_u32 vcc, 1, v11
    s_mov_b64 exec, -1
    s_cbranch_vccz nopoll_21
    s_mov_b64 exec, 0xff
    buffer_load_dword v11, v9, s[12:15], s41 offen sc1
    s_mov_b64 exec, 0
    s_branch hop_7
back_7:
    s_mov_b64 exec, 0xff
    s_waitcnt vmcnt(0)
    v_cmp_gt_u32 vcc, 1, v11
    s_mov_b64 exec, -1
    s_cbranch_vccz nopoll_21
    s_mov_b64 exec, 0xff
    buffer_load_dword v11, v9, s[12:15], s41 offen sc1
    s_mov_b64 exec, 0
    s_branch hop_8
back_8:
    s_mov_b64 exec, 0xff
    s_waitcnt vmcnt(0)
    v_cmp_gt_u32 vcc, 1, v11
    s_mov_b64 exec, -1
    s_cbranch_vccz nopoll_21
    s_mov_b64 exec, 0xff
    buffer_load_dword v11, v9, s[12:15], s41 offen sc1
    s_mov_b64 exec, 0
    s_branch hop_9
back_9:
    s_mov_b64 exec, 0xff
    s_waitcnt vmcnt(0)
    v_cmp_gt_u32 vcc, 1, v11
    s_mov_b64 exec, -1
    s_cbranch_vccz nopoll_21
    s_mov_b64 exec, 0xff
    buffer_load_dword v11, v9, s[12:15], s41 offen sc1
    s_mov_b64 exec, 0
    s_branch hop_10
back_10:
    s_mov_b64 exec, 0xff
    s_waitcnt vmcnt(0)
    v_cmp_gt_u32 vcc, 1, v11
    s_mov_b64 exec, -1
    s_cbranch_vccz nopoll_21
plain_22:
    s_mov_b32 s40, 0
    s_mov_b64 exec, 0xff
spin_23:
    buffer_load_dword v11, v9, s[12:15], s41 offen sc1
    s_add_u32 s40, s40, 1
    s_waitcnt vmcnt(0)
    v_cmp_gt_u32 vcc, 1, v11
    s_cbranch_vccz spin_23_x
    s_cmp_lt_u32 s40, 2097152
    s_cbranch_scc1 spin_23
spin_23_x:
    s_mov_b64 exec, -1
nopoll_21:
    s_and_b32 s41, s2, 7
    s_lshl_b32 s41, s41, 10
    s_add_u32 s41, s41, 16920576
    v_and_b32 v9, 7, v0
    v_lshlrev_b32 v9, 7, v9
    s_barrier
    s_add_u32 m0, s43, 0
    s_nop 0
    buffer_load_dwordx4 v4, s[12:15], s42 offen offset:0 sc1 lds
    buffer_load_dwordx4 v4, s[12:15], s42 offen offset:1024 sc1 lds
    buffer_load_dword v108, v7, s[12:15], s47 offen offset:0 sc1
    buffer_load_dword v109, v7, s[12:15], s47 offen offset:256 sc1
    buffer_load_dword v110, v7, s[12:15], s47 offen offset:2048 sc1
    buffer_load_dword v111, v7, s[12:15], s47 offen offset:2304 sc1
    buffer_load_dword v44, v8, s[12:15], s48 offen offset:0 sc1
    buffer_load_dword v48, v8, s[12:15], s48 offen offset:64 sc1
    s_add_u32 m0, s43, 8192
    s_add_u32 s42, s42, 8192
    buffer_load_dwordx4 v4, s[12:15], s42 offen offset:0 sc1 lds
    buffer_load_dwordx4 v4, s[12:15], s42 offen offset:1024 sc1 lds
    s_add_u32 m0, s43, 16384
    s_add_u32 s42, s42, 8192
    buffer_load_dwordx4 v4, s[12:15], s42 offen offset:0 sc1 lds
    buffer_load_dwordx4 v4, s[12:15], s42 offen offset:1024 sc1 lds
    s_add_u32 m0, s43, 24576
    s_add_u32 s42, s42, 8192
    buffer_load_dwordx4 v4, s[12:15], s42 offen offset:0 sc1 lds
    buffer_load_dwordx4 v4, s[12:15], s42 offen offset:1024 sc1 lds
    s_add_u32 m0, s43, 32768
    s_add_u32 s42, s42, 8192
    buffer_load_dwordx4 v4, s[12:15], s42 offen offset:0 sc1 lds
    buffer_load_dwordx4 v4, s[12:15], s42 offen offset:1024 sc1 lds
    s_add_u32 m0, s43, 40960
    s_add_u32 s42, s42, 8192
    buffer_load_dwordx4 v4, s[12:15], s42 offen offset:0 sc1 lds
    buffer_load_dwordx4 v4, s[12:15], s42 offen offset:1024 sc1 lds
    s_waitcnt vmcnt(16)
    s_barrier
    ds_read_b64_tr_b16 v[16:17], v40 offset:0
    ds_read_b64_tr_b16 v[18:19], v40 offset:4096
    ds_read_b64_tr_b16 v[20:21], v41 offset:0
    ds_read_b64_tr_b16 v[22:23], v41 offset:4096
    ds_read_b64_tr_b16 v[24:25], v42 offset:0
    ds_read_b64_tr_b16 v[26:27], v42 offset:4096
    ds_read_b64_tr_b16 v[28:29], v43 offset:0
    ds_read_b64_tr_b16 v[30:31], v43 offset:4096
    s_waitcnt vmcnt(10)
    v_sub_f32 v51, 0, v48
    v_sub_f32 v50, 0, v48
    v_sub_f32 v49, 0, v48
    v_sub_f32 v48, 0, v48
    v_sub_f32 v47, 0, v44
    v_sub_f32 v46, 0, v44
    v_sub_f32 v45, 0, v44
    v_sub_f32 v44, 0, v44
    v_mfma_f32_16x16x32_bf16 v[48:51], v[108:111], v[104:107], v[48:51]
    s_nop 0
    v_mfma_f32_16x16x32_bf16 v[44:47], v[108:111], v[84:87], v[44:47]
    v_mfma_f32_16x16x32_bf16 v[52:55], v[98:101], v[188:191], v[48:51]
    s_waitcnt vmcnt(8)
    s_barrier
    ds_read_b64_tr_b16 a[88:89], v12 offset:0
    v_mfma_f32_16x16x32_bf16 v[56:59], v[96:99], v[188:191], v[48:51]
    s_add_u32 m0, s43, 49152
    s_add_u32 s42, s42, 8192
    v_mfma_f32_16x16x32_bf16 v[60:63], v[98:101], a[0:3], v[44:47]
    buffer_load_dwordx4 v4, s[12:15], s42 offen offset:0 sc1 lds
    v_mfma_f32_16x16x32_bf16 v[64:67], v[96:99], a[0:3], v[44:47]
    ds_read_b64_tr_b16 a[90:91], v12 offset:4096
    s_waitcnt lgkmcnt(6)
    v_mfma_f32_16x16x32_bf16 v[52:55], v[16:19], v[104:107], v[52:55]
    buffer_load_dwordx4 v4, s[12:15], s42 offen offset:1024 sc1 lds
    v_mfma_f32_16x16x32_bf16 v[56:59], v[20:23], v[104:107], v[56:59]
    ds_read_b64_tr_b16 a[92:93], v13 offset:0
    s_add_u32 m0, s43, 57344
    v_cndmask_b32 v16, v16, 0, s[58:59]
    v_cndmask_b32 v17, v17, 0, s[58:59]
    v_cndmask_b32 v18, v18, 0, s[58:59]
    v_cndmask_b32 v19, v19, 0, s[58:59]
    s_nop 1
    v_mfma_f32_16x16x32_bf16 v[60:63], v[16:19], v[84:87], v[60:63]
    s_add_u32 s42, s42, 8192
    v_mfma_f32_16x16x32_bf16 v[64:67], v[20:23], v[84:87], v[64:67]
    ds_read_b64_tr_b16 a[94:95], v13 offset:4096
    v_mfma_f32_16x16x32_bf16 v[68:71], v[98:101], v[184:187], v[44:47]
    buffer_load_dwordx4 v4, s[12:15], s42 offen offset:0 sc1 lds
    v_mfma_f32_16x16x32_bf16 v[72:75], v[96:99], v[184:187], v[44:47]
    ds_read_b64_tr_b16 a[72:73], v14 offset:0
    v_mfma_f32_16x16x32_bf16 v[76:79], v[98:101], a[4:7], v[48:51]
    buffer_load_dwordx4 v4, s[12:15], s42 offen offset:1024 sc1 lds
    v_mfma_f32_16x16x32_bf16 v[80:83], v[96:99], a[4:7], v[48:51]
    s_waitcnt lgkmcnt(5)
    s_add_u32 m0, s43, 65536
    s_add_u32 s42, s42, 8192
    v_mfma_f32_16x16x32_bf16 v[68:71], v[24:27], v[88:91], v[68:71]
    ds_read_b64_tr_b16 a[74:75], v14 offset:4096
    v_cvt_pk_bf16_f32 v188, v52, v53
    v_mfma_f32_16x16x32_bf16 v[72:75], v[28:31], v[88:91], v[72:75]
    buffer_load_dwordx4 v4, s[12:15], s42 offen offset:0 sc1 lds
    v_cndmask_b32 v24, v24, 0, s[58:59]
    v_cndmask_b32 v25, v25, 0, s[58:59]
    v_cndmask_b32 v26, v26, 0, s[58:59]
    v_cndmask_b32 v27, v27, 0, s[58:59]
    s_nop 1
    v_mfma_f32_16x16x32_bf16 v[76:79], v[24:27], v[92:95], v[76:79]
    ds_read_b64_tr_b16 a[76:77], v15 offset:0
    v_cvt_pk_bf16_f32 v189, v54, v55
    v_cvt_pk_bf16_f32 v190, v56, v57
    v_cvt_pk_bf16_f32 v191, v58, v59
    v_mfma_f32_16x16x32_bf16 v[80:83], v[28:31], v[92:95], v[80:83]
    v_cvt_pk_bf16_f32 v112, v60, v61
    v_cvt_pk_bf16_f32 v113, v62, v63
    v_cvt_pk_bf16_f32 v114, v64, v65
    v_cvt_pk_bf16_f32 v115, v66, v67
    v_mfma_f32_16x16x32_bf16 a[172:175], v[188:191], v[188:191], 0
    ds_read_b64_tr_b16 a[78:79], v15 offset:4096
    v_mfma_f32_16x16x32_bf16 a[168:171], v[112:115], v[112:115], 0
    buffer_load_dwordx4 v4, s[12:15], s42 offen offset:1024 sc1 lds
    v_mfma_f32_16x16x32_bf16 v[52:55], v[98:101], v[196:199], v[48:51]
    s_waitcnt vmcnt(10)
    s_barrier
    v_cvt_pk_bf16_f32 v184, v68, v69
    v_mfma_f32_16x16x32_bf16 v[56:59], v[96:99], v[196:199], v[48:51]
    ds_read_b64_tr_b16 a[80:81], v12 offset:8192
    v_cvt_pk_bf16_f32 v185, v70, v71
    v_mfma_f32_16x16x32_bf16 v[60:63], v[98:101], a[8:11], v[44:47]
    v_cvt_pk_bf16_f32 v186, v72, v73
    v_cvt_pk_bf16_f32 v187, v74, v75
    v_mfma_f32_16x16x32_bf16 v[64:67], v[96:99], a[8:11], v[44:47]
    s_waitcnt lgkmcnt(5)
    v_cvt_pk_bf16_f32 v116, v76, v77
    v_cvt_pk_bf16_f32 v117, v78, v79
    v_mfma_f32_16x16x32_bf16 v[52:55], a[88:91], v[104:107], v[52:55]
    ds_read_b64_tr_b16 a[82:83], v12 offset:12288
    v_cvt_pk_bf16_f32 v118, v80, v81
    v_mfma_f32_16x16x32_bf16 v[56:59], a[92:95], v[104:107], v[56:59]
    v_cvt_pk_bf16_f32 v119, v82, v83
    v_mfma_f32_16x16x32_bf16 v[60:63], a[88:91], v[84:87], v[60:63]
    ds_read_b64_tr_b16 a[84:85], v13 offset:8192
    v_mfma_f32_16x16x32_bf16 v[64:67], a[92:95], v[84:87], v[64:67]
    v_mfma_f32_16x16x32_bf16 a[168:171], v[184:187], v[184:187], a[168:171]
    ds_read_b64_tr_b16 a[86:87], v13 offset:12288
    v_mfma_f32_16x16x32_bf16 a[172:175], v[116:119], v[116:119], a[172:175]
    v_mfma_f32_16x16x32_bf16 v[68:71], v[98:101], v[192:195], v[44:47]
    v_cvt_pk_bf16_f32 v196, v52, v53
    v_cvt_pk_bf16_f32 v197, v54, v55
    v_mfma_f32_16x16x32_bf16 v[72:75], v[96:99], v[192:195], v[44:47]
    ds_read_b64_tr_b16 a[88:89], v14 offset:8192
    v_cvt_pk_bf16_f32 v198, v56, v57
    v_mfma_f32_16x16x32_bf16 v[76:79], v[98:101], a[12:15], v[48:51]
    v_cvt_pk_bf16_f32 v199, v58, v59
    v_cvt_pk_bf16_f32 v120, v60, v61
    v_mfma_f32_16x16x32_bf16 v[80:83], v[96:99], a[12:15], v[48:51]
    s_waitcnt lgkmcnt(5)
    v_cvt_pk_bf16_f32 v121, v62, v63
    v_cvt_pk_bf16_f32 v122, v64, v65
    v_mfma_f32_16x16x32_bf16 v[68:71], a[72:75], v[88:91], v[68:71]
    ds_read_b64_tr_b16 a[90:91], v14 offset:12288
    v_cvt_pk_bf16_f32 v123, v66, v67
    v_mfma_f32_16x16x32_bf16 v[72:75], a[76:79], v[88:91], v[72:75]
    v_mfma_f32_16x16x32_bf16 v[76:79], a[72:75], v[92:95], v[76:79]
    ds_read_b64_tr_b16 a[92:93], v15 offset:8192
    v_mfma_f32_16x16x32_bf16 v[80:83], a[76:79], v[92:95], v[80:83]
    buffer_load_dword v11, v9, s[12:15], s41 offen sc1
    v_mfma_f32_16x16x32_bf16 a[172:175], v[196:199], v[196:199], a[172:175]
    ds_read_b64_tr_b16 a[94:95], v15 offset:12288
    v_mfma_f32_16x16x32_bf16 a[168:171], v[120:123], v[120:123], a[168:171]
    v_mfma_f32_16x16x32_bf16 v[52:55], v[98:101], v[204:207], v[48:51]
    v_cvt_pk_bf16_f32 v192, v68, v69
    v_cvt_pk_bf16_f32 v193, v70, v71
    v_mfma_f32_16x16x32_bf16 v[56:59], v[96:99], v[204:207], v[48:51]
    ds_read_b64_tr_b16 a[72:73], v12 offset:16384
    v_cvt_pk_bf16_f32 v194, v72, v73
    v_mfma_f32_16x16x32_bf16 v[60:63], v[98:101], a[16:19], v[44:47]
    v_cvt_pk_bf16_f32 v195, v74, v75
    v_cvt_pk_bf16_f32 v124, v76, v77
    v_mfma_f32_16x16x32_bf16 v[64:67], v[96:99], a[16:19], v[44:47]
    s_waitcnt lgkmcnt(5)
    v_cvt_pk_bf16_f32 v125, v78, v79
    v_cvt_pk_bf16_f32 v126, v80, v81
    v_mfma_f32_16x16x32_bf16 v[52:55], a[80:83], v[104:107], v[52:55]
    ds_read_b64_tr_b16 a[74:75], v12 offset:20480
    v_cvt_pk_bf16_f32 v127, v82, v83
    v_mfma_f32_16x16x32_bf16 v[56:59], a[84:87], v[104:107], v[56:59]
    v_mfma_f32_16x16x32_bf16 v[60:63], a[80:83], v[84:87], v[60:63]
    ds_read_b64_tr_b16 a[76:77], v13 offset:16384
    v_mfma_f32_16x16x32_bf16 v[64:67], a[84:87], v[84:87], v[64:67]
    v_mfma_f32_16x16x32_bf16 a[168:171], v[192:195], v[192:195], a[168:171]
    ds_read_b64_tr_b16 a[78:79], v13 offset:20480
    v_mfma_f32_16x16x32_bf16 a[172:175], v[124:127], v[124:127], a[172:175]
    v_mfma_f32_16x16x32_bf16 v[68:71], v[98:101], v[200:203], v[44:47]
    v_cvt_pk_bf16_f32 v204, v52, v53
    v_cvt_pk_bf16_f32 v205, v54, v55
    v_mfma_f32_16x16x32_bf16 v[72:75], v[96:99], v[200:203], v[44:47]
hop_0:
    s_cbranch_execz back_0
    ds_read_b64_tr_b16 a[80:81], v14 offset:16384
    v_cvt_pk_bf16_f32 v206, v56, v57
    v_mfma_f32_16x16x32_bf16 v[76:79], v[98:101], a[20:23], v[48:51]
    v_cvt_pk_bf16_f32 v207, v58, v59
    v_cvt_pk_bf16_f32 v128, v60, v61
    v_mfma_f32_16x16x32_bf16 v[80:83], v[96:99], a[20:23], v[48:51]
    s_waitcnt lgkmcnt(5)
    v_cvt_pk_bf16_f32 v129, v62, v63
    v_cvt_pk_bf16_f32 v130, v64, v65
    v_mfma_f32_16x16x32_bf16 v[68:71], a[88:91], v[88:91], v[68:71]
    ds_read_b64_tr_b16 a[82:83], v14 offset:20480
    v_cvt_pk_bf16_f32 v131, v66, v67
    v_mfma_f32_16x16x32_bf16 v[72:75], a[92:95], v[88:91], v[72:75]
    v_mfma_f32_16x16x32_bf16 v[76:79], a[88:91], v[92:95], v[76:79]
    ds_read_b64_tr_b16 a[84:85], v15 offset:16384
    v_mfma_f32_16x16x32_bf16 v[80:83], a[92:95], v[92:95], v[80:83]
    v_mfma_f32_16x16x32_bf16 a[172:175], v[204:207], v[204:207], a[172:175]
    ds_read_b64_tr_b16 a[86:87], v15 offset:20480
    v_mfma_f32_16x16x32_bf16 a[168:171], v[128:131], v[128:131], a[168:171]
    v_mfma_f32_16x16x32_bf16 v[52:55], v[98:101], v[212:215], v[48:51]
    s_waitcnt vmcnt(7)
    s_barrier
    v_cvt_pk_bf16_f32 v200, v68, v69
    v_mfma_f32_16x16x32_bf16 v[56:59], v[96:99], v[212:215], v[48:51]
    ds_read_b64_tr_b16 a[88:89], v12 offset:24576
    v_cvt_pk_bf16_f32 v201, v70, v71
    v_mfma_f32_16x16x32_bf16 v[60:63], v[98:101], a[24:27], v[44:47]
    v_cvt_pk_bf16_f32 v202, v72, v73
    v_cvt_pk_bf16_f32 v203, v74, v75
    v_mfma_f32_16x16x32_bf16 v[64:67], v[96:99], a[24:27], v[44:47]
    s_waitcnt lgkmcnt(5)
    v_cvt_pk_bf16_f32 v132, v76, v77
    v_cvt_pk_bf16_f32 v133, v78, v79
    v_mfma_f32_16x16x32_bf16 v[52:55], a[72:75], v[104:107], v[52:55]
    ds_read_b64_tr_b16 a[90:91], v12 offset:28672
    v_cvt_pk_bf16_f32 v134, v80, v81
    v_mfma_f32_16x16x32_bf16 v[56:59], a[76:79], v[104:107], v[56:59]
    v_cvt_pk_bf16_f32 v135, v82, v83
    v_mfma_f32_16x16x32_bf16 v[60:63], a[72:75], v[84:87], v[60:63]
    ds_read_b64_tr_b16 a[92:93], v13 offset:24576
    v_mfma_f32_16x16x32_bf16 v[64:67], a[76:79], v[84:87], v[64:67]
    v_mfma_f32_16x16x32_bf16 a[168:171], v[200:203], v[200:203], a[168:171]
    ds_read_b64_tr_b16 a[94:95], v13 offset:28672
    v_mfma_f32_16x16x32_bf16 a[172:175], v[132:135], v[132:135], a[172:175]
    v_mfma_f32_16x16x32_bf16 v[68:71], v[98:101], v[208:211], v[44:47]
    v_cvt_pk_bf16_f32 v212, v52, v53
    v_cvt_pk_bf16_f32 v213, v54, v55
    v_mfma_f32_16x16x32_bf16 v[72:75], v[96:99], v[208:211], v[44:47]
    ds_read_b64_tr_b16 a[72:73], v14 offset:24576
    v_cvt_pk_bf16_f32 v214, v56, v57
    v_mfma_f32_16x16x32_bf16 v[76:79], v[98:101], a[28:31], v[48:51]
    v_cvt_pk_bf16_f32 v215, v58, v59
    v_cvt_pk_bf16_f32 v136, v60, v61
    v_mfma_f32_16x16x32_bf16 v[80:83], v[96:99], a[28:31], v[48:51]
    s_waitcnt lgkmcnt(5)
    v_cvt_pk_bf16_f32 v137, v62, v63
    v_cvt_pk_bf16_f32 v138, v64, v65
    v_mfma_f32_16x16x32_bf16 v[68:71], a[80:83], v[88:91], v[68:71]
    ds_read_b64_tr_b16 a[74:75], v14 offset:28672
    v_cvt_pk_bf16_f32 v139, v66, v67
    v_mfma_f32_16x16x32_bf16 v[72:75], a[84:87], v[88:91], v[72:75]
    v_mfma_f32_16x16x32_bf16 v[76:79], a[80:83], v[92:95], v[76:79]
    ds_read_b64_tr_b16 a[76:77], v15 offset:24576
    v_mfma_f32_16x16x32_bf16 v[80:83], a[84:87], v[92:95], v[80:83]
    v_mfma_f32_16x16x32_bf16 a[172:175], v[212:215], v[212:215], a[172:175]
    ds_read_b64_tr_b16 a[78:79], v15 offset:28672
    v_mfma_f32_16x16x32_bf16 a[168:171], v[136:139], v[136:139], a[168:171]
    v_mfma_f32_16x16x32_bf16 v[52:55], v[98:101], v[220:223], v[48:51]
    v_cvt_pk_bf16_f32 v208, v68, v69
    v_cvt_pk_bf16_f32 v209, v70, v71
    v_mfma_f32_16x16x32_bf16 v[56:59], v[96:99], v[220:223], v[48:51]
    ds_read_b64_tr_b16 a[80:81], v12 offset:32768
    v_cvt_pk_bf16_f32 v210, v72, v73
    v_mfma_f32_16x16x32_bf16 v[60:63], v[98:101], a[32:35], v[44:47]
    s_waitcnt vmcnt(0)
    v_cmp_gt_u32 vcc, 1, v11
    s_cbranch_vccnz late_24
late_24_ok:
    v_mfma_f32_16x16x32_bf16 v[64:67], v[96:99], a[32:35], v[44:47]
    s_waitcnt lgkmcnt(5)
    v_cvt_pk_bf16_f32 v211, v74, v75
    v_cvt_pk_bf16_f32 v140, v76, v77
    v_mfma_f32_16x16x32_bf16 v[52:55], a[88:91], v[104:107], v[52:55]
    ds_read_b64_tr_b16 a[82:83], v12 offset:36864
    v_cvt_pk_bf16_f32 v141, v78, v79
    v_mfma_f32_16x16x32_bf16 v[56:59], a[92:95], v[104:107], v[56:59]
    s_add_u32 m0, s27, 0
    s_add_u32 s26, s26, 28672
    v_cvt_pk_bf16_f32 v142, v80, v81
    v_mfma_f32_16x16x32_bf16 v[60:63], a[88:91], v[84:87], v[60:63]
    ds_read_b64_tr_b16 a[84:85], v13 offset:32768
    v_cvt_pk_bf16_f32 v143, v82, v83
    v_mfma_f32_16x16x32_bf16 v[64:67], a[92:95], v[84:87], v[64:67]
    buffer_load_dwordx4 v4, s[12:15], s26 offen offset:0 sc1 lds
    v_mfma_f32_16x16x32_bf16 a[168:171], v[208:211], v[208:211], a[168:171]
    ds_read_b64_tr_b16 a[86:87], v13 offset:36864
    v_mfma_f32_16x16x32_bf16 a[172:175], v[140:143], v[140:143], a[172:175]
    v_mfma_f32_16x16x32_bf16 v[68:71], v[98:101], v[216:219], v[44:47]
    buffer_load_dwordx4 v4, s[12:15], s26 offen offset:1024 sc1 lds
    v_mfma_f32_16x16x32_bf16 v[72:75], v[96:99], v[216:219], v[44:47]
    ds_read_b64_tr_b16 a[88:89], v14 offset:32768
    v_cvt_pk_bf16_f32 v220, v52, v53
    v_mfma_f32_16x16x32_bf16 v[76:79], v[98:101], a[36:39], v[48:51]
    v_cvt_pk_bf16_f32 v221, v54, v55
    v_cvt_pk_bf16_f32 v222, v56, v57
    v_mfma_f32_16x16x32_bf16 v[80:83], v[96:99], a[36:39], v[48:51]
    s_waitcnt lgkmcnt(5)
    v_cvt_pk_bf16_f32 v223, v58, v59
    v_cvt_pk_bf16_f32 v144, v60, v61
    v_mfma_f32_16x16x32_bf16 v[68:71], a[72:75], v[88:91], v[68:71]
    ds_read_b64_tr_b16 a[90:91], v14 offset:36864
    v_cvt_pk_bf16_f32 v145, v62, v63
    v_mfma_f32_16x16x32_bf16 v[72:75], a[76:79], v[88:91], v[72:75]
    buffer_load_dwordx4 v4, s[12:15], s26 offen offset:2048 sc1 lds
    v_mfma_f32_16x16x32_bf16 v[76:79], a[72:75], v[92:95], v[76:79]
    ds_read_b64_tr_b16 a[92:93], v15 offset:32768
    v_cvt_pk_bf16_f32 v146, v64, v65
    v_mfma_f32_16x16x32_bf16 v[80:83], a[76:79], v[92:95], v[80:83]
    v_cvt_pk_bf16_f32 v147, v66, v67
    v_mfma_f32_16x16x32_bf16 a[172:175], v[220:223], v[220:223], a[172:175]
    ds_read_b64_tr_b16 a[94:95], v15 offset:36864
    buffer_load_dwordx4 v4, s[12:15], s26 offen offset:3072 sc1 lds
    s_add_u32 m0, s27, 4096
    s_add_u32 s26, s26, 4096
    v_mfma_f32_16x16x32_bf16 a[168:171], v[144:147], v[144:147], a[168:171]
    buffer_load_dwordx4 v4, s[12:15], s26 offen offset:0 sc1 lds
    v_mfma_f32_16x16x32_bf16 v[52:55], v[98:101], v[228:231], v[48:51]
    s_barrier
    v_cvt_pk_bf16_f32 v216, v68, v69
    v_cvt_pk_bf16_f32 v217, v70, v71
    v_mfma_f32_16x16x32_bf16 v[56:59], v[96:99], v[228:231], v[48:51]
    ds_read_b64_tr_b16 a[72:73], v12 offset:40960
    v_cvt_pk_bf16_f32 v218, v72, v73
    v_mfma_f32_16x16x32_bf16 v[60:63], v[98:101], a[40:43], v[44:47]
    buffer_load_dwordx4 v4, s[12:15], s26 offen offset:1024 sc1 lds
    v_mfma_f32_16x16x32_bf16 v[64:67], v[96:99], a[40:43], v[44:47]
    s_waitcnt lgkmcnt(5)
    v_cvt_pk_bf16_f32 v219, v74, v75
    v_cvt_pk_bf16_f32 v148, v76, v77
    v_mfma_f32_16x16x32_bf16 v[52:55], a[80:83], v[104:107], v[52:55]
    ds_read_b64_tr_b16 a[74:75], v12 offset:45056
    v_cvt_pk_bf16_f32 v149, v78, v79
    v_mfma_f32_16x16x32_bf16 v[56:59], a[84:87], v[104:107], v[56:59]
    buffer_load_dwordx4 v4, s[12:15], s26 offen offset:2048 sc1 lds
    v_mfma_f32_16x16x32_bf16 v[60:63], a[80:83], v[84:87], v[60:63]
    ds_read_b64_tr_b16 a[76:77], v13 offset:40960
    v_cvt_pk_bf16_f32 v150, v80, v81
    v_mfma_f32_16x16x32_bf16 v[64:67], a[84:87], v[84:87], v[64:67]
    v_cvt_pk_bf16_f32 v151, v82, v83
    v_mfma_f32_16x16x32_bf16 a[168:171], v[216:219], v[216:219], a[168:171]
    ds_read_b64_tr_b16 a[78:79], v13 offset:45056
    v_mfma_f32_16x16x32_bf16 a[172:175], v[148:151], v[148:151], a[172:175]
    buffer_load_dwordx4 v4, s[12:15], s26 offen offset:3072 sc1 lds
    v_mfma_f32_16x16x32_bf16 v[68:71], v[98:101], v[224:227], v[44:47]
    s_add_u32 m0, s27, 8192
    s_add_u32 s26, s26, 4096
    v_cvt_pk_bf16_f32 v228, v52, v53
    v_mfma_f32_16x16x32_bf16 v[72:75], v[96:99], v[224:227], v[44:47]
    ds_read_b64_tr_b16 a[80:81], v14 offset:40960
    v_cvt_pk_bf16_f32 v229, v54, v55
    v_mfma_f32_16x16x32_bf16 v[76:79], v[98:101], a[44:47], v[48:51]
    buffer_load_dwordx4 v4, s[12:15], s26 offen offset:0 sc1 lds
    v_mfma_f32_16x16x32_bf16 v[80:83], v[96:99], a[44:47], v[48:51]
    s_waitcnt lgkmcnt(5)
    v_cvt_pk_bf16_f32 v230, v56, v57
    v_cvt_pk_bf16_f32 v231, v58, v59
    v_mfma_f32_16x16x32_bf16 v[68:71], a[88:91], v[88:91], v[68:71]
    ds_read_b64_tr_b16 a[82:83], v14 offset:45056
    v_cvt_pk_bf16_f32 v152, v60, v61
    v_mfma_f32_16x16x32_bf16 v[72:75], a[92:95], v[88:91], v[72:75]
    v_cvt_pk_bf16_f32 v153, v62, v63
    v_cvt_pk_bf16_f32 v154, v64, v65
    v_mfma_f32_16x16x32_bf16 v[76:79], a[88:91], v[92:95], v[76:79]
    ds_read_b64_tr_b16 a[84:85], v15 offset:40960
    v_cvt_pk_bf16_f32 v155, v66, v67
    v_mfma_f32_16x16x32_bf16 v[80:83], a[92:95], v[92:95], v[80:83]
    s_add_u32 m0, s27, 36864
    s_add_u32 s26, s26, 28672
    v_mfma_f32_16x16x32_bf16 a[172:175], v[228:231], v[228:231], a[172:175]
    ds_read_b64_tr_b16 a[86:87], v15 offset:45056
    v_mfma_f32_16x16x32_bf16 a[168:171], v[152:155], v[152:155], a[168:171]
    v_mfma_f32_16x16x32_bf16 v[52:55], v[98:101], v[236:239], v[48:51]
    buffer_load_dwordx4 v4, s[12:15], s26 offen offset:0 sc1 lds
    v_mfma_f32_16x16x32_bf16 v[56:59], v[96:99], v[236:239], v[48:51]
    ds_read_b64_tr_b16 a[88:89], v12 offset:49152
    v_cvt_pk_bf16_f32 v224, v68, v69
    v_mfma_f32_16x16x32_bf16 v[60:63], v[98:101], a[48:51], v[44:47]
    v_cvt_pk_bf16_f32 v225, v70, v71
    v_cvt_pk_bf16_f32 v226, v72, v73
    v_mfma_f32_16x16x32_bf16 v[64:67], v[96:99], a[48:51], v[44:47]
    s_waitcnt lgkmcnt(5)
    v_cvt_pk_bf16_f32 v227, v74, v75
    v_cvt_pk_bf16_f32 v156, v76, v77
    v_mfma_f32_16x16x32_bf16 v[52:55], a[72:75], v[104:107], v[52:55]
    ds_read_b64_tr_b16 a[90:91], v12 offset:53248
    v_cvt_pk_bf16_f32 v157, v78, v79
    v_mfma_f32_16x16x32_bf16 v[56:59], a[76:79], v[104:107], v[56:59]
    buffer_load_dwordx4 v4, s[12:15], s26 offen offset:1024 sc1 lds
    v_mfma_f32_16x16x32_bf16 v[60:63], a[72:75], v[84:87], v[60:63]
    ds_read_b64_tr_b16 a[92:93], v13 offset:49152
    v_cvt_pk_bf16_f32 v158, v80, v81
    v_mfma_f32_16x16x32_bf16 v[64:67], a[76:79], v[84:87], v[64:67]
    v_cvt_pk_bf16_f32 v159, v82, v83
    v_mfma_f32_16x16x32_bf16 a[168:171], v[224:227], v[224:227], a[168:171]
    ds_read_b64_tr_b16 a[94:95], v13 offset:53248
    v_mfma_f32_16x16x32_bf16 a[172:175], v[156:159], v[156:159], a[172:175]
    v_mfma_f32_16x16x32_bf16 v[68:71], v[98:101], v[232:235], v[44:47]
    buffer_load_dwordx4 v4, s[12:15], s26 offen offset:2048 sc1 lds
    v_mfma_f32_16x16x32_bf16 v[72:75], v[96:99], v[232:235], v[44:47]
    ds_read_b64_tr_b16 a[72:73], v14 offset:49152
    v_cvt_pk_bf16_f32 v236, v52, v53
    v_mfma_f32_16x16x32_bf16 v[76:79], v[98:101], a[52:55], v[48:51]
    v_cvt_pk_bf16_f32 v237, v54, v55
    v_cvt_pk_bf16_f32 v238, v56, v57
    v_mfma_f32_16x16x32_bf16 v[80:83], v[96:99], a[52:55], v[48:51]
    s_waitcnt lgkmcnt(5)
    v_cvt_pk_bf16_f32 v239, v58, v59
    v_cvt_pk_bf16_f32 v160, v60, v61
    v_mfma_f32_16x16x32_bf16 v[68:71], a[80:83], v[88:91], v[68:71]
    ds_read_b64_tr_b16 a[74:75], v14 offset:53248
    v_cvt_pk_bf16_f32 v161, v62, v63
    v_mfma_f32_16x16x32_bf16 v[72:75], a[84:87], v[88:91], v[72:75]
    buffer_load_dwordx4 v4, s[12:15], s26 offen offset:3072 sc1 lds
    v_mfma_f32_16x16x32_bf16 v[76:79], a[80:83], v[92:95], v[76:79]
    ds_read_b64_tr_b16 a[76:77], v15 offset:49152
    v_cvt_pk_bf16_f32 v162, v64, v65
    v_mfma_f32_16x16x32_bf16 v[80:83], a[84:87], v[92:95], v[80:83]
    s_add_u32 m0, s27, 40960
    v_cvt_pk_bf16_f32 v163, v66, v67
    s_add_u32 s26, s26, 4096
    v_mfma_f32_16x16x32_bf16 a[172:175], v[236:239], v[236:239], a[172:175]
    ds_read_b64_tr_b16 a[78:79], v15 offset:53248
    v_mfma_f32_16x16x32_bf16 a[168:171], v[160:163], v[160:163], a[168:171]
    v_mfma_f32_16x16x32_bf16 v[52:55], v[98:101], v[244:247], v[48:51]
    buffer_load_dwordx4 v4, s[12:15], s26 offen offset:0 sc1 lds
    v_mfma_f32_16x16x32_bf16 v[56:59], v[96:99], v[244:247], v[48:51]
    ds_read_b64_tr_b16 a[80:81], v12 offset:57344
    v_cvt_pk_bf16_f32 v232, v68, v69
    v_mfma_f32_16x16x32_bf16 v[60:63], v[98:101], a[56:59], v[44:47]
    v_cvt_pk_bf16_f32 v233, v70, v71
    v_cvt_pk_bf16_f32 v234, v72, v73
    v_mfma_f32_16x16x32_bf16 v[64:67], v[96:99], a[56:59], v[44:47]
    s_waitcnt lgkmcnt(5)
    v_cvt_pk_bf16_f32 v235, v74, v75
    v_cvt_pk_bf16_f32 v164, v76, v77
    v_mfma_f32_16x16x32_bf16 v[52:55], a[88:91], v[104:107], v[52:55]
    ds_read_b64_tr_b16 a[82:83], v12 offset:61440
    v_cvt_pk_bf16_f32 v165, v78, v79
    v_mfma_f32_16x16x32_bf16 v[56:59], a[92:95], v[104:107], v[56:59]
    buffer_load_dwordx4 v4, s[12:15], s26 offen offset:1024 sc1 lds
    v_mfma_f32_16x16x32_bf16 v[60:63], a[88:91], v[84:87], v[60:63]
    ds_read_b64_tr_b16 a[84:85], v13 offset:57344
    v_cvt_pk_bf16_f32 v166, v80, v81
    v_mfma_f32_16x16x32_bf16 v[64:67], a[92:95], v[84:87], v[64:67]
    v_cvt_pk_bf16_f32 v167, v82, v83
    v_mfma_f32_16x16x32_bf16 a[168:171], v[232:235], v[232:235], a[168:171]
    ds_read_b64_tr_b16 a[86:87], v13 offset:61440
    v_mfma_f32_16x16x32_bf16 a[172:175], v[164:167], v[164:167], a[172:175]
    v_mfma_f32_16x16x32_bf16 v[68:71], v[98:101], v[240:243], v[44:47]
    buffer_load_dwordx4 v4, s[12:15], s26 offen offset:2048 sc1 lds
    v_mfma_f32_16x16x32_bf16 v[72:75], v[96:99], v[240:243], v[44:47]
    ds_read_b64_tr_b16 a[88:89], v14 offset:57344
    v_cvt_pk_bf16_f32 v244, v52, v53
    v_mfma_f32_16x16x32_bf16 v[76:79], v[98:101], a[60:63], v[48:51]
    v_cvt_pk_bf16_f32 v245, v54, v55
    v_cvt_pk_bf16_f32 v246, v56, v57
    v_mfma_f32_16x16x32_bf16 v[80:83], v[96:99], a[60:63], v[48:51]
    s_waitcnt lgkmcnt(5)
    v_cvt_pk_bf16_f32 v247, v58, v59
    v_cvt_pk_bf16_f32 v168, v60, v61
    v_mfma_f32_16x16x32_bf16 v[68:71], a[72:75], v[88:91], v[68:71]
    ds_read_b64_tr_b16 a[90:91], v14 offset:61440
    v_cvt_pk_bf16_f32 v169, v62, v63
    v_mfma_f32_16x16x32_bf16 v[72:75], a[76:79], v[88:91], v[72:75]
    buffer_load_dwordx4 v4, s[12:15], s26 offen offset:3072 sc1 lds
    v_mfma_f32_16x16x32_bf16 v[76:79], a[72:75], v[92:95], v[76:79]
    ds_read_b64_tr_b16 a[92:93], v15 offset:57344
    v_cvt_pk_bf16_f32 v170, v64, v65
    v_mfma_f32_16x16x32_bf16 v[80:83], a[76:79], v[92:95], v[80:83]
    s_add_u32 m0, s27, 45056
    v_cvt_pk_bf16_f32 v171, v66, v67
    s_add_u32 s26, s26, 4096
    v_mfma_f32_16x16x32_bf16 a[172:175], v[244:247], v[244:247], a[172:175]
    ds_read_b64_tr_b16 a[94:95], v15 offset:61440
    v_mfma_f32_16x16x32_bf16 a[168:171], v[168:171], v[168:171], a[168:171]
    v_mfma_f32_16x16x32_bf16 v[52:55], v[98:101], v[252:255], v[48:51]
    buffer_load_dwordx4 v4, s[12:15], s26 offen offset:0 sc1 lds
    v_mfma_f32_16x16x32_bf16 v[56:59], v[96:99], v[252:255], v[48:51]
    v_cvt_pk_bf16_f32 v240, v68, v69
    v_cvt_pk_bf16_f32 v241, v70, v71
    v_mfma_f32_16x16x32_bf16 v[60:63], v[98:101], a[64:67], v[44:47]
    v_cvt_pk_bf16_f32 v242, v72, v73
    v_cvt_pk_bf16_f32 v243, v74, v75
    v_mfma_f32_16x16x32_bf16 v[64:67], v[96:99], a[64:67], v[44:47]
    s_waitcnt lgkmcnt(4)
    v_cvt_pk_bf16_f32 v172, v76, v77
    v_cvt_pk_bf16_f32 v173, v78, v79
    v_mfma_f32_16x16x32_bf16 v[52:55], a[80:83], v[104:107], v[52:55]
    v_cvt_pk_bf16_f32 v174, v80, v81
    v_cvt_pk_bf16_f32 v175, v82, v83
    v_mfma_f32_16x16x32_bf16 v[56:59], a[84:87], v[104:107], v[56:59]
    s_waitcnt vmcnt(9) lgkmcnt(0)
    s_barrier
    v_mfma_f32_16x16x32_bf16 v[60:63], a[80:83], v[84:87], v[60:63]
    v_mfma_f32_16x16x32_bf16 v[64:67], a[84:87], v[84:87], v[64:67]
    v_mfma_f32_16x16x32_bf16 a[168:171], v[240:243], v[240:243], a[168:171]
    ds_read_b128 v[16:19], v4 offset:0
    v_mfma_f32_16x16x32_bf16 a[172:175], v[172:175], v[172:175], a[172:175]
    v_mfma_f32_16x16x32_bf16 v[68:71], v[98:101], v[248:251], v[44:47]
    ds_read_b128 v[20:23], v4 offset:1024
    v_cvt_pk_bf16_f32 v252, v52, v53
    v_mfma_f32_16x16x32_bf16 v[72:75], v[96:99], v[248:251], v[44:47]
    v_cvt_pk_bf16_f32 v253, v54, v55
    v_cvt_pk_bf16_f32 v254, v56, v57
    v_mfma_f32_16x16x32_bf16 v[76:79], v[98:101], a[68:71], v[48:51]
    ds_read_b128 v[24:27], v4 offset:2048
    v_cvt_pk_bf16_f32 v255, v58, v59
    v_mfma_f32_16x16x32_bf16 v[80:83], v[96:99], a[68:71], v[48:51]
    v_cvt_pk_bf16_f32 v176, v60, v61
    v_cvt_pk_bf16_f32 v177, v62, v63
    v_mfma_f32_16x16x32_bf16 v[68:71], a[88:91], v[88:91], v[68:71]
    ds_read_b128 v[28:31], v4 offset:3072
    v_cvt_pk_bf16_f32 v178, v64, v65
    v_mfma_f32_16x16x32_bf16 v[72:75], a[92:95], v[88:91], v[72:75]
    v_cvt_pk_bf16_f32 v179, v66, v67
    v_mfma_f32_16x16x32_bf16 v[76:79], a[88:91], v[92:95], v[76:79]
    ds_read_b128 v[32:35], v4 offset:4096
    v_mfma_f32_16x16x32_bf16 v[80:83], a[92:95], v[92:95], v[80:83]
    v_mfma_f32_16x16x32_bf16 a[172:175], v[252:255], v[252:255], a[172:175]
    ds_read_b128 v[36:39], v4 offset:5120
    v_sub_f32 v94, 0, v44
    v_sub_f32 v95, 0, v48
    v_mfma_f32_16x16x32_bf16 a[168:171], v[176:179], v[176:179], a[168:171]
    s_waitcnt lgkmcnt(3)
    v_mfma_f32_16x16x32_bf16 v[52:55], v[16:19], v[112:115], 0
    ds_read_b128 v[40:43], v4 offset:6144
    v_cvt_pk_bf16_f32 v248, v68, v69
    v_mfma_f32_16x16x32_bf16 v[52:55], v[20:23], v[120:123], v[52:55]
    v_cvt_pk_bf16_f32 v249, v70, v71
    v_cvt_pk_bf16_f32 v250, v72, v73
    v_mfma_f32_16x16x32_bf16 v[52:55], v[24:27], v[128:131], v[52:55]
    ds_read_b128 v[44:47], v4 offset:7168
    v_cvt_pk_bf16_f32 v251, v74, v75
    v_mfma_f32_16x16x32_bf16 v[56:59], v[24:27], v[132:135], 0
    v_cvt_pk_bf16_f32 v180, v76, v77
    v_cvt_pk_bf16_f32 v181, v78, v79
    v_mfma_f32_16x16x32_bf16 v[56:59], v[20:23], v[124:127], v[56:59]
    ds_read_b128 v[48:51], v4 offset:8192
    v_cvt_pk_bf16_f32 v182, v80, v81
    v_cvt_pk_bf16_f32 v183, v82, v83
    v_mfma_f32_16x16x32_bf16 v[56:59], v[16:19], v[116:119], v[56:59]
    s_add_u32 m0, s27, 73728
    s_add_u32 s26, s26, 28672
    v_mfma_f32_16x16x32_bf16 a[168:171], v[248:251], v[248:251], a[168:171]
    v_cmp_eq_u32 vcc, 0, v0
    v_mov_b32 v85, 2.0
    v_mfma_f32_16x16x32_bf16 a[172:175], v[180:183], v[180:183], a[172:175]
    s_waitcnt lgkmcnt(3)
    s_lshl_b32 s52, s22, 2
    v_mov_b32 v12, s52
    v_mfma_f32_16x16x32_bf16 v[56:59], v[28:31], v[140:143], v[56:59]
    ds_read_b128 v[16:19], v4 offset:9216
    v_cndmask_b32 v12, v85, v12, vcc
    v_mfma_f32_16x16x32_bf16 v[56:59], v[32:35], v[148:151], v[56:59]
    buffer_load_dwordx4 v4, s[12:15], s26 offen offset:0 sc1 lds
    v_mfma_f32_16x16x32_bf16 v[56:59], v[36:39], v[156:159], v[56:59]
    ds_read_b128 v[20:23], v4 offset:10240
    s_lshl_b32 s52, s21, 2
    v_mfma_f32_16x16x32_bf16 v[52:55], v[36:39], v[152:155], v[52:55]
    v_mov_b32 v13, s52
    v_cndmask_b32 v13, v85, v13, vcc
    v_mfma_f32_16x16x32_bf16 v[52:55], v[32:35], v[144:147], v[52:55]
    ds_read_b128 v[24:27], v4 offset:11264
    v_cndmask_b32 v14, 0, 3, vcc
    v_mfma_f32_16x16x32_bf16 v[52:55], v[28:31], v[136:139], v[52:55]
    s_waitcnt lgkmcnt(3)
    v_cmp_eq_u32 s[58:59], s3, 1
    v_and_b32 v92, 3, v3
    v_mfma_f32_16x16x32_bf16 v[52:55], v[40:43], v[160:163], v[52:55]
    ds_read_b128 v[28:31], v4 offset:12288
    v_lshrrev_b32 v93, 2, v3
    v_mfma_f32_16x16x32_bf16 v[52:55], v[44:47], v[168:171], v[52:55]
    buffer_load_dwordx4 v4, s[12:15], s26 offen offset:1024 sc1 lds
    v_mfma_f32_16x16x32_bf16 v[52:55], v[48:51], v[176:179], v[52:55]
    ds_read_b128 v[32:35], v4 offset:13312
    v_lshl_add_u32 v93, v93, 4, v3
    v_mfma_f32_16x16x32_bf16 v[56:59], v[48:51], v[180:183], v[56:59]
    v_lshlrev_b32 v93, 2, v93
    v_mov_b32 v11, 148480
    v_mfma_f32_16x16x32_bf16 v[56:59], v[44:47], v[172:175], v[56:59]
    ds_read_b128 v[36:39], v4 offset:14336
    v_cndmask_b32 v15, v11, v1, s[58:59]
    v_mfma_f32_16x16x32_bf16 v[56:59], v[40:43], v[164:167], v[56:59]
    s_waitcnt lgkmcnt(3)
    v_cmp_eq_u32 s[52:53], 1, v92
    v_cmp_eq_u32 s[54:55], 2, v92
    v_mfma_f32_16x16x32_bf16 v[56:59], v[16:19], v[188:191], v[56:59]
    ds_read_b128 v[40:43], v4 offset:15360
    v_cmp_eq_u32 s[58:59], 0, v2
    v_mfma_f32_16x16x32_bf16 v[56:59], v[20:23], v[196:199], v[56:59]
    buffer_load_dwordx4 v4, s[12:15], s26 offen offset:2048 sc1 lds
    v_mfma_f32_16x16x32_bf16 v[56:59], v[24:27], v[204:207], v[56:59]
    ds_read_b128 v[44:47], v4 offset:16384
    v_cmp_eq_u32 s[56:57], 3, v92
    v_mfma_f32_16x16x32_bf16 v[52:55], v[24:27], v[200:203], v[52:55]
    v_accvgpr_read_b32 v84, a168
    v_accvgpr_read_b32 v85, a169
    v_mfma_f32_16x16x32_bf16 v[52:55], v[20:23], v[192:195], v[52:55]
    ds_read_b128 v[48:51], v4 offset:17408
    v_accvgpr_read_b32 v86, a170
    v_mfma_f32_16x16x32_bf16 v[52:55], v[16:19], v[184:187], v[52:55]
    s_waitcnt lgkmcnt(3)
    v_cndmask_b32 v11, v11, v15, s[58:59]
    v_accvgpr_read_b32 v87, a171
    v_mfma_f32_16x16x32_bf16 v[52:55], v[28:31], v[208:211], v[52:55]
    ds_read_b128 v[16:19], v4 offset:18432
    v_accvgpr_read_b32 v88, a172
    v_mfma_f32_16x16x32_bf16 v[52:55], v[32:35], v[216:219], v[52:55]
    s_cmp_eq_u32 s22, 1
    s_cbranch_scc1 pj_35
    s_cmp_eq_u32 s22, 2
    s_cbranch_scc1 pj_36
    s_cmp_eq_u32 s22, 3
    s_cbranch_scc1 pj_37
pj_34:
    ds_write_b64 v1, v[144:145] offset:2048
    ds_write_b64 v1, v[148:149] offset:2056
    s_cmp_eq_u32 s21, 1
    s_cbranch_scc1 pj_34_1
    s_cmp_eq_u32 s21, 2
    s_cbranch_scc1 pj_34_2
    s_cmp_eq_u32 s21, 3
    s_cbranch_scc1 pj_34_3
pj_34_0:
    ds_write_b128 v1, v[112:115] offset:0
    ds_write_b128 v1, v[116:119] offset:1024
    s_branch parked_38
pj_34_1:
    ds_write_b128 v1, v[120:123] offset:0
    ds_write_b128 v1, v[124:127] offset:1024
    s_branch parked_38
pj_34_2:
    ds_write_b128 v1, v[128:131] offset:0
    ds_write_b128 v1, v[132:135] offset:1024
    s_branch parked_38
pj_34_3:
    ds_write_b128 v1, v[136:139] offset:0
    ds_write_b128 v1, v[140:143] offset:1024
    s_branch parked_38
pj_35:
    ds_write_b64 v1, v[146:147] offset:2048
    ds_write_b64 v1, v[150:151] offset:2056
    s_cmp_eq_u32 s21, 1
    s_cbranch_scc1 pj_35_1
    s_cmp_eq_u32 s21, 2
    s_cbranch_scc1 pj_35_2
    s_cmp_eq_u32 s21, 3
    s_cbranch_scc1 pj_35_3
pj_35_0:
    ds_write_b128 v1, v[152:155] offset:0
    ds_write_b128 v1, v[156:159] offset:1024
    s_branch parked_38
pj_35_1:
    ds_write_b128 v1, v[160:163] offset:0
    ds_write_b128 v1, v[164:167] offset:1024
    s_branch parked_38
pj_35_2:
    ds_write_b128 v1, v[168:171] offset:0
    ds_write_b128 v1, v[172:175] offset:1024
    s_branch parked_38
pj_35_3:
    ds_write_b128 v1, v[176:179] offset:0
    ds_write_b128 v1, v[180:183] offset:1024
    s_branch parked_38
pj_36:
    ds_write_b64 v1, v[216:217] offset:2048
    ds_write_b64 v1, v[220:221] offset:2056
    ds_write_b16 v15, v218 offset:2048
    ds_write_b16 v15, v222 offset:2056
    s_cmp_eq_u32 s21, 1
    s_cbranch_scc1 pj_36_1
    s_cmp_eq_u32 s21, 2
    s_cbranch_scc1 pj_36_2
    s_cmp_eq_u32 s21, 3
    s_cbranch_scc1 pj_36_3
pj_36_0:
    ds_write_b128 v1, v[184:187] offset:0
    ds_write_b128 v1, v[188:191] offset:1024
    ds_write_b16 v11, v192 offset:0
    ds_write_b16 v11, v196 offset:1024
    s_branch parked_38
pj_36_1:
    ds_write_b128 v1, v[192:195] offset:0
    ds_write_b128 v1, v[196:199] offset:1024
    ds_write_b16 v11, v200 offset:0
    ds_write_b16 v11, v204 offset:1024
    s_branch parked_38
pj_36_2:
    ds_write_b128 v1, v[200:203] offset:0
    ds_write_b128 v1, v[204:207] offset:1024
    ds_write_b16 v11, v208 offset:0
    ds_write_b16 v11, v212 offset:1024
    s_branch parked_38
pj_36_3:
    ds_write_b128 v1, v[208:211] offset:0
    ds_write_b128 v1, v[212:215] offset:1024
    ds_write_b16 v11, v216 offset:0
    ds_write_b16 v11, v220 offset:1024
    s_branch parked_38
pj_37:
    ds_write_b64 v1, v[218:219] offset:2048
    ds_write_b64 v1, v[222:223] offset:2056
    ds_write_b16 v15, v216 offset:1792
    ds_write_b16 v15, v220 offset:1800
    ds_write_b16 v11, v224 offset:2816
    ds_write_b16 v11, v228 offset:2824
    s_cmp_eq_u32 s21, 1
    s_cbranch_scc1 pj_37_1
    s_cmp_eq_u32 s21, 2
    s_cbranch_scc1 pj_37_2
    s_cmp_eq_u32 s21, 3
    s_cbranch_scc1 pj_37_3
pj_37_0:
    ds_write_b128 v1, v[224:227] offset:0
    ds_write_b128 v1, v[228:231] offset:1024
    ds_write_b16 v11, v232 offset:0
    ds_write_b16 v11, v236 offset:1024
    s_branch parked_38
pj_37_1:
    ds_write_b128 v1, v[232:235] offset:0
    ds_write_b128 v1, v[236:239] offset:1024
    ds_write_b16 v11, v240 offset:0
    ds_write_b16 v11, v244 offset:1024
    s_branch parked_38
pj_37_2:
    ds_write_b128 v1, v[240:243] offset:0
    ds_write_b128 v1, v[244:247] offset:1024
    ds_write_b16 v11, v248 offset:0
    ds_write_b16 v11, v252 offset:1024
    s_branch parked_38
pj_37_3:
    ds_write_b128 v1, v[248:251] offset:0
    ds_write_b128 v1, v[252:255] offset:1024
    ds_write_b16 v11, v184 offset:0
    ds_write_b16 v11, v188 offset:1024
parked_38:
    v_mfma_f32_16x16x32_bf16 v[52:55], v[36:39], v[224:227], v[52:55]
    ds_read_b128 v[20:23], v4 offset:19456
    v_accvgpr_read_b32 v89, a173
    v_mfma_f32_16x16x32_bf16 v[56:59], v[36:39], v[228:231], v[56:59]
    buffer_load_dwordx4 v4, s[12:15], s26 offen offset:3072 sc1 lds
    v_mfma_f32_16x16x32_bf16 v[56:59], v[32:35], v[220:223], v[56:59]
    ds_read_b128 v[24:27], v4 offset:20480
    v_accvgpr_read_b32 v90, a174
    v_mfma_f32_16x16x32_bf16 v[56:59], v[28:31], v[212:215], v[56:59]
    s_waitcnt lgkmcnt(3)
    v_accvgpr_read_b32 v91, a175
    v_cndmask_b32 v84, v84, v85, s[52:53]
    v_mfma_f32_16x16x32_bf16 v[56:59], v[40:43], v[236:239], v[56:59]
    ds_read_b128 v[28:31], v4 offset:21504
    s_add_u32 m0, s27, 77824
    s_add_u32 s26, s26, 4096
    v_mfma_f32_16x16x32_bf16 v[56:59], v[44:47], v[244:247], v[56:59]
    v_cndmask_b32 v88, v88, v89, s[52:53]
    v_cndmask_b32 v84, v84, v86, s[54:55]
    v_mfma_f32_16x16x32_bf16 v[56:59], v[48:51], v[252:255], v[56:59]
    ds_read_b128 v[32:35], v4 offset:22528
    v_cndmask_b32 v88, v88, v90, s[54:55]
    v_mfma_f32_16x16x32_bf16 v[52:55], v[48:51], v[248:251], v[52:55]
    buffer_load_dwordx4 v4, s[12:15], s26 offen offset:0 sc1 lds
    v_mfma_f32_16x16x32_bf16 v[52:55], v[44:47], v[240:243], v[52:55]
    ds_read_b128 v[36:39], v4 offset:23552
    v_cndmask_b32 v84, v84, v87, s[56:57]
    v_cndmask_b32 v88, v88, v91, s[56:57]
    ds_bpermute_b32 v84, v93, v84
    ds_bpermute_b32 v88, v93, v88
hop_1:
    s_cbranch_execz back_1
    v_mfma_f32_16x16x32_bf16 v[52:55], v[40:43], v[232:235], v[52:55]
    s_waitcnt lgkmcnt(5)
    v_mfma_f32_16x16x32_bf16 v[60:63], v[16:19], v[112:115], 0
    ds_read_b128 v[40:43], v4 offset:24576
    v_mfma_f32_16x16x32_bf16 v[60:63], v[20:23], v[120:123], v[60:63]
    s_cmp_lg_u32 s100, 1
    s_cbranch_scc1 nohold_39
    buffer_store_dwordx4 a[208:211], v4, s[12:15], s0 offen sc1
    buffer_store_dwordx4 a[212:215], v4, s[12:15], s1 offen sc1
nohold_39:
    v_mfma_f32_16x16x32_bf16 v[60:63], v[24:27], v[128:131], v[60:63]
    ds_read_b128 v[44:47], v4 offset:25600
    s_waitcnt lgkmcnt(2)
    v_mfma_f32_16x16x32_bf16 v[64:67], v[24:27], v[132:135], 0
    buffer_load_dwordx4 v4, s[12:15], s26 offen offset:1024 sc1 lds
    v_mfma_f32_16x16x32_bf16 v[64:67], v[20:23], v[124:127], v[64:67]
    ds_read_b128 v[48:51], v4 offset:26624
    s_mov_b32 s41, 0x3ae38e39
    v_mfma_f32_16x16x32_bf16 v[64:67], v[16:19], v[116:119], v[64:67]
    v_mov_b32 v92, 0x3727c5ac
    v_fma_f32 v84, v84, s41, v92
    v_mfma_f32_16x16x32_bf16 v[64:67], v[28:31], v[140:143], v[64:67]
    ds_read_b128 v[16:19], v4 offset:27648
    v_fma_f32 v88, v88, s41, v92
    v_mfma_f32_16x16x32_bf16 v[64:67], v[32:35], v[148:151], v[64:67]
    buffer_load_dwordx4 v4, s[12:15], s26 offen offset:2048 sc1 lds
    v_mfma_f32_16x16x32_bf16 v[64:67], v[36:39], v[156:159], v[64:67]
    ds_read_b128 v[20:23], v4 offset:28672
    v_mfma_f32_16x16x32_bf16 v[60:63], v[36:39], v[152:155], v[60:63]
    v_rsq_f32 v7, v84
    v_mfma_f32_16x16x32_bf16 v[60:63], v[32:35], v[144:147], v[60:63]
    ds_read_b128 v[24:27], v4 offset:29696
    v_mul_f32 v7, 0xbfb8aa3b, v7
    v_mfma_f32_16x16x32_bf16 v[60:63], v[28:31], v[136:139], v[60:63]
    s_waitcnt lgkmcnt(3)
    v_rsq_f32 v8, v88
    v_mfma_f32_16x16x32_bf16 v[60:63], v[40:43], v[160:163], v[60:63]
    ds_read_b128 v[28:31], v4 offset:30720
    v_mul_f32 v8, 0xbfb8aa3b, v8
    v_mfma_f32_16x16x32_bf16 v[60:63], v[44:47], v[168:171], v[60:63]
    v_rcp_f32 v9, v84
    v_mfma_f32_16x16x32_bf16 v[60:63], v[48:51], v[176:179], v[60:63]
    ds_read_b128 v[32:35], v4 offset:31744
    v_rcp_f32 v10, v88
    v_mfma_f32_16x16x32_bf16 v[64:67], v[48:51], v[180:183], v[64:67]
    buffer_load_dwordx4 v4, s[12:15], s26 offen offset:3072 sc1 lds
    v_mfma_f32_16x16x32_bf16 v[64:67], v[44:47], v[172:175], v[64:67]
    ds_read_b128 v[36:39], v4 offset:32768
    s_add_u32 m0, s27, 81920
    v_mfma_f32_16x16x32_bf16 v[64:67], v[40:43], v[164:167], v[64:67]
    s_waitcnt lgkmcnt(3)
    s_add_u32 s26, s26, 4096
    v_mul_f32 v84, v7, v52
    v_mfma_f32_16x16x32_bf16 v[64:67], v[16:19], v[188:191], v[64:67]
    ds_read_b128 v[40:43], v4 offset:33792
    v_mul_f32 v85, v7, v53
    v_mfma_f32_16x16x32_bf16 v[64:67], v[20:23], v[196:199], v[64:67]
    buffer_load_dwordx4 v4, s[12:15], s26 offen offset:0 sc1 lds
    v_mfma_f32_16x16x32_bf16 v[64:67], v[24:27], v[204:207], v[64:67]
    ds_read_b128 v[44:47], v4 offset:34816
    s_add_u32 m0, s27, 110592
    v_mfma_f32_16x16x32_bf16 v[60:63], v[24:27], v[200:203], v[60:63]
    s_add_u32 s26, s26, 28672
    v_exp_f32 v84, v84
    v_mfma_f32_16x16x32_bf16 v[60:63], v[20:23], v[192:195], v[60:63]
    ds_read_b128 v[48:51], v4 offset:35840
    s_waitcnt vmcnt(9)
    s_barrier
    v_mfma_f32_16x16x32_bf16 v[60:63], v[16:19], v[184:187], v[60:63]
    s_waitcnt lgkmcnt(3)
    v_exp_f32 v85, v85
    v_mfma_f32_16x16x32_bf16 v[60:63], v[28:31], v[208:211], v[60:63]
    ds_read_b128 v[16:19], v4 offset:36864
    v_mul_f32 v86, v7, v54
    v_mfma_f32_16x16x32_bf16 v[60:63], v[32:35], v[216:219], v[60:63]
    buffer_load_dwordx4 v4, s[12:15], s26 offen offset:0 sc1 lds
    v_mfma_f32_16x16x32_bf16 v[60:63], v[36:39], v[224:227], v[60:63]
    ds_read_b128 v[20:23], v4 offset:37888
    v_mul_f32 v87, v7, v55
    v_mfma_f32_16x16x32_bf16 v[64:67], v[36:39], v[228:231], v[64:67]
    v_exp_f32 v86, v86
    v_mfma_f32_16x16x32_bf16 v[64:67], v[32:35], v[220:223], v[64:67]
    ds_read_b128 v[24:27], v4 offset:38912
    v_add_f32 v84, 1.0, v84
    v_mfma_f32_16x16x32_bf16 v[64:67], v[28:31], v[212:215], v[64:67]
    s_waitcnt lgkmcnt(3)
    v_exp_f32 v87, v87
    v_mfma_f32_16x16x32_bf16 v[64:67], v[40:43], v[236:239], v[64:67]
    ds_read_b128 v[28:31], v4 offset:39936
    v_add_f32 v85, 1.0, v85
    v_mfma_f32_16x16x32_bf16 v[64:67], v[44:47], v[244:247], v[64:67]
    buffer_load_dwordx4 v4, s[12:15], s26 offen offset:1024 sc1 lds
    v_mfma_f32_16x16x32_bf16 v[64:67], v[48:51], v[252:255], v[64:67]
    ds_read_b128 v[32:35], v4 offset:40960
    v_add_f32 v86, 1.0, v86
    v_mfma_f32_16x16x32_bf16 v[60:63], v[48:51], v[248:251], v[60:63]
    v_rcp_f32 v84, v84
    v_mfma_f32_16x16x32_bf16 v[60:63], v[44:47], v[240:243], v[60:63]
    ds_read_b128 v[36:39], v4 offset:41984
    v_add_f32 v87, 1.0, v87
    v_mfma_f32_16x16x32_bf16 v[60:63], v[40:43], v[232:235], v[60:63]
    s_waitcnt lgkmcnt(3)
    v_rcp_f32 v85, v85
    v_mfma_f32_16x16x32_bf16 v[68:71], v[16:19], v[112:115], 0
    ds_read_b128 v[40:43], v4 offset:43008
    v_mul_f32 v52, v84, v52
    v_mfma_f32_16x16x32_bf16 v[68:71], v[20:23], v[120:123], v[68:71]
    buffer_load_dwordx4 v4, s[12:15], s26 offen offset:2048 sc1 lds
    v_mfma_f32_16x16x32_bf16 v[68:71], v[24:27], v[128:131], v[68:71]
    ds_read_b128 v[44:47], v4 offset:44032
    v_mul_f32 v53, v85, v53
    v_mfma_f32_16x16x32_bf16 v[72:75], v[24:27], v[132:135], 0
    v_rcp_f32 v86, v86
    v_mfma_f32_16x16x32_bf16 v[72:75], v[20:23], v[124:127], v[72:75]
    ds_read_b128 v[48:51], v4 offset:45056
    v_mul_f32 v54, v86, v54
    v_mfma_f32_16x16x32_bf16 v[72:75], v[16:19], v[116:119], v[72:75]
    s_waitcnt lgkmcnt(3)
    v_rcp_f32 v87, v87
    v_mfma_f32_16x16x32_bf16 v[72:75], v[28:31], v[140:143], v[72:75]
    ds_read_b128 v[16:19], v4 offset:46080
    v_mul_f32 v55, v87, v55
    v_mfma_f32_16x16x32_bf16 v[72:75], v[32:35], v[148:151], v[72:75]
    buffer_load_dwordx4 v4, s[12:15], s26 offen offset:3072 sc1 lds
    v_mfma_f32_16x16x32_bf16 v[72:75], v[36:39], v[156:159], v[72:75]
    ds_read_b128 v[20:23], v4 offset:47104
    s_add_u32 m0, s27, 114688
    v_mfma_f32_16x16x32_bf16 v[68:71], v[36:39], v[152:155], v[68:71]
    s_cmp_lg_u32 s100, 1
    s_cbranch_scc1 nohold_40
    buffer_store_dwordx4 a[216:219], v4, s[12:15], s4 offen sc1
    buffer_store_dwordx4 a[220:223], v4, s[12:15], s5 offen sc1
nohold_40:
    v_mfma_f32_16x16x32_bf16 v[68:71], v[32:35], v[144:147], v[68:71]
    ds_read_b128 v[24:27], v4 offset:48128
    s_add_u32 s26, s26, 4096
    v_mfma_f32_16x16x32_bf16 v[68:71], v[28:31], v[136:139], v[68:71]
    s_waitcnt lgkmcnt(3)
    v_mul_f32 v88, v8, v56
    v_mul_f32 v89, v8, v57
    v_mfma_f32_16x16x32_bf16 v[68:71], v[40:43], v[160:163], v[68:71]
    ds_read_b128 v[28:31], v4 offset:49152
    v_mul_f32 v90, v8, v58
    v_mfma_f32_16x16x32_bf16 v[68:71], v[44:47], v[168:171], v[68:71]
    buffer_load_dwordx4 v4, s[12:15], s26 offen offset:0 sc1 lds
    v_mfma_f32_16x16x32_bf16 v[68:71], v[48:51], v[176:179], v[68:71]
    ds_read_b128 v[32:35], v4 offset:50176
    v_mul_f32 v91, v8, v59
    v_mfma_f32_16x16x32_bf16 v[72:75], v[48:51], v[180:183], v[72:75]
    v_exp_f32 v88, v88
    v_mfma_f32_16x16x32_bf16 v[72:75], v[44:47], v[172:175], v[72:75]
    ds_read_b128 v[36:39], v4 offset:51200
    v_add_f32 v88, 1.0, v88
    v_mfma_f32_16x16x32_bf16 v[72:75], v[40:43], v[164:167], v[72:75]
    s_waitcnt lgkmcnt(3)
    v_exp_f32 v89, v89
    v_mfma_f32_16x16x32_bf16 v[72:75], v[16:19], v[188:191], v[72:75]
    ds_read_b128 v[40:43], v4 offset:52224
    v_add_f32 v89, 1.0, v89
    v_mfma_f32_16x16x32_bf16 v[72:75], v[20:23], v[196:199], v[72:75]
    buffer_load_dwordx4 v4, s[12:15], s26 offen offset:1024 sc1 lds
    v_mfma_f32_16x16x32_bf16 v[72:75], v[24:27], v[204:207], v[72:75]
    ds_read_b128 v[44:47], v4 offset:53248
    v_mul_f32 v60, v52, v60
    v_mfma_f32_16x16x32_bf16 v[68:71], v[24:27], v[200:203], v[68:71]
    v_exp_f32 v90, v90
    v_mfma_f32_16x16x32_bf16 v[68:71], v[20:23], v[192:195], v[68:71]
    ds_read_b128 v[48:51], v4 offset:54272
    v_add_f32 v90, 1.0, v90
    v_mfma_f32_16x16x32_bf16 v[68:71], v[16:19], v[184:187], v[68:71]
    s_waitcnt lgkmcnt(3)
    v_exp_f32 v91, v91
    v_mfma_f32_16x16x32_bf16 v[68:71], v[28:31], v[208:211], v[68:71]
    ds_read_b128 v[16:19], v4 offset:55296
    v_add_f32 v91, 1.0, v91
    v_mfma_f32_16x16x32_bf16 v[68:71], v[32:35], v[216:219], v[68:71]
    buffer_load_dwordx4 v4, s[12:15], s26 offen offset:2048 sc1 lds
    v_mfma_f32_16x16x32_bf16 v[68:71], v[36:39], v[224:227], v[68:71]
    ds_read_b128 v[20:23], v4 offset:56320
    v_mul_f32 v61, v53, v61
    v_mfma_f32_16x16x32_bf16 v[72:75], v[36:39], v[228:231], v[72:75]
    v_rcp_f32 v88, v88
    v_mfma_f32_16x16x32_bf16 v[72:75], v[32:35], v[220:223], v[72:75]
    ds_read_b128 v[24:27], v4 offset:57344
    v_mul_f32 v56, v88, v56
    v_mfma_f32_16x16x32_bf16 v[72:75], v[28:31], v[212:215], v[72:75]
    s_waitcnt lgkmcnt(3)
    v_rcp_f32 v89, v89
    v_mfma_f32_16x16x32_bf16 v[72:75], v[40:43], v[236:239], v[72:75]
    ds_read_b128 v[28:31], v4 offset:58368
    v_mul_f32 v57, v89, v57
    v_mfma_f32_16x16x32_bf16 v[72:75], v[44:47], v[244:247], v[72:75]
    buffer_load_dwordx4 v4, s[12:15], s26 offen offset:3072 sc1 lds
    v_mfma_f32_16x16x32_bf16 v[72:75], v[48:51], v[252:255], v[72:75]
    ds_read_b128 v[32:35], v4 offset:59392
    s_add_u32 m0, s27, 118784
    v_mfma_f32_16x16x32_bf16 v[68:71], v[48:51], v[248:251], v[68:71]
    s_add_u32 s26, s26, 4096
    v_rcp_f32 v90, v90
    v_mfma_f32_16x16x32_bf16 v[68:71], v[44:47], v[240:243], v[68:71]
    ds_read_b128 v[36:39], v4 offset:60416
    v_mul_f32 v58, v90, v58
    v_mfma_f32_16x16x32_bf16 v[68:71], v[40:43], v[232:235], v[68:71]
    s_waitcnt lgkmcnt(3)
    v_rcp_f32 v91, v91
    v_mfma_f32_16x16x32_bf16 v[76:79], v[16:19], v[112:115], 0
    ds_read_b128 v[40:43], v4 offset:61440
    v_mul_f32 v59, v91, v59
    v_mfma_f32_16x16x32_bf16 v[76:79], v[20:23], v[120:123], v[76:79]
    buffer_load_dwordx4 v4, s[12:15], s26 offen offset:0 sc1 lds
    v_mfma_f32_16x16x32_bf16 v[76:79], v[24:27], v[128:131], v[76:79]
    ds_read_b128 v[44:47], v4 offset:62464
    v_mul_f32 v62, v54, v62
    v_mfma_f32_16x16x32_bf16 v[80:83], v[24:27], v[132:135], 0
    v_mul_f32 v63, v55, v63
    v_cvt_pk_bf16_f32 v60, v60, v61
    v_mfma_f32_16x16x32_bf16 v[80:83], v[20:23], v[124:127], v[80:83]
    ds_read_b128 v[48:51], v4 offset:63488
    v_cvt_pk_bf16_f32 v62, v62, v63
    v_mfma_f32_16x16x32_bf16 v[80:83], v[16:19], v[116:119], v[80:83]
    s_waitcnt lgkmcnt(3)
    v_accvgpr_write_b32 a0, v60
    v_accvgpr_write_b32 a1, v62
    v_mfma_f32_16x16x32_bf16 v[80:83], v[28:31], v[140:143], v[80:83]
    ds_read_b128 v[16:19], v4 offset:64512
    v_mul_f32 v64, v56, v64
    v_mfma_f32_16x16x32_bf16 v[80:83], v[32:35], v[148:151], v[80:83]
    v_mul_f32 v84, v7, v68
    v_mul_f32 v65, v57, v65
    v_mfma_f32_16x16x32_bf16 v[80:83], v[36:39], v[156:159], v[80:83]
    ds_read_b128 v[20:23], v5 offset:0
    v_mul_f32 v66, v58, v66
    v_mfma_f32_16x16x32_bf16 v[76:79], v[36:39], v[152:155], v[76:79]
    v_exp_f32 v84, v84
    v_mfma_f32_16x16x32_bf16 v[76:79], v[32:35], v[144:147], v[76:79]
    ds_read_b128 v[24:27], v5 offset:1024
    v_mul_f32 v67, v59, v67
    v_mfma_f32_16x16x32_bf16 v[76:79], v[28:31], v[136:139], v[76:79]
    s_waitcnt lgkmcnt(3)
    v_mul_f32 v85, v7, v69
    v_cvt_pk_bf16_f32 v64, v64, v65
    v_mfma_f32_16x16x32_bf16 v[76:79], v[40:43], v[160:163], v[76:79]
    ds_read_b128 v[28:31], v5 offset:2048
    v_cvt_pk_bf16_f32 v66, v66, v67
    v_mfma_f32_16x16x32_bf16 v[76:79], v[44:47], v[168:171], v[76:79]
    s_cmp_lg_u32 s100, 1
    s_cbranch_scc1 nohold_41
    buffer_store_dwordx4 a[224:227], v4, s[12:15], s6 offen sc1
    buffer_store_dwordx4 a[228:231], v4, s[12:15], s7 offen sc1
nohold_41:
    v_mfma_f32_16x16x32_bf16 v[76:79], v[48:51], v[176:179], v[76:79]
    ds_read_b128 v[32:35], v5 offset:3072
    v_accvgpr_write_b32 a4, v64
    v_mfma_f32_16x16x32_bf16 v[80:83], v[48:51], v[180:183], v[80:83]
    v_exp_f32 v85, v85
    v_mfma_f32_16x16x32_bf16 v[80:83], v[44:47], v[172:175], v[80:83]
    ds_read_b128 v[36:39], v5 offset:4096
    v_mul_f32 v86, v7, v70
    v_mfma_f32_16x16x32_bf16 v[80:83], v[40:43], v[164:167], v[80:83]
    s_waitcnt lgkmcnt(3)
    v_exp_f32 v86, v86
    v_mfma_f32_16x16x32_bf16 v[80:83], v[16:19], v[188:191], v[80:83]
    ds_read_b128 v[40:43], v5 offset:5120
    v_accvgpr_write_b32 a5, v66
    v_mfma_f32_16x16x32_bf16 v[80:83], v[20:23], v[196:199], v[80:83]
    v_mul_f32 v87, v7, v71
    v_add_f32 v84, 1.0, v84
    v_mfma_f32_16x16x32_bf16 v[80:83], v[24:27], v[204:207], v[80:83]
    ds_read_b128 v[44:47], v5 offset:6144
    s_add_u32 m0, s27, 0
    v_mfma_f32_16x16x32_bf16 v[76:79], v[24:27], v[200:203], v[76:79]
    s_add_u32 s26, s26, 28672
    v_exp_f32 v87, v87
    v_mfma_f32_16x16x32_bf16 v[76:79], v[20:23], v[192:195], v[76:79]
    ds_read_b128 v[48:51], v5 offset:7168
    s_waitcnt vmcnt(9)
    s_barrier
    v_mfma_f32_16x16x32_bf16 v[76:79], v[16:19], v[184:187], v[76:79]
    s_waitcnt lgkmcnt(3)
    v_rcp_f32 v84, v84
    v_mfma_f32_16x16x32_bf16 v[76:79], v[28:31], v[208:211], v[76:79]
    ds_read_b128 v[16:19], v5 offset:8192
    v_add_f32 v85, 1.0, v85
    v_mfma_f32_16x16x32_bf16 v[76:79], v[32:35], v[216:219], v[76:79]
    buffer_load_dwordx4 v4, s[12:15], s26 offen offset:0 sc1 lds
    v_mfma_f32_16x16x32_bf16 v[76:79], v[36:39], v[224:227], v[76:79]
    ds_read_b128 v[20:23], v5 offset:9216
    v_add_f32 v86, 1.0, v86
    v_mfma_f32_16x16x32_bf16 v[80:83], v[36:39], v[228:231], v[80:83]
    v_rcp_f32 v85, v85
    v_mfma_f32_16x16x32_bf16 v[80:83], v[32:35], v[220:223], v[80:83]
    ds_read_b128 v[24:27], v5 offset:10240
    v_add_f32 v87, 1.0, v87
    v_mfma_f32_16x16x32_bf16 v[80:83], v[28:31], v[212:215], v[80:83]
    s_waitcnt lgkmcnt(3)
    v_rcp_f32 v86, v86
    v_mfma_f32_16x16x32_bf16 v[80:83], v[40:43], v[236:239], v[80:83]
    ds_read_b128 v[28:31], v5 offset:11264
    v_mul_f32 v68, v84, v68
    v_mfma_f32_16x16x32_bf16 v[80:83], v[44:47], v[244:247], v[80:83]
    buffer_load_dwordx4 v4, s[12:15], s26 offen offset:1024 sc1 lds
    v_mfma_f32_16x16x32_bf16 v[80:83], v[48:51], v[252:255], v[80:83]
    ds_read_b128 v[32:35], v5 offset:12288
    v_mul_f32 v69, v85, v69
    v_mfma_f32_16x16x32_bf16 v[76:79], v[48:51], v[248:251], v[76:79]
    v_rcp_f32 v87, v87
    v_mfma_f32_16x16x32_bf16 v[76:79], v[44:47], v[240:243], v[76:79]
    ds_read_b128 v[36:39], v5 offset:13312
    v_mul_f32 v70, v86, v70
    v_mfma_f32_16x16x32_bf16 v[76:79], v[40:43], v[232:235], v[76:79]
    s_waitcnt lgkmcnt(3)
    v_mul_f32 v71, v87, v71
    v_mul_f32 v88, v8, v72
    v_mfma_f32_16x16x32_bf16 v[52:55], v[16:19], v[112:115], 0
    ds_read_b128 v[40:43], v5 offset:14336
    v_mul_f32 v89, v8, v73
    v_mfma_f32_16x16x32_bf16 v[52:55], v[20:23], v[120:123], v[52:55]
    buffer_load_dwordx4 v4, s[12:15], s26 offen offset:2048 sc1 lds
    v_mfma_f32_16x16x32_bf16 v[52:55], v[24:27], v[128:131], v[52:55]
    ds_read_b128 v[44:47], v5 offset:15360
    v_mul_f32 v90, v8, v74
    v_mfma_f32_16x16x32_bf16 v[56:59], v[24:27], v[132:135], 0
    v_exp_f32 v88, v88
    v_mfma_f32_16x16x32_bf16 v[56:59], v[20:23], v[124:127], v[56:59]
    ds_read_b128 v[48:51], v5 offset:16384
    v_mul_f32 v91, v8, v75
    v_mfma_f32_16x16x32_bf16 v[56:59], v[16:19], v[116:119], v[56:59]
    s_waitcnt lgkmcnt(3)
    v_exp_f32 v89, v89
    v_mfma_f32_16x16x32_bf16 v[56:59], v[28:31], v[140:143], v[56:59]
    ds_read_b128 v[16:19], v5 offset:17408
    v_add_f32 v88, 1.0, v88
    v_mfma_f32_16x16x32_bf16 v[56:59], v[32:35], v[148:151], v[56:59]
    buffer_load_dwordx4 v4, s[12:15], s26 offen offset:3072 sc1 lds
    v_mfma_f32_16x16x32_bf16 v[56:59], v[36:39], v[156:159], v[56:59]
    ds_read_b128 v[20:23], v5 offset:18432
    s_add_u32 m0, s27, 4096
    v_mfma_f32_16x16x32_bf16 v[52:55], v[36:39], v[152:155], v[52:55]
    s_add_u32 s26, s26, 4096
    v_exp_f32 v90, v90
    v_mfma_f32_16x16x32_bf16 v[52:55], v[32:35], v[144:147], v[52:55]
    ds_read_b128 v[24:27], v5 offset:19456
    v_add_f32 v89, 1.0, v89
    v_mfma_f32_16x16x32_bf16 v[52:55], v[28:31], v[136:139], v[52:55]
    s_waitcnt lgkmcnt(3)
    v_exp_f32 v91, v91
    v_mfma_f32_16x16x32_bf16 v[52:55], v[40:43], v[160:163], v[52:55]
    ds_read_b128 v[28:31], v5 offset:20480
    v_add_f32 v90, 1.0, v90
    v_mfma_f32_16x16x32_bf16 v[52:55], v[44:47], v[168:171], v[52:55]
    buffer_load_dwordx4 v4, s[12:15], s26 offen offset:0 sc1 lds
    v_mfma_f32_16x16x32_bf16 v[52:55], v[48:51], v[176:179], v[52:55]
    ds_read_b128 v[32:35], v5 offset:21504
    v_add_f32 v91, 1.0, v91
    v_mfma_f32_16x16x32_bf16 v[56:59], v[48:51], v[180:183], v[56:59]
    v_rcp_f32 v88, v88
    v_mfma_f32_16x16x32_bf16 v[56:59], v[44:47], v[172:175], v[56:59]
    ds_read_b128 v[36:39], v5 offset:22528
    v_mul_f32 v72, v88, v72
    v_mfma_f32_16x16x32_bf16 v[56:59], v[40:43], v[164:167], v[56:59]
    s_waitcnt lgkmcnt(3)
    v_rcp_f32 v89, v89
    v_mfma_f32_16x16x32_bf16 v[56:59], v[16:19], v[188:191], v[56:59]
    ds_read_b128 v[40:43], v5 offset:23552
    v_mul_f32 v73, v89, v73
    v_mfma_f32_16x16x32_bf16 v[56:59], v[20:23], v[196:199], v[56:59]
    buffer_load_dwordx4 v4, s[12:15], s26 offen offset:1024 sc1 lds
    v_mfma_f32_16x16x32_bf16 v[56:59], v[24:27], v[204:207], v[56:59]
    ds_read_b128 v[44:47], v5 offset:24576
    v_mul_f32 v76, v68, v76
    v_mfma_f32_16x16x32_bf16 v[52:55], v[24:27], v[200:203], v[52:55]
    s_cmp_lg_u32 s100, 1
    s_cbranch_scc1 nohold_42
    buffer_store_dwordx4 a[232:235], v4, s[12:15], s50 offen sc1
    buffer_store_dwordx4 a[236:239], v4, s[12:15], s51 offen sc1
nohold_42:
    v_mfma_f32_16x16x32_bf16 v[52:55], v[20:23], v[192:195], v[52:55]
    ds_read_b128 v[48:51], v5 offset:25600
    v_mul_f32 v77, v69, v77
    v_mfma_f32_16x16x32_bf16 v[52:55], v[16:19], v[184:187], v[52:55]
    s_waitcnt lgkmcnt(3)
    v_rcp_f32 v90, v90
    v_mfma_f32_16x16x32_bf16 v[52:55], v[28:31], v[208:211], v[52:55]
    ds_read_b128 v[16:19], v5 offset:26624
    v_mul_f32 v74, v90, v74
    v_mfma_f32_16x16x32_bf16 v[52:55], v[32:35], v[216:219], v[52:55]
    buffer_load_dwordx4 v4, s[12:15], s26 offen offset:2048 sc1 lds
    v_mfma_f32_16x16x32_bf16 v[52:55], v[36:39], v[224:227], v[52:55]
    ds_read_b128 v[20:23], v5 offset:27648
    v_mul_f32 v78, v70, v78
    v_mfma_f32_16x16x32_bf16 v[56:59], v[36:39], v[228:231], v[56:59]
    v_rcp_f32 v91, v91
    v_mfma_f32_16x16x32_bf16 v[56:59], v[32:35], v[220:223], v[56:59]
    ds_read_b128 v[24:27], v5 offset:28672
    v_mul_f32 v75, v91, v75
    v_mfma_f32_16x16x32_bf16 v[56:59], v[28:31], v[212:215], v[56:59]
    s_waitcnt lgkmcnt(3)
    v_mul_f32 v79, v71, v79
    v_cvt_pk_bf16_f32 v76, v76, v77
    v_mfma_f32_16x16x32_bf16 v[56:59], v[40:43], v[236:239], v[56:59]
    ds_read_b128 v[28:31], v5 offset:29696
    v_cvt_pk_bf16_f32 v78, v78, v79
    v_mfma_f32_16x16x32_bf16 v[56:59], v[44:47], v[244:247], v[56:59]
    buffer_load_dwordx4 v4, s[12:15], s26 offen offset:3072 sc1 lds
    v_mfma_f32_16x16x32_bf16 v[56:59], v[48:51], v[252:255], v[56:59]
    ds_read_b128 v[32:35], v5 offset:30720
    s_add_u32 m0, s27, 8192
    v_mfma_f32_16x16x32_bf16 v[52:55], v[48:51], v[248:251], v[52:55]
    s_add_u32 s26, s26, 4096
    v_accvgpr_write_b32 a2, v76
    v_accvgpr_write_b32 a3, v78
    v_mfma_f32_16x16x32_bf16 v[52:55], v[44:47], v[240:243], v[52:55]
    ds_read_b128 v[36:39], v5 offset:31744
    v_mul_f32 v80, v72, v80
    v_mfma_f32_16x16x32_bf16 v[52:55], v[40:43], v[232:235], v[52:55]
    s_waitcnt lgkmcnt(3)
    v_mul_f32 v81, v73, v81
    v_mul_f32 v82, v74, v82
    v_mfma_f32_16x16x32_bf16 v[60:63], v[16:19], v[112:115], 0
    ds_read_b128 v[40:43], v5 offset:32768
    v_mul_f32 v83, v75, v83
    v_mfma_f32_16x16x32_bf16 v[60:63], v[20:23], v[120:123], v[60:63]
    buffer_load_dwordx4 v4, s[12:15], s26 offen offset:0 sc1 lds
    v_mfma_f32_16x16x32_bf16 v[60:63], v[24:27], v[128:131], v[60:63]
    ds_read_b128 v[44:47], v5 offset:33792
    v_cvt_pk_bf16_f32 v80, v80, v81
    v_mfma_f32_16x16x32_bf16 v[64:67], v[24:27], v[132:135], 0
    v_mul_f32 v84, v7, v52
    v_cvt_pk_bf16_f32 v82, v82, v83
    v_mfma_f32_16x16x32_bf16 v[64:67], v[20:23], v[124:127], v[64:67]
    ds_read_b128 v[48:51], v5 offset:34816
    v_accvgpr_write_b32 a6, v80
    v_mfma_f32_16x16x32_bf16 v[64:67], v[16:19], v[116:119], v[64:67]
    s_waitcnt lgkmcnt(3)
    v_exp_f32 v84, v84
    v_mfma_f32_16x16x32_bf16 v[64:67], v[28:31], v[140:143], v[64:67]
    ds_read_b128 v[16:19], v5 offset:35840
    v_accvgpr_write_b32 a7, v82
    v_mfma_f32_16x16x32_bf16 v[64:67], v[32:35], v[148:151], v[64:67]
    v_mul_f32 v85, v7, v53
    v_mul_f32 v86, v7, v54
    v_mfma_f32_16x16x32_bf16 v[64:67], v[36:39], v[156:159], v[64:67]
    ds_read_b128 v[20:23], v5 offset:36864
    v_mul_f32 v87, v7, v55
    v_mfma_f32_16x16x32_bf16 v[60:63], v[36:39], v[152:155], v[60:63]
    v_exp_f32 v85, v85
    v_mfma_f32_16x16x32_bf16 v[60:63], v[32:35], v[144:147], v[60:63]
    ds_read_b128 v[24:27], v5 offset:37888
    v_add_f32 v84, 1.0, v84
    v_mfma_f32_16x16x32_bf16 v[60:63], v[28:31], v[136:139], v[60:63]
    s_waitcnt lgkmcnt(3)
    v_exp_f32 v86, v86
    v_mfma_f32_16x16x32_bf16 v[60:63], v[40:43], v[160:163], v[60:63]
    ds_read_b128 v[28:31], v5 offset:38912
    v_add_f32 v85, 1.0, v85
    v_mfma_f32_16x16x32_bf16 v[60:63], v[44:47], v[168:171], v[60:63]
    s_cmp_lg_u32 s100, 3
    s_cbranch_scc1 nohold_43
    v_accvgpr_read_b32 v15, a212
    s_mov_b64 exec, 0xffff
    buffer_store_dwordx4 a[208:211], v15, s[12:15], 0 offen sc1
    s_mov_b64 exec, -1
nohold_43:
    v_mfma_f32_16x16x32_bf16 v[60:63], v[48:51], v[176:179], v[60:63]
    ds_read_b128 v[32:35], v5 offset:39936
    v_add_f32 v86, 1.0, v86
    v_mfma_f32_16x16x32_bf16 v[64:67], v[48:51], v[180:183], v[64:67]
    v_exp_f32 v87, v87
    v_mfma_f32_16x16x32_bf16 v[64:67], v[44:47], v[172:175], v[64:67]
    ds_read_b128 v[36:39], v5 offset:40960
    v_add_f32 v87, 1.0, v87
    v_mfma_f32_16x16x32_bf16 v[64:67], v[40:43], v[164:167], v[64:67]
    s_waitcnt lgkmcnt(3)
    v_rcp_f32 v84, v84
    v_mfma_f32_16x16x32_bf16 v[64:67], v[16:19], v[188:191], v[64:67]
    ds_read_b128 v[40:43], v5 offset:41984
    v_mul_f32 v52, v84, v52
    v_mfma_f32_16x16x32_bf16 v[64:67], v[20:23], v[196:199], v[64:67]
    buffer_store_dwordx4 a[0:3], v4, s[12:15], s28 offen offset:0 sc1
    v_mfma_f32_16x16x32_bf16 v[64:67], v[24:27], v[204:207], v[64:67]
    ds_read_b128 v[44:47], v5 offset:43008
    s_add_u32 m0, s27, 36864
    v_mfma_f32_16x16x32_bf16 v[60:63], v[24:27], v[200:203], v[60:63]
    s_add_u32 s26, s26, 28672
    v_rcp_f32 v85, v85
    v_mfma_f32_16x16x32_bf16 v[60:63], v[20:23], v[192:195], v[60:63]
    ds_read_b128 v[48:51], v5 offset:44032
    s_waitcnt vmcnt(10)
    s_barrier
    v_mfma_f32_16x16x32_bf16 v[60:63], v[16:19], v[184:187], v[60:63]
    s_waitcnt lgkmcnt(3)
    v_rcp_f32 v86, v86
    v_mfma_f32_16x16x32_bf16 v[60:63], v[28:31], v[208:211], v[60:63]
    ds_read_b128 v[16:19], v5 offset:45056
    v_mul_f32 v53, v85, v53
    v_mfma_f32_16x16x32_bf16 v[60:63], v[32:35], v[216:219], v[60:63]
    buffer_load_dwordx4 v4, s[12:15], s26 offen offset:0 sc1 lds
    v_mfma_f32_16x16x32_bf16 v[60:63], v[36:39], v[224:227], v[60:63]
    ds_read_b128 v[20:23], v5 offset:46080
    v_mul_f32 v54, v86, v54
    v_mfma_f32_16x16x32_bf16 v[64:67], v[36:39], v[228:231], v[64:67]
    v_rcp_f32 v87, v87
    v_mfma_f32_16x16x32_bf16 v[64:67], v[32:35], v[220:223], v[64:67]
    ds_read_b128 v[24:27], v5 offset:47104
    v_mul_f32 v55, v87, v55
    v_mfma_f32_16x16x32_bf16 v[64:67], v[28:31], v[212:215], v[64:67]
    s_waitcnt lgkmcnt(3)
    v_mul_f32 v88, v8, v56
    v_mul_f32 v89, v8, v57
    v_mfma_f32_16x16x32_bf16 v[64:67], v[40:43], v[236:239], v[64:67]
    ds_read_b128 v[28:31], v5 offset:48128
    v_mul_f32 v90, v8, v58
    v_mfma_f32_16x16x32_bf16 v[64:67], v[44:47], v[244:247], v[64:67]
    buffer_load_dwordx4 v4, s[12:15], s26 offen offset:1024 sc1 lds
    v_mfma_f32_16x16x32_bf16 v[64:67], v[48:51], v[252:255], v[64:67]
    ds_read_b128 v[32:35], v5 offset:49152
    v_mul_f32 v91, v8, v59
    v_mfma_f32_16x16x32_bf16 v[60:63], v[48:51], v[248:251], v[60:63]
    v_exp_f32 v88, v88
    v_mfma_f32_16x16x32_bf16 v[60:63], v[44:47], v[240:243], v[60:63]
    ds_read_b128 v[36:39], v5 offset:50176
    v_add_f32 v88, 1.0, v88
    v_mfma_f32_16x16x32_bf16 v[60:63], v[40:43], v[232:235], v[60:63]
    s_waitcnt lgkmcnt(3)
    v_exp_f32 v89, v89
    v_mfma_f32_16x16x32_bf16 v[68:71], v[16:19], v[112:115], 0
    ds_read_b128 v[40:43], v5 offset:51200
    v_add_f32 v89, 1.0, v89
    v_mfma_f32_16x16x32_bf16 v[68:71], v[20:23], v[120:123], v[68:71]
    buffer_load_dwordx4 v4, s[12:15], s26 offen offset:2048 sc1 lds
    v_mfma_f32_16x16x32_bf16 v[68:71], v[24:27], v[128:131], v[68:71]
    ds_read_b128 v[44:47], v5 offset:52224
    v_mfma_f32_16x16x32_bf16 v[72:75], v[24:27], v[132:135], 0
    v_exp_f32 v90, v90
    v_mfma_f32_16x16x32_bf16 v[72:75], v[20:23], v[124:127], v[72:75]
    ds_read_b128 v[48:51], v5 offset:53248
    v_add_f32 v90, 1.0, v90
    v_mfma_f32_16x16x32_bf16 v[72:75], v[16:19], v[116:119], v[72:75]
    s_waitcnt lgkmcnt(3)
    v_exp_f32 v91, v91
    v_mfma_f32_16x16x32_bf16 v[72:75], v[28:31], v[140:143], v[72:75]
    ds_read_b128 v[16:19], v5 offset:54272
    v_add_f32 v91, 1.0, v91
    v_mfma_f32_16x16x32_bf16 v[72:75], v[32:35], v[148:151], v[72:75]
    buffer_load_dwordx4 v4, s[12:15], s26 offen offset:3072 sc1 lds
    v_mfma_f32_16x16x32_bf16 v[72:75], v[36:39], v[156:159], v[72:75]
    ds_read_b128 v[20:23], v5 offset:55296
    s_add_u32 m0, s27, 40960
    v_mfma_f32_16x16x32_bf16 v[68:71], v[36:39], v[152:155], v[68:71]
    s_add_u32 s26, s26, 4096
    v_rcp_f32 v88, v88
    v_mfma_f32_16x16x32_bf16 v[68:71], v[32:35], v[144:147], v[68:71]
    ds_read_b128 v[24:27], v5 offset:56320
    v_mul_f32 v56, v88, v56
    v_mfma_f32_16x16x32_bf16 v[68:71], v[28:31], v[136:139], v[68:71]
    s_waitcnt lgkmcnt(3)
    v_rcp_f32 v89, v89
    v_mfma_f32_16x16x32_bf16 v[68:71], v[40:43], v[160:163], v[68:71]
    ds_read_b128 v[28:31], v5 offset:57344
    v_mul_f32 v57, v89, v57
    v_mfma_f32_16x16x32_bf16 v[68:71], v[44:47], v[168:171], v[68:71]
    buffer_load_dwordx4 v4, s[12:15], s26 offen offset:0 sc1 lds
    v_mfma_f32_16x16x32_bf16 v[68:71], v[48:51], v[176:179], v[68:71]
    ds_read_b128 v[32:35], v5 offset:58368
    v_mul_f32 v60, v52, v60
    v_mfma_f32_16x16x32_bf16 v[72:75], v[48:51], v[180:183], v[72:75]
    v_rcp_f32 v90, v90
    v_mfma_f32_16x16x32_bf16 v[72:75], v[44:47], v[172:175], v[72:75]
    ds_read_b128 v[36:39], v5 offset:59392
    v_mul_f32 v58, v90, v58
    v_mfma_f32_16x16x32_bf16 v[72:75], v[40:43], v[164:167], v[72:75]
    s_waitcnt lgkmcnt(3)
    v_rcp_f32 v91, v91
    v_mfma_f32_16x16x32_bf16 v[72:75], v[16:19], v[188:191], v[72:75]
    ds_read_b128 v[40:43], v5 offset:60416
    v_mul_f32 v59, v91, v59
    v_mfma_f32_16x16x32_bf16 v[72:75], v[20:23], v[196:199], v[72:75]
    buffer_load_dwordx4 v4, s[12:15], s26 offen offset:1024 sc1 lds
    v_mfma_f32_16x16x32_bf16 v[72:75], v[24:27], v[204:207], v[72:75]
    ds_read_b128 v[44:47], v5 offset:61440
    v_mul_f32 v61, v53, v61
    v_mfma_f32_16x16x32_bf16 v[68:71], v[24:27], v[200:203], v[68:71]
    v_mul_f32 v62, v54, v62
    v_mul_f32 v63, v55, v63
    v_mfma_f32_16x16x32_bf16 v[68:71], v[20:23], v[192:195], v[68:71]
    ds_read_b128 v[48:51], v5 offset:62464
    v_cvt_pk_bf16_f32 v60, v60, v61
    v_mfma_f32_16x16x32_bf16 v[68:71], v[16:19], v[184:187], v[68:71]
    s_waitcnt lgkmcnt(3)
    v_cvt_pk_bf16_f32 v62, v62, v63
    v_accvgpr_write_b32 a32, v60
    v_mfma_f32_16x16x32_bf16 v[68:71], v[28:31], v[208:211], v[68:71]
    ds_read_b128 v[16:19], v5 offset:63488
    v_accvgpr_write_b32 a33, v62
    v_mfma_f32_16x16x32_bf16 v[68:71], v[32:35], v[216:219], v[68:71]
    buffer_load_dwordx4 v4, s[12:15], s26 offen offset:2048 sc1 lds
    v_mfma_f32_16x16x32_bf16 v[68:71], v[36:39], v[224:227], v[68:71]
    ds_read_b128 v[20:23], v5 offset:64512
    v_mul_f32 v64, v56, v64
    v_mfma_f32_16x16x32_bf16 v[72:75], v[36:39], v[228:231], v[72:75]
    s_cmp_lg_u32 s100, 2
    s_cbranch_scc1 nohold_44
    buffer_store_dwordx4 a[208:211], v4, s[12:15], s0 offen sc1
    buffer_store_dwordx4 a[212:215], v4, s[12:15], s1 offen sc1
nohold_44:
    v_mfma_f32_16x16x32_bf16 v[72:75], v[32:35], v[220:223], v[72:75]
    ds_read_b128 v[24:27], v6 offset:0
    v_mul_f32 v65, v57, v65
    v_mfma_f32_16x16x32_bf16 v[72:75], v[28:31], v[212:215], v[72:75]
    s_waitcnt lgkmcnt(3)
    v_mul_f32 v66, v58, v66
    v_mul_f32 v67, v59, v67
    v_mfma_f32_16x16x32_bf16 v[72:75], v[40:43], v[236:239], v[72:75]
    ds_read_b128 v[28:31], v6 offset:1024
    v_cvt_pk_bf16_f32 v64, v64, v65
    v_mfma_f32_16x16x32_bf16 v[72:75], v[44:47], v[244:247], v[72:75]
    buffer_load_dwordx4 v4, s[12:15], s26 offen offset:3072 sc1 lds
    v_mfma_f32_16x16x32_bf16 v[72:75], v[48:51], v[252:255], v[72:75]
    ds_read_b128 v[32:35], v6 offset:2048
    s_add_u32 m0, s27, 45056
hop_2:
    s_cbranch_execz back_2
    v_mfma_f32_16x16x32_bf16 v[68:71], v[48:51], v[248:251], v[68:71]
    s_add_u32 s26, s26, 4096
    v_cvt_pk_bf16_f32 v66, v66, v67
    v_accvgpr_write_b32 a36, v64
    v_mfma_f32_16x16x32_bf16 v[68:71], v[44:47], v[240:243], v[68:71]
    ds_read_b128 v[36:39], v6 offset:3072
    v_accvgpr_write_b32 a37, v66
    v_mfma_f32_16x16x32_bf16 v[68:71], v[40:43], v[232:235], v[68:71]
    s_waitcnt lgkmcnt(3)
    v_mfma_f32_16x16x32_bf16 v[76:79], v[16:19], v[112:115], 0
    ds_read_b128 v[40:43], v6 offset:4096
    v_mfma_f32_16x16x32_bf16 v[76:79], v[20:23], v[120:123], v[76:79]
    buffer_load_dwordx4 v4, s[12:15], s26 offen offset:0 sc1 lds
    v_mfma_f32_16x16x32_bf16 v[76:79], v[24:27], v[128:131], v[76:79]
    ds_read_b128 v[44:47], v6 offset:5120
    v_mfma_f32_16x16x32_bf16 v[80:83], v[24:27], v[132:135], 0
    v_mul_f32 v84, v7, v68
    v_mul_f32 v85, v7, v69
    v_mfma_f32_16x16x32_bf16 v[80:83], v[20:23], v[124:127], v[80:83]
    ds_read_b128 v[48:51], v6 offset:6144
    v_mul_f32 v86, v7, v70
    v_mfma_f32_16x16x32_bf16 v[80:83], v[16:19], v[116:119], v[80:83]
    s_waitcnt lgkmcnt(3)
    v_exp_f32 v84, v84
    v_mfma_f32_16x16x32_bf16 v[80:83], v[28:31], v[140:143], v[80:83]
    ds_read_b128 v[16:19], v6 offset:7168
    v_mul_f32 v87, v7, v71
    v_mfma_f32_16x16x32_bf16 v[80:83], v[32:35], v[148:151], v[80:83]
    v_exp_f32 v85, v85
    v_mfma_f32_16x16x32_bf16 v[80:83], v[36:39], v[156:159], v[80:83]
    ds_read_b128 v[20:23], v6 offset:8192
    v_add_f32 v84, 1.0, v84
    v_mfma_f32_16x16x32_bf16 v[76:79], v[36:39], v[152:155], v[76:79]
    v_exp_f32 v86, v86
    v_mfma_f32_16x16x32_bf16 v[76:79], v[32:35], v[144:147], v[76:79]
    ds_read_b128 v[24:27], v6 offset:9216
    v_add_f32 v85, 1.0, v85
    v_mfma_f32_16x16x32_bf16 v[76:79], v[28:31], v[136:139], v[76:79]
    s_waitcnt lgkmcnt(3)
    v_exp_f32 v87, v87
    v_mfma_f32_16x16x32_bf16 v[76:79], v[40:43], v[160:163], v[76:79]
    ds_read_b128 v[28:31], v6 offset:10240
    v_add_f32 v86, 1.0, v86
    v_mfma_f32_16x16x32_bf16 v[76:79], v[44:47], v[168:171], v[76:79]
    v_rcp_f32 v84, v84
    v_mfma_f32_16x16x32_bf16 v[76:79], v[48:51], v[176:179], v[76:79]
    ds_read_b128 v[32:35], v6 offset:11264
    v_add_f32 v87, 1.0, v87
    v_mfma_f32_16x16x32_bf16 v[80:83], v[48:51], v[180:183], v[80:83]
    v_rcp_f32 v85, v85
    v_mfma_f32_16x16x32_bf16 v[80:83], v[44:47], v[172:175], v[80:83]
    ds_read_b128 v[36:39], v6 offset:12288
    v_mul_f32 v68, v84, v68
    v_mfma_f32_16x16x32_bf16 v[80:83], v[40:43], v[164:167], v[80:83]
    s_waitcnt lgkmcnt(3)
    v_rcp_f32 v86, v86
    v_mfma_f32_16x16x32_bf16 v[80:83], v[16:19], v[188:191], v[80:83]
    ds_read_b128 v[40:43], v6 offset:13312
    v_mul_f32 v69, v85, v69
    v_mfma_f32_16x16x32_bf16 v[80:83], v[20:23], v[196:199], v[80:83]
    buffer_store_dwordx4 a[4:7], v4, s[12:15], s28 offen offset:1024 sc1
    v_mfma_f32_16x16x32_bf16 v[80:83], v[24:27], v[204:207], v[80:83]
    ds_read_b128 v[44:47], v6 offset:14336
    s_add_u32 m0, s27, 73728
    v_mfma_f32_16x16x32_bf16 v[76:79], v[24:27], v[200:203], v[76:79]
    s_add_u32 s26, s26, 28672
    v_rcp_f32 v87, v87
    v_mfma_f32_16x16x32_bf16 v[76:79], v[20:23], v[192:195], v[76:79]
    ds_read_b128 v[48:51], v6 offset:15360
    s_waitcnt vmcnt(11)
    s_barrier
    v_mfma_f32_16x16x32_bf16 v[76:79], v[16:19], v[184:187], v[76:79]
    s_waitcnt lgkmcnt(3)
    v_mul_f32 v70, v86, v70
    v_mul_f32 v71, v87, v71
    v_mfma_f32_16x16x32_bf16 v[76:79], v[28:31], v[208:211], v[76:79]
    ds_read_b128 v[16:19], v4 offset:0
    v_mul_f32 v88, v8, v72
    v_mfma_f32_16x16x32_bf16 v[76:79], v[32:35], v[216:219], v[76:79]
    buffer_load_dwordx4 v4, s[12:15], s26 offen offset:0 sc1 lds
    v_mfma_f32_16x16x32_bf16 v[76:79], v[36:39], v[224:227], v[76:79]
    ds_read_b128 v[20:23], v4 offset:1024
    v_mul_f32 v89, v8, v73
    v_mfma_f32_16x16x32_bf16 v[80:83], v[36:39], v[228:231], v[80:83]
    v_exp_f32 v88, v88
    v_mfma_f32_16x16x32_bf16 v[80:83], v[32:35], v[220:223], v[80:83]
    ds_read_b128 v[24:27], v4 offset:2048
    v_mul_f32 v90, v8, v74
    v_mfma_f32_16x16x32_bf16 v[80:83], v[28:31], v[212:215], v[80:83]
    s_waitcnt lgkmcnt(3)
    v_exp_f32 v89, v89
    v_mfma_f32_16x16x32_bf16 v[80:83], v[40:43], v[236:239], v[80:83]
    ds_read_b128 v[28:31], v4 offset:3072
    v_mul_f32 v91, v8, v75
    v_mfma_f32_16x16x32_bf16 v[80:83], v[44:47], v[244:247], v[80:83]
    buffer_load_dwordx4 v4, s[12:15], s26 offen offset:1024 sc1 lds
    v_mfma_f32_16x16x32_bf16 v[80:83], v[48:51], v[252:255], v[80:83]
    ds_read_b128 v[32:35], v4 offset:4096
    v_add_f32 v88, 1.0, v88
    v_mfma_f32_16x16x32_bf16 v[76:79], v[48:51], v[248:251], v[76:79]
    s_cmp_lg_u32 s100, 1
    s_cbranch_scc1 nohold_45
    s_cmp_lg_u32 s23, 1
    s_cbranch_scc1 nohold_45
    v_mov_b32 v15, 1
    s_mov_b64 exec, 1
    buffer_atomic_add v15, off, s[12:15], s99 sc1
    s_mov_b64 exec, -1
nohold_45:
    v_mfma_f32_16x16x32_bf16 v[76:79], v[44:47], v[240:243], v[76:79]
    ds_read_b128 v[36:39], v4 offset:5120
    v_add_f32 v89, 1.0, v89
    v_mfma_f32_16x16x32_bf16 v[76:79], v[40:43], v[232:235], v[76:79]
    s_waitcnt lgkmcnt(3)
    v_exp_f32 v90, v90
    v_mfma_f32_16x16x32_bf16 v[52:55], v[16:19], v[112:115], 0
    ds_read_b128 v[40:43], v4 offset:6144
    v_add_f32 v90, 1.0, v90
    v_mfma_f32_16x16x32_bf16 v[52:55], v[20:23], v[120:123], v[52:55]
    buffer_load_dwordx4 v4, s[12:15], s26 offen offset:2048 sc1 lds
    v_mfma_f32_16x16x32_bf16 v[52:55], v[24:27], v[128:131], v[52:55]
    ds_read_b128 v[44:47], v4 offset:7168
    v_mfma_f32_16x16x32_bf16 v[56:59], v[24:27], v[132:135], 0
    v_exp_f32 v91, v91
    v_mfma_f32_16x16x32_bf16 v[56:59], v[20:23], v[124:127], v[56:59]
    ds_read_b128 v[48:51], v4 offset:8192
    v_add_f32 v91, 1.0, v91
    v_mfma_f32_16x16x32_bf16 v[56:59], v[16:19], v[116:119], v[56:59]
    s_waitcnt lgkmcnt(3)
    v_rcp_f32 v88, v88
    v_mfma_f32_16x16x32_bf16 v[56:59], v[28:31], v[140:143], v[56:59]
    ds_read_b128 v[16:19], v4 offset:9216
    v_mul_f32 v72, v88, v72
    v_mfma_f32_16x16x32_bf16 v[56:59], v[32:35], v[148:151], v[56:59]
    buffer_load_dwordx4 v4, s[12:15], s26 offen offset:3072 sc1 lds
    v_mfma_f32_16x16x32_bf16 v[56:59], v[36:39], v[156:159], v[56:59]
    ds_read_b128 v[20:23], v4 offset:10240
    s_add_u32 m0, s27, 77824
    v_mfma_f32_16x16x32_bf16 v[52:55], v[36:39], v[152:155], v[52:55]
    s_add_u32 s26, s26, 4096
    v_rcp_f32 v89, v89
    v_mfma_f32_16x16x32_bf16 v[52:55], v[32:35], v[144:147], v[52:55]
    ds_read_b128 v[24:27], v4 offset:11264
    v_mul_f32 v73, v89, v73
    v_mfma_f32_16x16x32_bf16 v[52:55], v[28:31], v[136:139], v[52:55]
    s_waitcnt lgkmcnt(3)
    v_rcp_f32 v90, v90
    v_mfma_f32_16x16x32_bf16 v[52:55], v[40:43], v[160:163], v[52:55]
    ds_read_b128 v[28:31], v4 offset:12288
    v_mul_f32 v74, v90, v74
    v_mfma_f32_16x16x32_bf16 v[52:55], v[44:47], v[168:171], v[52:55]
    buffer_load_dwordx4 v4, s[12:15], s26 offen offset:0 sc1 lds
    v_mfma_f32_16x16x32_bf16 v[52:55], v[48:51], v[176:179], v[52:55]
    ds_read_b128 v[32:35], v4 offset:13312
    v_mul_f32 v76, v68, v76
    v_mfma_f32_16x16x32_bf16 v[56:59], v[48:51], v[180:183], v[56:59]
    s_cmp_lg_u32 s100, 2
    s_cbranch_scc1 nohold_46
    buffer_store_dwordx4 a[216:219], v4, s[12:15], s4 offen sc1
    buffer_store_dwordx4 a[220:223], v4, s[12:15], s5 offen sc1
nohold_46:
    v_mfma_f32_16x16x32_bf16 v[56:59], v[44:47], v[172:175], v[56:59]
    ds_read_b128 v[36:39], v4 offset:14336
    v_mul_f32 v77, v69, v77
    v_mfma_f32_16x16x32_bf16 v[56:59], v[40:43], v[164:167], v[56:59]
    s_waitcnt lgkmcnt(3)
    v_rcp_f32 v91, v91
    v_mfma_f32_16x16x32_bf16 v[56:59], v[16:19], v[188:191], v[56:59]
    ds_read_b128 v[40:43], v4 offset:15360
    v_mul_f32 v75, v91, v75
    v_mfma_f32_16x16x32_bf16 v[56:59], v[20:23], v[196:199], v[56:59]
    buffer_load_dwordx4 v4, s[12:15], s26 offen offset:1024 sc1 lds
    v_mfma_f32_16x16x32_bf16 v[56:59], v[24:27], v[204:207], v[56:59]
    ds_read_b128 v[44:47], v4 offset:16384
    v_mul_f32 v78, v70, v78
    v_mfma_f32_16x16x32_bf16 v[52:55], v[24:27], v[200:203], v[52:55]
    v_mul_f32 v79, v71, v79
    v_cvt_pk_bf16_f32 v76, v76, v77
    v_mfma_f32_16x16x32_bf16 v[52:55], v[20:23], v[192:195], v[52:55]
    ds_read_b128 v[48:51], v4 offset:17408
    v_cvt_pk_bf16_f32 v78, v78, v79
    v_mfma_f32_16x16x32_bf16 v[52:55], v[16:19], v[184:187], v[52:55]
    s_waitcnt lgkmcnt(3)
    v_accvgpr_write_b32 a34, v76
    v_accvgpr_write_b32 a35, v78
    v_mfma_f32_16x16x32_bf16 v[52:55], v[28:31], v[208:211], v[52:55]
    ds_read_b128 v[16:19], v4 offset:18432
    v_mul_f32 v80, v72, v80
    v_mfma_f32_16x16x32_bf16 v[52:55], v[32:35], v[216:219], v[52:55]
    buffer_load_dwordx4 v4, s[12:15], s26 offen offset:2048 sc1 lds
    v_mfma_f32_16x16x32_bf16 v[52:55], v[36:39], v[224:227], v[52:55]
    ds_read_b128 v[20:23], v4 offset:19456
    v_mul_f32 v81, v73, v81
    v_mfma_f32_16x16x32_bf16 v[56:59], v[36:39], v[228:231], v[56:59]
    v_mul_f32 v82, v74, v82
    v_mul_f32 v83, v75, v83
    v_mfma_f32_16x16x32_bf16 v[56:59], v[32:35], v[220:223], v[56:59]
    ds_read_b128 v[24:27], v4 offset:20480
    v_cvt_pk_bf16_f32 v80, v80, v81
    v_mfma_f32_16x16x32_bf16 v[56:59], v[28:31], v[212:215], v[56:59]
    s_waitcnt lgkmcnt(3)
    v_cvt_pk_bf16_f32 v82, v82, v83
    v_accvgpr_write_b32 a38, v80
    v_mfma_f32_16x16x32_bf16 v[56:59], v[40:43], v[236:239], v[56:59]
    ds_read_b128 v[28:31], v4 offset:21504
    v_accvgpr_write_b32 a39, v82
    v_mfma_f32_16x16x32_bf16 v[56:59], v[44:47], v[244:247], v[56:59]
    buffer_load_dwordx4 v4, s[12:15], s26 offen offset:3072 sc1 lds
    v_mfma_f32_16x16x32_bf16 v[56:59], v[48:51], v[252:255], v[56:59]
    ds_read_b128 v[32:35], v4 offset:22528
    s_add_u32 m0, s27, 81920
    v_mfma_f32_16x16x32_bf16 v[52:55], v[48:51], v[248:251], v[52:55]
    s_add_u32 s26, s26, 4096
    v_mfma_f32_16x16x32_bf16 v[52:55], v[44:47], v[240:243], v[52:55]
    ds_read_b128 v[36:39], v4 offset:23552
    v_mfma_f32_16x16x32_bf16 v[52:55], v[40:43], v[232:235], v[52:55]
    s_waitcnt lgkmcnt(3)
    v_mfma_f32_16x16x32_bf16 v[60:63], v[16:19], v[112:115], 0
    ds_read_b128 v[40:43], v4 offset:24576
    v_mfma_f32_16x16x32_bf16 v[60:63], v[20:23], v[120:123], v[60:63]
    buffer_load_dwordx4 v4, s[12:15], s26 offen offset:0 sc1 lds
    v_mfma_f32_16x16x32_bf16 v[60:63], v[24:27], v[128:131], v[60:63]
    ds_read_b128 v[44:47], v4 offset:25600
    v_mfma_f32_16x16x32_bf16 v[64:67], v[24:27], v[132:135], 0
    v_mul_f32 v84, v7, v52
    v_mul_f32 v85, v7, v53
    v_mfma_f32_16x16x32_bf16 v[64:67], v[20:23], v[124:127], v[64:67]
    ds_read_b128 v[48:51], v4 offset:26624
    v_mul_f32 v86, v7, v54
    v_mfma_f32_16x16x32_bf16 v[64:67], v[16:19], v[116:119], v[64:67]
    s_waitcnt lgkmcnt(3)
    v_exp_f32 v84, v84
    v_mfma_f32_16x16x32_bf16 v[64:67], v[28:31], v[140:143], v[64:67]
    ds_read_b128 v[16:19], v4 offset:27648
    v_mul_f32 v87, v7, v55
    v_mfma_f32_16x16x32_bf16 v[64:67], v[32:35], v[148:151], v[64:67]
    v_exp_f32 v85, v85
    v_mfma_f32_16x16x32_bf16 v[64:67], v[36:39], v[156:159], v[64:67]
    ds_read_b128 v[20:23], v4 offset:28672
    v_add_f32 v84, 1.0, v84
    v_mfma_f32_16x16x32_bf16 v[60:63], v[36:39], v[152:155], v[60:63]
    v_exp_f32 v86, v86
    v_mfma_f32_16x16x32_bf16 v[60:63], v[32:35], v[144:147], v[60:63]
    ds_read_b128 v[24:27], v4 offset:29696
    v_add_f32 v85, 1.0, v85
    v_mfma_f32_16x16x32_bf16 v[60:63], v[28:31], v[136:139], v[60:63]
    s_waitcnt lgkmcnt(3)
    v_exp_f32 v87, v87
    v_mfma_f32_16x16x32_bf16 v[60:63], v[40:43], v[160:163], v[60:63]
    ds_read_b128 v[28:31], v4 offset:30720
    v_add_f32 v86, 1.0, v86
    v_mfma_f32_16x16x32_bf16 v[60:63], v[44:47], v[168:171], v[60:63]
    v_rcp_f32 v84, v84
    v_mfma_f32_16x16x32_bf16 v[60:63], v[48:51], v[176:179], v[60:63]
    ds_read_b128 v[32:35], v4 offset:31744
    v_add_f32 v87, 1.0, v87
    v_mfma_f32_16x16x32_bf16 v[64:67], v[48:51], v[180:183], v[64:67]
    buffer_store_dwordx4 a[32:35], v4, s[12:15], s28 offen offset:2048 sc1
    v_mfma_f32_16x16x32_bf16 v[64:67], v[44:47], v[172:175], v[64:67]
    ds_read_b128 v[36:39], v4 offset:32768
    v_mul_f32 v52, v84, v52
    v_mfma_f32_16x16x32_bf16 v[64:67], v[40:43], v[164:167], v[64:67]
    s_waitcnt lgkmcnt(3)
    v_rcp_f32 v85, v85
    v_mfma_f32_16x16x32_bf16 v[64:67], v[16:19], v[188:191], v[64:67]
    ds_read_b128 v[40:43], v4 offset:33792
    v_mul_f32 v53, v85, v53
    v_mfma_f32_16x16x32_bf16 v[64:67], v[20:23], v[196:199], v[64:67]
    v_rcp_f32 v86, v86
    v_mfma_f32_16x16x32_bf16 v[64:67], v[24:27], v[204:207], v[64:67]
    ds_read_b128 v[44:47], v4 offset:34816
    s_add_u32 m0, s27, 110592
    v_mfma_f32_16x16x32_bf16 v[60:63], v[24:27], v[200:203], v[60:63]
    s_add_u32 s26, s26, 28672
    v_rcp_f32 v87, v87
    v_mfma_f32_16x16x32_bf16 v[60:63], v[20:23], v[192:195], v[60:63]
    ds_read_b128 v[48:51], v4 offset:35840
    s_waitcnt vmcnt(11)
    s_barrier
    v_mfma_f32_16x16x32_bf16 v[60:63], v[16:19], v[184:187], v[60:63]
    s_waitcnt lgkmcnt(3)
    v_mul_f32 v54, v86, v54
    v_mul_f32 v55, v87, v55
    v_mfma_f32_16x16x32_bf16 v[60:63], v[28:31], v[208:211], v[60:63]
    ds_read_b128 v[16:19], v4 offset:36864
    v_mul_f32 v88, v8, v56
    v_mfma_f32_16x16x32_bf16 v[60:63], v[32:35], v[216:219], v[60:63]
    buffer_load_dwordx4 v4, s[12:15], s26 offen offset:0 sc1 lds
    v_mfma_f32_16x16x32_bf16 v[60:63], v[36:39], v[224:227], v[60:63]
    ds_read_b128 v[20:23], v4 offset:37888
    v_mul_f32 v89, v8, v57
    v_mfma_f32_16x16x32_bf16 v[64:67], v[36:39], v[228:231], v[64:67]
    v_exp_f32 v88, v88
    v_mfma_f32_16x16x32_bf16 v[64:67], v[32:35], v[220:223], v[64:67]
    ds_read_b128 v[24:27], v4 offset:38912
    v_mul_f32 v90, v8, v58
    v_mfma_f32_16x16x32_bf16 v[64:67], v[28:31], v[212:215], v[64:67]
    s_waitcnt lgkmcnt(3)
    v_exp_f32 v89, v89
    v_mfma_f32_16x16x32_bf16 v[64:67], v[40:43], v[236:239], v[64:67]
    ds_read_b128 v[28:31], v4 offset:39936
    v_mul_f32 v91, v8, v59
    v_mfma_f32_16x16x32_bf16 v[64:67], v[44:47], v[244:247], v[64:67]
    buffer_load_dwordx4 v4, s[12:15], s26 offen offset:1024 sc1 lds
    v_mfma_f32_16x16x32_bf16 v[64:67], v[48:51], v[252:255], v[64:67]
    ds_read_b128 v[32:35], v4 offset:40960
    v_add_f32 v88, 1.0, v88
    v_mfma_f32_16x16x32_bf16 v[60:63], v[48:51], v[248:251], v[60:63]
    v_exp_f32 v90, v90
    v_mfma_f32_16x16x32_bf16 v[60:63], v[44:47], v[240:243], v[60:63]
    ds_read_b128 v[36:39], v4 offset:41984
    v_add_f32 v89, 1.0, v89
    v_mfma_f32_16x16x32_bf16 v[60:63], v[40:43], v[232:235], v[60:63]
    s_waitcnt lgkmcnt(3)
    v_exp_f32 v91, v91
    v_mfma_f32_16x16x32_bf16 v[68:71], v[16:19], v[112:115], 0
    ds_read_b128 v[40:43], v4 offset:43008
    v_add_f32 v90, 1.0, v90
    v_mfma_f32_16x16x32_bf16 v[68:71], v[20:23], v[120:123], v[68:71]
    buffer_load_dwordx4 v4, s[12:15], s26 offen offset:2048 sc1 lds
    v_mfma_f32_16x16x32_bf16 v[68:71], v[24:27], v[128:131], v[68:71]
    ds_read_b128 v[44:47], v4 offset:44032
    v_add_f32 v91, 1.0, v91
    v_mfma_f32_16x16x32_bf16 v[72:75], v[24:27], v[132:135], 0
    v_rcp_f32 v88, v88
    v_mfma_f32_16x16x32_bf16 v[72:75], v[20:23], v[124:127], v[72:75]
    ds_read_b128 v[48:51], v4 offset:45056
    v_mul_f32 v56, v88, v56
    v_mfma_f32_16x16x32_bf16 v[72:75], v[16:19], v[116:119], v[72:75]
    s_waitcnt lgkmcnt(3)
    v_rcp_f32 v89, v89
    v_mfma_f32_16x16x32_bf16 v[72:75], v[28:31], v[140:143], v[72:75]
    ds_read_b128 v[16:19], v4 offset:46080
    v_mul_f32 v57, v89, v57
    v_mfma_f32_16x16x32_bf16 v[72:75], v[32:35], v[148:151], v[72:75]
    buffer_load_dwordx4 v4, s[12:15], s26 offen offset:3072 sc1 lds
    v_mfma_f32_16x16x32_bf16 v[72:75], v[36:39], v[156:159], v[72:75]
    ds_read_b128 v[20:23], v4 offset:47104
    s_add_u32 m0, s27, 114688
    v_mfma_f32_16x16x32_bf16 v[68:71], v[36:39], v[152:155], v[68:71]
    s_add_u32 s26, s26, 4096
    v_rcp_f32 v90, v90
    v_mfma_f32_16x16x32_bf16 v[68:71], v[32:35], v[144:147], v[68:71]
    ds_read_b128 v[24:27], v4 offset:48128
    v_mul_f32 v58, v90, v58
    v_mfma_f32_16x16x32_bf16 v[68:71], v[28:31], v[136:139], v[68:71]
    s_waitcnt lgkmcnt(3)
    v_rcp_f32 v91, v91
    v_mfma_f32_16x16x32_bf16 v[68:71], v[40:43], v[160:163], v[68:71]
    ds_read_b128 v[28:31], v4 offset:49152
    v_mul_f32 v59, v91, v59
    v_mfma_f32_16x16x32_bf16 v[68:71], v[44:47], v[168:171], v[68:71]
    buffer_load_dwordx4 v4, s[12:15], s26 offen offset:0 sc1 lds
    v_mfma_f32_16x16x32_bf16 v[68:71], v[48:51], v[176:179], v[68:71]
    ds_read_b128 v[32:35], v4 offset:50176
    v_mul_f32 v60, v52, v60
    v_mfma_f32_16x16x32_bf16 v[72:75], v[48:51], v[180:183], v[72:75]
    v_mul_f32 v61, v53, v61
    v_mul_f32 v62, v54, v62
    v_mfma_f32_16x16x32_bf16 v[72:75], v[44:47], v[172:175], v[72:75]
    ds_read_b128 v[36:39], v4 offset:51200
    v_mul_f32 v63, v55, v63
    v_mfma_f32_16x16x32_bf16 v[72:75], v[40:43], v[164:167], v[72:75]
    s_waitcnt lgkmcnt(3)
    v_cvt_pk_bf16_f32 v60, v60, v61
    v_cvt_pk_bf16_f32 v62, v62, v63
    v_mfma_f32_16x16x32_bf16 v[72:75], v[16:19], v[188:191], v[72:75]
    ds_read_b128 v[40:43], v4 offset:52224
    v_accvgpr_write_b32 a64, v60
    v_mfma_f32_16x16x32_bf16 v[72:75], v[20:23], v[196:199], v[72:75]
    buffer_load_dwordx4 v4, s[12:15], s26 offen offset:1024 sc1 lds
    v_mfma_f32_16x16x32_bf16 v[72:75], v[24:27], v[204:207], v[72:75]
    ds_read_b128 v[44:47], v4 offset:53248
    v_accvgpr_write_b32 a65, v62
    v_mfma_f32_16x16x32_bf16 v[68:71], v[24:27], v[200:203], v[68:71]
    s_cmp_lg_u32 s100, 2
    s_cbranch_scc1 nohold_47
    buffer_store_dwordx4 a[224:227], v4, s[12:15], s6 offen sc1
    buffer_store_dwordx4 a[228:231], v4, s[12:15], s7 offen sc1
nohold_47:
    v_mfma_f32_16x16x32_bf16 v[68:71], v[20:23], v[192:195], v[68:71]
    ds_read_b128 v[48:51], v4 offset:54272
    v_mul_f32 v64, v56, v64
    v_mfma_f32_16x16x32_bf16 v[68:71], v[16:19], v[184:187], v[68:71]
    s_waitcnt lgkmcnt(3)
    v_mul_f32 v65, v57, v65
    v_mul_f32 v66, v58, v66
    v_mfma_f32_16x16x32_bf16 v[68:71], v[28:31], v[208:211], v[68:71]
    ds_read_b128 v[16:19], v4 offset:55296
    v_mul_f32 v67, v59, v67
    v_mfma_f32_16x16x32_bf16 v[68:71], v[32:35], v[216:219], v[68:71]
    buffer_load_dwordx4 v4, s[12:15], s26 offen offset:2048 sc1 lds
    v_mfma_f32_16x16x32_bf16 v[68:71], v[36:39], v[224:227], v[68:71]
    ds_read_b128 v[20:23], v4 offset:56320
    v_cvt_pk_bf16_f32 v64, v64, v65
    v_mfma_f32_16x16x32_bf16 v[72:75], v[36:39], v[228:231], v[72:75]
    v_cvt_pk_bf16_f32 v66, v66, v67
    v_accvgpr_write_b32 a68, v64
    v_mfma_f32_16x16x32_bf16 v[72:75], v[32:35], v[220:223], v[72:75]
    ds_read_b128 v[24:27], v4 offset:57344
    v_accvgpr_write_b32 a69, v66
    v_mfma_f32_16x16x32_bf16 v[72:75], v[28:31], v[212:215], v[72:75]
    s_waitcnt lgkmcnt(3)
    v_mfma_f32_16x16x32_bf16 v[72:75], v[40:43], v[236:239], v[72:75]
    ds_read_b128 v[28:31], v4 offset:58368
    v_mov_b32 v104, -1
    v_mfma_f32_16x16x32_bf16 v[72:75], v[44:47], v[244:247], v[72:75]
    buffer_load_dwordx4 v4, s[12:15], s26 offen offset:3072 sc1 lds
    v_mfma_f32_16x16x32_bf16 v[72:75], v[48:51], v[252:255], v[72:75]
    ds_read_b128 v[32:35], v4 offset:59392
    s_add_u32 m0, s27, 118784
    v_mfma_f32_16x16x32_bf16 v[68:71], v[48:51], v[248:251], v[68:71]
    s_add_u32 s26, s26, 4096
    v_mov_b32 v105, -1
    v_mov_b32 v106, -1
    v_mfma_f32_16x16x32_bf16 v[68:71], v[44:47], v[240:243], v[68:71]
    ds_read_b128 v[36:39], v4 offset:60416
    v_mov_b32 v107, -1
    v_mfma_f32_16x16x32_bf16 v[68:71], v[40:43], v[232:235], v[68:71]
    s_waitcnt lgkmcnt(3)
    s_add_u32 s45, s38, 4096
    v_mfma_f32_16x16x32_bf16 v[76:79], v[16:19], v[112:115], 0
    ds_read_b128 v[40:43], v4 offset:61440
    v_mfma_f32_16x16x32_bf16 v[76:79], v[20:23], v[120:123], v[76:79]
    buffer_load_dwordx4 v4, s[12:15], s26 offen offset:0 sc1 lds
    v_mfma_f32_16x16x32_bf16 v[76:79], v[24:27], v[128:131], v[76:79]
    ds_read_b128 v[44:47], v4 offset:62464
    v_mfma_f32_16x16x32_bf16 v[80:83], v[24:27], v[132:135], 0
    v_mul_f32 v84, v7, v68
    v_mul_f32 v85, v7, v69
    v_mfma_f32_16x16x32_bf16 v[80:83], v[20:23], v[124:127], v[80:83]
    ds_read_b128 v[48:51], v4 offset:63488
    v_mul_f32 v86, v7, v70
    v_mfma_f32_16x16x32_bf16 v[80:83], v[16:19], v[116:119], v[80:83]
    s_waitcnt lgkmcnt(3)
    v_exp_f32 v84, v84
    v_mfma_f32_16x16x32_bf16 v[80:83], v[28:31], v[140:143], v[80:83]
    ds_read_b128 v[16:19], v4 offset:64512
    v_mul_f32 v87, v7, v71
    v_mfma_f32_16x16x32_bf16 v[80:83], v[32:35], v[148:151], v[80:83]
    v_exp_f32 v85, v85
    v_mfma_f32_16x16x32_bf16 v[80:83], v[36:39], v[156:159], v[80:83]
    ds_read_b128 v[20:23], v5 offset:0
    v_add_f32 v84, 1.0, v84
    v_mfma_f32_16x16x32_bf16 v[76:79], v[36:39], v[152:155], v[76:79]
    v_exp_f32 v86, v86
    v_mfma_f32_16x16x32_bf16 v[76:79], v[32:35], v[144:147], v[76:79]
    ds_read_b128 v[24:27], v5 offset:1024
    v_add_f32 v85, 1.0, v85
    v_mfma_f32_16x16x32_bf16 v[76:79], v[28:31], v[136:139], v[76:79]
    s_waitcnt lgkmcnt(3)
    v_exp_f32 v87, v87
    v_mfma_f32_16x16x32_bf16 v[76:79], v[40:43], v[160:163], v[76:79]
    ds_read_b128 v[28:31], v5 offset:2048
    v_add_f32 v86, 1.0, v86
    v_mfma_f32_16x16x32_bf16 v[76:79], v[44:47], v[168:171], v[76:79]
    buffer_store_dwordx4 v[104:107], v4, s[12:15], s45 offen offset:0 sc1
    v_mfma_f32_16x16x32_bf16 v[76:79], v[48:51], v[176:179], v[76:79]
    ds_read_b128 v[32:35], v5 offset:3072
    v_add_f32 v87, 1.0, v87
    v_mfma_f32_16x16x32_bf16 v[80:83], v[48:51], v[180:183], v[80:83]
    buffer_store_dwordx4 a[36:39], v4, s[12:15], s28 offen offset:3072 sc1
    v_mfma_f32_16x16x32_bf16 v[80:83], v[44:47], v[172:175], v[80:83]
    ds_read_b128 v[36:39], v5 offset:4096
    s_add_u32 s28, s28, 4096
    v_mfma_f32_16x16x32_bf16 v[80:83], v[40:43], v[164:167], v[80:83]
    s_waitcnt lgkmcnt(3)
    v_rcp_f32 v84, v84
    v_mfma_f32_16x16x32_bf16 v[80:83], v[16:19], v[188:191], v[80:83]
    ds_read_b128 v[40:43], v5 offset:5120
    v_mul_f32 v68, v84, v68
    v_mfma_f32_16x16x32_bf16 v[80:83], v[20:23], v[196:199], v[80:83]
    v_rcp_f32 v85, v85
    v_mfma_f32_16x16x32_bf16 v[80:83], v[24:27], v[204:207], v[80:83]
    ds_read_b128 v[44:47], v5 offset:6144
    s_add_u32 m0, s27, 0
    v_mfma_f32_16x16x32_bf16 v[76:79], v[24:27], v[200:203], v[76:79]
    s_add_u32 s26, s26, 28672
    v_rcp_f32 v86, v86
    v_mfma_f32_16x16x32_bf16 v[76:79], v[20:23], v[192:195], v[76:79]
    ds_read_b128 v[48:51], v5 offset:7168
    s_waitcnt vmcnt(12)
    s_barrier
    v_mfma_f32_16x16x32_bf16 v[76:79], v[16:19], v[184:187], v[76:79]
    s_waitcnt lgkmcnt(3)
    v_rcp_f32 v87, v87
    v_mfma_f32_16x16x32_bf16 v[76:79], v[28:31], v[208:211], v[76:79]
    ds_read_b128 v[16:19], v5 offset:8192
    v_mul_f32 v69, v85, v69
    v_mfma_f32_16x16x32_bf16 v[76:79], v[32:35], v[216:219], v[76:79]
    buffer_store_dwordx4 v[104:107], v4, s[12:15], s45 offen offset:1024 sc1
    v_mfma_f32_16x16x32_bf16 v[76:79], v[36:39], v[224:227], v[76:79]
    ds_read_b128 v[20:23], v5 offset:9216
    v_mul_f32 v70, v86, v70
    v_mfma_f32_16x16x32_bf16 v[80:83], v[36:39], v[228:231], v[80:83]
    buffer_load_dwordx4 v4, s[12:15], s26 offen offset:0 sc1 lds
    v_mfma_f32_16x16x32_bf16 v[80:83], v[32:35], v[220:223], v[80:83]
    ds_read_b128 v[24:27], v5 offset:10240
    v_mul_f32 v71, v87, v71
    v_mfma_f32_16x16x32_bf16 v[80:83], v[28:31], v[212:215], v[80:83]
    s_waitcnt lgkmcnt(3)
    v_mul_f32 v88, v8, v72
    v_mul_f32 v89, v8, v73
    v_mfma_f32_16x16x32_bf16 v[80:83], v[40:43], v[236:239], v[80:83]
    ds_read_b128 v[28:31], v5 offset:11264
    v_mul_f32 v90, v8, v74
    v_mfma_f32_16x16x32_bf16 v[80:83], v[44:47], v[244:247], v[80:83]
    buffer_load_dwordx4 v4, s[12:15], s26 offen offset:1024 sc1 lds
    v_mfma_f32_16x16x32_bf16 v[80:83], v[48:51], v[252:255], v[80:83]
    ds_read_b128 v[32:35], v5 offset:12288
    v_mul_f32 v91, v8, v75
    v_mfma_f32_16x16x32_bf16 v[76:79], v[48:51], v[248:251], v[76:79]
    v_exp_f32 v88, v88
    v_mfma_f32_16x16x32_bf16 v[76:79], v[44:47], v[240:243], v[76:79]
    ds_read_b128 v[36:39], v5 offset:13312
    v_add_f32 v88, 1.0, v88
    v_mfma_f32_16x16x32_bf16 v[76:79], v[40:43], v[232:235], v[76:79]
    s_waitcnt lgkmcnt(3)
    v_exp_f32 v89, v89
    v_mfma_f32_16x16x32_bf16 v[52:55], v[16:19], v[112:115], 0
    ds_read_b128 v[40:43], v5 offset:14336
    v_add_f32 v89, 1.0, v89
    v_mfma_f32_16x16x32_bf16 v[52:55], v[20:23], v[120:123], v[52:55]
    buffer_load_dwordx4 v4, s[12:15], s26 offen offset:2048 sc1 lds
    v_mfma_f32_16x16x32_bf16 v[52:55], v[24:27], v[128:131], v[52:55]
    ds_read_b128 v[44:47], v5 offset:15360
    v_mfma_f32_16x16x32_bf16 v[56:59], v[24:27], v[132:135], 0
    v_exp_f32 v90, v90
    v_mfma_f32_16x16x32_bf16 v[56:59], v[20:23], v[124:127], v[56:59]
    ds_read_b128 v[48:51], v5 offset:16384
    v_add_f32 v90, 1.0, v90
    v_mfma_f32_16x16x32_bf16 v[56:59], v[16:19], v[116:119], v[56:59]
    s_waitcnt lgkmcnt(3)
    v_exp_f32 v91, v91
    v_mfma_f32_16x16x32_bf16 v[56:59], v[28:31], v[140:143], v[56:59]
    ds_read_b128 v[16:19], v5 offset:17408
    v_add_f32 v91, 1.0, v91
    v_mfma_f32_16x16x32_bf16 v[56:59], v[32:35], v[148:151], v[56:59]
    buffer_load_dwordx4 v4, s[12:15], s26 offen offset:3072 sc1 lds
    v_mfma_f32_16x16x32_bf16 v[56:59], v[36:39], v[156:159], v[56:59]
    ds_read_b128 v[20:23], v5 offset:18432
    s_add_u32 m0, s27, 4096
    v_mfma_f32_16x16x32_bf16 v[52:55], v[36:39], v[152:155], v[52:55]
    s_cmp_lg_u32 s100, 2
    s_cbranch_scc1 nohold_48
    buffer_store_dwordx4 a[232:235], v4, s[12:15], s50 offen sc1
    buffer_store_dwordx4 a[236:239], v4, s[12:15], s51 offen sc1
nohold_48:
    v_mfma_f32_16x16x32_bf16 v[52:55], v[32:35], v[144:147], v[52:55]
    ds_read_b128 v[24:27], v5 offset:19456
    s_add_u32 s26, s26, 4096
    v_mfma_f32_16x16x32_bf16 v[52:55], v[28:31], v[136:139], v[52:55]
    s_waitcnt lgkmcnt(3)
    v_rcp_f32 v88, v88
    v_mfma_f32_16x16x32_bf16 v[52:55], v[40:43], v[160:163], v[52:55]
    ds_read_b128 v[28:31], v5 offset:20480
    v_mul_f32 v72, v88, v72
    v_mfma_f32_16x16x32_bf16 v[52:55], v[44:47], v[168:171], v[52:55]
    buffer_load_dwordx4 v4, s[12:15], s26 offen offset:0 sc1 lds
    v_mfma_f32_16x16x32_bf16 v[52:55], v[48:51], v[176:179], v[52:55]
    ds_read_b128 v[32:35], v5 offset:21504
    v_mul_f32 v76, v68, v76
    v_mfma_f32_16x16x32_bf16 v[56:59], v[48:51], v[180:183], v[56:59]
    v_rcp_f32 v89, v89
    v_mfma_f32_16x16x32_bf16 v[56:59], v[44:47], v[172:175], v[56:59]
    ds_read_b128 v[36:39], v5 offset:22528
    v_mul_f32 v73, v89, v73
    v_mfma_f32_16x16x32_bf16 v[56:59], v[40:43], v[164:167], v[56:59]
    s_waitcnt lgkmcnt(3)
    v_rcp_f32 v90, v90
    v_mfma_f32_16x16x32_bf16 v[56:59], v[16:19], v[188:191], v[56:59]
    ds_read_b128 v[40:43], v5 offset:23552
    v_mul_f32 v74, v90, v74
    v_mfma_f32_16x16x32_bf16 v[56:59], v[20:23], v[196:199], v[56:59]
    buffer_load_dwordx4 v4, s[12:15], s26 offen offset:1024 sc1 lds
    v_mfma_f32_16x16x32_bf16 v[56:59], v[24:27], v[204:207], v[56:59]
    ds_read_b128 v[44:47], v5 offset:24576
    v_mul_f32 v77, v69, v77
    v_mfma_f32_16x16x32_bf16 v[52:55], v[24:27], v[200:203], v[52:55]
    v_rcp_f32 v91, v91
    v_mfma_f32_16x16x32_bf16 v[52:55], v[20:23], v[192:195], v[52:55]
    ds_read_b128 v[48:51], v5 offset:25600
    v_mul_f32 v75, v91, v75
    v_mfma_f32_16x16x32_bf16 v[52:55], v[16:19], v[184:187], v[52:55]
    s_waitcnt lgkmcnt(3)
    v_mul_f32 v78, v70, v78
    v_mul_f32 v79, v71, v79
    v_mfma_f32_16x16x32_bf16 v[52:55], v[28:31], v[208:211], v[52:55]
    ds_read_b128 v[16:19], v5 offset:26624
    v_cvt_pk_bf16_f32 v76, v76, v77
    v_mfma_f32_16x16x32_bf16 v[52:55], v[32:35], v[216:219], v[52:55]
    buffer_load_dwordx4 v4, s[12:15], s26 offen offset:2048 sc1 lds
    v_mfma_f32_16x16x32_bf16 v[52:55], v[36:39], v[224:227], v[52:55]
    ds_read_b128 v[20:23], v5 offset:27648
    v_cvt_pk_bf16_f32 v78, v78, v79
    v_mfma_f32_16x16x32_bf16 v[56:59], v[36:39], v[228:231], v[56:59]
    v_accvgpr_write_b32 a66, v76
    v_accvgpr_write_b32 a67, v78
    v_mfma_f32_16x16x32_bf16 v[56:59], v[32:35], v[220:223], v[56:59]
    ds_read_b128 v[24:27], v5 offset:28672
    v_mul_f32 v80, v72, v80
    v_mfma_f32_16x16x32_bf16 v[56:59], v[28:31], v[212:215], v[56:59]
    s_waitcnt lgkmcnt(3)
    v_mul_f32 v81, v73, v81
    v_mul_f32 v82, v74, v82
    v_mfma_f32_16x16x32_bf16 v[56:59], v[40:43], v[236:239], v[56:59]
    ds_read_b128 v[28:31], v5 offset:29696
    v_mul_f32 v83, v75, v83
    v_mfma_f32_16x16x32_bf16 v[56:59], v[44:47], v[244:247], v[56:59]
    buffer_load_dwordx4 v4, s[12:15], s26 offen offset:3072 sc1 lds
    v_mfma_f32_16x16x32_bf16 v[56:59], v[48:51], v[252:255], v[56:59]
    ds_read_b128 v[32:35], v5 offset:30720
    s_add_u32 m0, s27, 8192
    v_mfma_f32_16x16x32_bf16 v[52:55], v[48:51], v[248:251], v[52:55]
    s_add_u32 s26, s26, 4096
    v_cvt_pk_bf16_f32 v80, v80, v81
    v_cvt_pk_bf16_f32 v82, v82, v83
hop_3:
    s_cbranch_execz back_3
    v_mfma_f32_16x16x32_bf16 v[52:55], v[44:47], v[240:243], v[52:55]
    ds_read_b128 v[36:39], v5 offset:31744
    v_accvgpr_write_b32 a70, v80
    v_mfma_f32_16x16x32_bf16 v[52:55], v[40:43], v[232:235], v[52:55]
    s_waitcnt lgkmcnt(3)
    v_accvgpr_write_b32 a71, v82
    v_mfma_f32_16x16x32_bf16 v[60:63], v[16:19], v[112:115], 0
    ds_read_b128 v[40:43], v5 offset:32768
    v_mfma_f32_16x16x32_bf16 v[60:63], v[20:23], v[120:123], v[60:63]
    buffer_load_dwordx4 v4, s[12:15], s26 offen offset:0 sc1 lds
    v_mfma_f32_16x16x32_bf16 v[60:63], v[24:27], v[128:131], v[60:63]
    ds_read_b128 v[44:47], v5 offset:33792
    v_mfma_f32_16x16x32_bf16 v[64:67], v[24:27], v[132:135], 0
    v_mul_f32 v84, v7, v52
    v_mul_f32 v85, v7, v53
    v_mfma_f32_16x16x32_bf16 v[64:67], v[20:23], v[124:127], v[64:67]
    ds_read_b128 v[48:51], v5 offset:34816
    v_mul_f32 v86, v7, v54
    v_mfma_f32_16x16x32_bf16 v[64:67], v[16:19], v[116:119], v[64:67]
    s_waitcnt lgkmcnt(3)
    v_exp_f32 v84, v84
    v_mfma_f32_16x16x32_bf16 v[64:67], v[28:31], v[140:143], v[64:67]
    ds_read_b128 v[16:19], v5 offset:35840
    v_mul_f32 v87, v7, v55
    v_mfma_f32_16x16x32_bf16 v[64:67], v[32:35], v[148:151], v[64:67]
    v_exp_f32 v85, v85
    v_mfma_f32_16x16x32_bf16 v[64:67], v[36:39], v[156:159], v[64:67]
    ds_read_b128 v[20:23], v5 offset:36864
    v_add_f32 v84, 1.0, v84
    v_mfma_f32_16x16x32_bf16 v[60:63], v[36:39], v[152:155], v[60:63]
    v_exp_f32 v86, v86
    v_mfma_f32_16x16x32_bf16 v[60:63], v[32:35], v[144:147], v[60:63]
    ds_read_b128 v[24:27], v5 offset:37888
    v_add_f32 v85, 1.0, v85
    v_mfma_f32_16x16x32_bf16 v[60:63], v[28:31], v[136:139], v[60:63]
    s_waitcnt lgkmcnt(3)
    v_exp_f32 v87, v87
    v_mfma_f32_16x16x32_bf16 v[60:63], v[40:43], v[160:163], v[60:63]
    ds_read_b128 v[28:31], v5 offset:38912
    v_add_f32 v86, 1.0, v86
    v_mfma_f32_16x16x32_bf16 v[60:63], v[44:47], v[168:171], v[60:63]
    v_rcp_f32 v84, v84
    v_mfma_f32_16x16x32_bf16 v[60:63], v[48:51], v[176:179], v[60:63]
    ds_read_b128 v[32:35], v5 offset:39936
    v_add_f32 v87, 1.0, v87
    v_mfma_f32_16x16x32_bf16 v[64:67], v[48:51], v[180:183], v[64:67]
    buffer_store_dwordx4 a[64:67], v4, s[12:15], s28 offen offset:0 sc1
    v_mfma_f32_16x16x32_bf16 v[64:67], v[44:47], v[172:175], v[64:67]
    ds_read_b128 v[36:39], v5 offset:40960
    s_mov_b32 s41, 16877568
    v_mfma_f32_16x16x32_bf16 v[64:67], v[40:43], v[164:167], v[64:67]
    s_waitcnt lgkmcnt(3)
    v_rcp_f32 v85, v85
    v_mfma_f32_16x16x32_bf16 v[64:67], v[16:19], v[188:191], v[64:67]
    ds_read_b128 v[40:43], v5 offset:41984
    v_and_b32 v92, 7, v0
    v_mfma_f32_16x16x32_bf16 v[64:67], v[20:23], v[196:199], v[64:67]
    v_rcp_f32 v86, v86
    v_mfma_f32_16x16x32_bf16 v[64:67], v[24:27], v[204:207], v[64:67]
    ds_read_b128 v[44:47], v5 offset:43008
    v_lshlrev_b32 v92, 8, v92
    v_mfma_f32_16x16x32_bf16 v[60:63], v[24:27], v[200:203], v[60:63]
    buffer_load_dword v11, v92, s[12:15], s41 offen sc1
    v_mov_b32 v15, 1
    s_waitcnt vmcnt(12)
    buffer_store_dword v15, v12, s[12:15], s32 offen sc1
    v_mfma_f32_16x16x32_bf16 v[60:63], v[20:23], v[192:195], v[60:63]
    ds_read_b128 v[48:51], v5 offset:44032
    s_barrier
    v_mfma_f32_16x16x32_bf16 v[60:63], v[16:19], v[184:187], v[60:63]
    s_waitcnt lgkmcnt(3)
    v_rcp_f32 v87, v87
    v_mfma_f32_16x16x32_bf16 v[60:63], v[28:31], v[208:211], v[60:63]
    ds_read_b128 v[16:19], v5 offset:45056
    s_add_u32 m0, s27, 36864
    s_add_u32 s26, s26, 28672
    v_mfma_f32_16x16x32_bf16 v[60:63], v[32:35], v[216:219], v[60:63]
    buffer_load_dwordx4 v4, s[12:15], s26 offen offset:0 sc1 lds
    v_mfma_f32_16x16x32_bf16 v[60:63], v[36:39], v[224:227], v[60:63]
    ds_read_b128 v[20:23], v5 offset:46080
    v_mul_f32 v52, v84, v52
    v_mfma_f32_16x16x32_bf16 v[64:67], v[36:39], v[228:231], v[64:67]
    v_mul_f32 v53, v85, v53
    v_mul_f32 v54, v86, v54
    v_mfma_f32_16x16x32_bf16 v[64:67], v[32:35], v[220:223], v[64:67]
    ds_read_b128 v[24:27], v5 offset:47104
    v_mul_f32 v55, v87, v55
    v_mfma_f32_16x16x32_bf16 v[64:67], v[28:31], v[212:215], v[64:67]
    s_waitcnt lgkmcnt(3)
    v_mul_f32 v88, v8, v56
    v_mul_f32 v89, v8, v57
    v_mfma_f32_16x16x32_bf16 v[64:67], v[40:43], v[236:239], v[64:67]
    ds_read_b128 v[28:31], v5 offset:48128
    v_mul_f32 v90, v8, v58
    v_mfma_f32_16x16x32_bf16 v[64:67], v[44:47], v[244:247], v[64:67]
    buffer_load_dwordx4 v4, s[12:15], s26 offen offset:1024 sc1 lds
    v_mfma_f32_16x16x32_bf16 v[64:67], v[48:51], v[252:255], v[64:67]
    ds_read_b128 v[32:35], v5 offset:49152
    v_mul_f32 v91, v8, v59
    v_mfma_f32_16x16x32_bf16 v[60:63], v[48:51], v[248:251], v[60:63]
    v_exp_f32 v88, v88
    v_mfma_f32_16x16x32_bf16 v[60:63], v[44:47], v[240:243], v[60:63]
    ds_read_b128 v[36:39], v5 offset:50176
    v_add_f32 v88, 1.0, v88
    v_mfma_f32_16x16x32_bf16 v[60:63], v[40:43], v[232:235], v[60:63]
    s_waitcnt lgkmcnt(3)
    v_exp_f32 v89, v89
    v_mfma_f32_16x16x32_bf16 v[68:71], v[16:19], v[112:115], 0
    ds_read_b128 v[40:43], v5 offset:51200
    v_add_f32 v89, 1.0, v89
    v_mfma_f32_16x16x32_bf16 v[68:71], v[20:23], v[120:123], v[68:71]
    buffer_load_dwordx4 v4, s[12:15], s26 offen offset:2048 sc1 lds
    v_mfma_f32_16x16x32_bf16 v[68:71], v[24:27], v[128:131], v[68:71]
    ds_read_b128 v[44:47], v5 offset:52224
    v_mfma_f32_16x16x32_bf16 v[72:75], v[24:27], v[132:135], 0
    v_exp_f32 v90, v90
    v_mfma_f32_16x16x32_bf16 v[72:75], v[20:23], v[124:127], v[72:75]
    ds_read_b128 v[48:51], v5 offset:53248
    v_add_f32 v90, 1.0, v90
    v_mfma_f32_16x16x32_bf16 v[72:75], v[16:19], v[116:119], v[72:75]
    s_waitcnt lgkmcnt(3)
    v_exp_f32 v91, v91
    v_mfma_f32_16x16x32_bf16 v[72:75], v[28:31], v[140:143], v[72:75]
    ds_read_b128 v[16:19], v5 offset:54272
    v_add_f32 v91, 1.0, v91
    v_mfma_f32_16x16x32_bf16 v[72:75], v[32:35], v[148:151], v[72:75]
    buffer_load_dwordx4 v4, s[12:15], s26 offen offset:3072 sc1 lds
    v_mfma_f32_16x16x32_bf16 v[72:75], v[36:39], v[156:159], v[72:75]
    ds_read_b128 v[20:23], v5 offset:55296
    s_add_u32 m0, s27, 40960
    v_mfma_f32_16x16x32_bf16 v[68:71], v[36:39], v[152:155], v[68:71]
    s_add_u32 s26, s26, 4096
    v_rcp_f32 v88, v88
    v_mfma_f32_16x16x32_bf16 v[68:71], v[32:35], v[144:147], v[68:71]
    ds_read_b128 v[24:27], v5 offset:56320
    v_mul_f32 v56, v88, v56
    v_mfma_f32_16x16x32_bf16 v[68:71], v[28:31], v[136:139], v[68:71]
    s_waitcnt lgkmcnt(3)
    v_rcp_f32 v89, v89
    v_mfma_f32_16x16x32_bf16 v[68:71], v[40:43], v[160:163], v[68:71]
    ds_read_b128 v[28:31], v5 offset:57344
    v_mul_f32 v57, v89, v57
    v_mfma_f32_16x16x32_bf16 v[68:71], v[44:47], v[168:171], v[68:71]
    buffer_load_dwordx4 v4, s[12:15], s26 offen offset:0 sc1 lds
    v_mfma_f32_16x16x32_bf16 v[68:71], v[48:51], v[176:179], v[68:71]
    ds_read_b128 v[32:35], v5 offset:58368
    v_mul_f32 v60, v52, v60
    v_mfma_f32_16x16x32_bf16 v[72:75], v[48:51], v[180:183], v[72:75]
    v_rcp_f32 v90, v90
    v_mfma_f32_16x16x32_bf16 v[72:75], v[44:47], v[172:175], v[72:75]
    ds_read_b128 v[36:39], v5 offset:59392
    v_mul_f32 v58, v90, v58
    v_mfma_f32_16x16x32_bf16 v[72:75], v[40:43], v[164:167], v[72:75]
    s_waitcnt lgkmcnt(3)
    v_rcp_f32 v91, v91
    v_mfma_f32_16x16x32_bf16 v[72:75], v[16:19], v[188:191], v[72:75]
    ds_read_b128 v[40:43], v5 offset:60416
    v_mul_f32 v59, v91, v59
    v_mfma_f32_16x16x32_bf16 v[72:75], v[20:23], v[196:199], v[72:75]
    buffer_load_dwordx4 v4, s[12:15], s26 offen offset:1024 sc1 lds
    v_mfma_f32_16x16x32_bf16 v[72:75], v[24:27], v[204:207], v[72:75]
    ds_read_b128 v[44:47], v5 offset:61440
    v_mul_f32 v61, v53, v61
    v_mfma_f32_16x16x32_bf16 v[68:71], v[24:27], v[200:203], v[68:71]
    v_mul_f32 v62, v54, v62
    v_mul_f32 v63, v55, v63
    v_mfma_f32_16x16x32_bf16 v[68:71], v[20:23], v[192:195], v[68:71]
    ds_read_b128 v[48:51], v5 offset:62464
    v_cvt_pk_bf16_f32 v60, v60, v61
    v_mfma_f32_16x16x32_bf16 v[68:71], v[16:19], v[184:187], v[68:71]
    s_waitcnt lgkmcnt(3)
    v_cvt_pk_bf16_f32 v62, v62, v63
    v_accvgpr_write_b32 a96, v60
    v_mfma_f32_16x16x32_bf16 v[68:71], v[28:31], v[208:211], v[68:71]
    ds_read_b128 v[16:19], v5 offset:63488
    v_accvgpr_write_b32 a97, v62
    v_mfma_f32_16x16x32_bf16 v[68:71], v[32:35], v[216:219], v[68:71]
    buffer_load_dwordx4 v4, s[12:15], s26 offen offset:2048 sc1 lds
    v_mfma_f32_16x16x32_bf16 v[68:71], v[36:39], v[224:227], v[68:71]
    ds_read_b128 v[20:23], v5 offset:64512
    v_mul_f32 v64, v56, v64
    v_mfma_f32_16x16x32_bf16 v[72:75], v[36:39], v[228:231], v[72:75]
    s_cmp_lg_u32 s100, 2
    s_cbranch_scc1 nohold_49
    buffer_store_dwordx4 a[240:243], v4, s[12:15], s60 offen sc1
    buffer_store_dwordx4 a[244:247], v4, s[12:15], s61 offen sc1
nohold_49:
    v_mfma_f32_16x16x32_bf16 v[72:75], v[32:35], v[220:223], v[72:75]
    ds_read_b128 v[24:27], v6 offset:0
    v_mul_f32 v65, v57, v65
    v_mfma_f32_16x16x32_bf16 v[72:75], v[28:31], v[212:215], v[72:75]
    s_waitcnt lgkmcnt(3)
    v_mul_f32 v66, v58, v66
    v_mul_f32 v67, v59, v67
    v_mfma_f32_16x16x32_bf16 v[72:75], v[40:43], v[236:239], v[72:75]
    ds_read_b128 v[28:31], v6 offset:1024
    v_cvt_pk_bf16_f32 v64, v64, v65
    v_mfma_f32_16x16x32_bf16 v[72:75], v[44:47], v[244:247], v[72:75]
    buffer_load_dwordx4 v4, s[12:15], s26 offen offset:3072 sc1 lds
    v_mfma_f32_16x16x32_bf16 v[72:75], v[48:51], v[252:255], v[72:75]
    ds_read_b128 v[32:35], v6 offset:2048
    s_add_u32 m0, s27, 45056
    v_mfma_f32_16x16x32_bf16 v[68:71], v[48:51], v[248:251], v[68:71]
    s_add_u32 s26, s26, 4096
    v_cvt_pk_bf16_f32 v66, v66, v67
    v_accvgpr_write_b32 a100, v64
    v_mfma_f32_16x16x32_bf16 v[68:71], v[44:47], v[240:243], v[68:71]
    ds_read_b128 v[36:39], v6 offset:3072
    v_accvgpr_write_b32 a101, v66
    v_mfma_f32_16x16x32_bf16 v[68:71], v[40:43], v[232:235], v[68:71]
    s_waitcnt lgkmcnt(3)
    v_mfma_f32_16x16x32_bf16 v[76:79], v[16:19], v[112:115], 0
    ds_read_b128 v[40:43], v6 offset:4096
    v_mfma_f32_16x16x32_bf16 v[76:79], v[20:23], v[120:123], v[76:79]
    buffer_load_dwordx4 v4, s[12:15], s26 offen offset:0 sc1 lds
    v_mfma_f32_16x16x32_bf16 v[76:79], v[24:27], v[128:131], v[76:79]
    ds_read_b128 v[44:47], v6 offset:5120
    v_mfma_f32_16x16x32_bf16 v[80:83], v[24:27], v[132:135], 0
    v_mul_f32 v84, v7, v68
    v_mul_f32 v85, v7, v69
    v_mfma_f32_16x16x32_bf16 v[80:83], v[20:23], v[124:127], v[80:83]
    ds_read_b128 v[48:51], v6 offset:6144
    v_mul_f32 v86, v7, v70
    v_mfma_f32_16x16x32_bf16 v[80:83], v[16:19], v[116:119], v[80:83]
    s_waitcnt lgkmcnt(3)
    v_exp_f32 v84, v84
    v_mfma_f32_16x16x32_bf16 v[80:83], v[28:31], v[140:143], v[80:83]
    ds_read_b128 v[16:19], v6 offset:7168
    v_mul_f32 v87, v7, v71
    v_mfma_f32_16x16x32_bf16 v[80:83], v[32:35], v[148:151], v[80:83]
    v_exp_f32 v85, v85
    v_mfma_f32_16x16x32_bf16 v[80:83], v[36:39], v[156:159], v[80:83]
    ds_read_b128 v[20:23], v6 offset:8192
    v_add_f32 v84, 1.0, v84
    v_mfma_f32_16x16x32_bf16 v[76:79], v[36:39], v[152:155], v[76:79]
    v_exp_f32 v86, v86
    v_mfma_f32_16x16x32_bf16 v[76:79], v[32:35], v[144:147], v[76:79]
    ds_read_b128 v[24:27], v6 offset:9216
    v_add_f32 v85, 1.0, v85
    v_mfma_f32_16x16x32_bf16 v[76:79], v[28:31], v[136:139], v[76:79]
    s_waitcnt lgkmcnt(3)
    v_exp_f32 v87, v87
    v_mfma_f32_16x16x32_bf16 v[76:79], v[40:43], v[160:163], v[76:79]
    ds_read_b128 v[28:31], v6 offset:10240
    v_add_f32 v86, 1.0, v86
    v_mfma_f32_16x16x32_bf16 v[76:79], v[44:47], v[168:171], v[76:79]
    v_rcp_f32 v84, v84
    v_mfma_f32_16x16x32_bf16 v[76:79], v[48:51], v[176:179], v[76:79]
    ds_read_b128 v[32:35], v6 offset:11264
    v_add_f32 v87, 1.0, v87
    v_mfma_f32_16x16x32_bf16 v[80:83], v[48:51], v[180:183], v[80:83]
    buffer_store_dwordx4 a[68:71], v4, s[12:15], s28 offen offset:1024 sc1
    s_waitcnt vmcnt(11)
    v_cmp_gt_u32 vcc, 14, v11
    s_cbranch_vccnz late_25
late_25_ok:
    v_mfma_f32_16x16x32_bf16 v[80:83], v[44:47], v[172:175], v[80:83]
    ds_read_b128 v[36:39], v6 offset:12288
    v_mul_f32 v68, v84, v68
    v_mfma_f32_16x16x32_bf16 v[80:83], v[40:43], v[164:167], v[80:83]
    s_waitcnt lgkmcnt(3)
    v_rcp_f32 v85, v85
    v_mfma_f32_16x16x32_bf16 v[80:83], v[16:19], v[188:191], v[80:83]
    ds_read_b128 v[40:43], v6 offset:13312
    v_mul_f32 v69, v85, v69
    v_mfma_f32_16x16x32_bf16 v[80:83], v[20:23], v[196:199], v[80:83]
    v_rcp_f32 v86, v86
    v_mfma_f32_16x16x32_bf16 v[80:83], v[24:27], v[204:207], v[80:83]
    ds_read_b128 v[44:47], v6 offset:14336
    s_add_u32 m0, s27, 73728
    v_mfma_f32_16x16x32_bf16 v[76:79], v[24:27], v[200:203], v[76:79]
    buffer_load_dword v11, v102, s[12:15], s32 offen sc1
    v_mfma_f32_16x16x32_bf16 v[76:79], v[20:23], v[192:195], v[76:79]
    ds_read_b128 v[48:51], v6 offset:15360
    s_barrier
    v_mfma_f32_16x16x32_bf16 v[76:79], v[16:19], v[184:187], v[76:79]
    s_waitcnt lgkmcnt(3)
    v_rcp_f32 v87, v87
    v_mfma_f32_16x16x32_bf16 v[76:79], v[28:31], v[208:211], v[76:79]
    ds_read_b128 v[16:19], v4 offset:0
    s_add_u32 s26, s26, 28672
    v_mfma_f32_16x16x32_bf16 v[76:79], v[32:35], v[216:219], v[76:79]
    buffer_load_dwordx4 v4, s[12:15], s26 offen offset:0 sc1 lds
    v_mfma_f32_16x16x32_bf16 v[76:79], v[36:39], v[224:227], v[76:79]
    ds_read_b128 v[20:23], v4 offset:1024
    v_mul_f32 v70, v86, v70
    v_mfma_f32_16x16x32_bf16 v[80:83], v[36:39], v[228:231], v[80:83]
    v_mul_f32 v71, v87, v71
    v_mul_f32 v88, v8, v72
    v_mfma_f32_16x16x32_bf16 v[80:83], v[32:35], v[220:223], v[80:83]
    ds_read_b128 v[24:27], v4 offset:2048
    v_mul_f32 v89, v8, v73
    v_mfma_f32_16x16x32_bf16 v[80:83], v[28:31], v[212:215], v[80:83]
    s_waitcnt lgkmcnt(3)
    v_exp_f32 v88, v88
    v_mfma_f32_16x16x32_bf16 v[80:83], v[40:43], v[236:239], v[80:83]
    ds_read_b128 v[28:31], v4 offset:3072
    v_mul_f32 v90, v8, v74
    v_mfma_f32_16x16x32_bf16 v[80:83], v[44:47], v[244:247], v[80:83]
    buffer_load_dwordx4 v4, s[12:15], s26 offen offset:1024 sc1 lds
    v_mfma_f32_16x16x32_bf16 v[80:83], v[48:51], v[252:255], v[80:83]
    ds_read_b128 v[32:35], v4 offset:4096
    v_mul_f32 v91, v8, v75
    v_mfma_f32_16x16x32_bf16 v[76:79], v[48:51], v[248:251], v[76:79]
    v_exp_f32 v89, v89
    v_mfma_f32_16x16x32_bf16 v[76:79], v[44:47], v[240:243], v[76:79]
    ds_read_b128 v[36:39], v4 offset:5120
    v_add_f32 v88, 1.0, v88
    v_mfma_f32_16x16x32_bf16 v[76:79], v[40:43], v[232:235], v[76:79]
    s_waitcnt lgkmcnt(3)
    v_exp_f32 v90, v90
    v_mfma_f32_16x16x32_bf16 v[52:55], v[16:19], v[112:115], 0
    ds_read_b128 v[40:43], v4 offset:6144
    v_add_f32 v89, 1.0, v89
    v_mfma_f32_16x16x32_bf16 v[52:55], v[20:23], v[120:123], v[52:55]
    buffer_load_dwordx4 v4, s[12:15], s26 offen offset:2048 sc1 lds
    v_mfma_f32_16x16x32_bf16 v[52:55], v[24:27], v[128:131], v[52:55]
    ds_read_b128 v[44:47], v4 offset:7168
    v_add_f32 v90, 1.0, v90
    v_mfma_f32_16x16x32_bf16 v[56:59], v[24:27], v[132:135], 0
    v_exp_f32 v91, v91
    v_mfma_f32_16x16x32_bf16 v[56:59], v[20:23], v[124:127], v[56:59]
    ds_read_b128 v[48:51], v4 offset:8192
    v_add_f32 v91, 1.0, v91
    v_mfma_f32_16x16x32_bf16 v[56:59], v[16:19], v[116:119], v[56:59]
    s_waitcnt lgkmcnt(3)
    v_rcp_f32 v88, v88
    v_mfma_f32_16x16x32_bf16 v[56:59], v[28:31], v[140:143], v[56:59]
    ds_read_b128 v[16:19], v4 offset:9216
    v_mul_f32 v72, v88, v72
    v_mfma_f32_16x16x32_bf16 v[56:59], v[32:35], v[148:151], v[56:59]
    buffer_load_dwordx4 v4, s[12:15], s26 offen offset:3072 sc1 lds
    v_mfma_f32_16x16x32_bf16 v[56:59], v[36:39], v[156:159], v[56:59]
    ds_read_b128 v[20:23], v4 offset:10240
    s_add_u32 m0, s27, 77824
    v_mfma_f32_16x16x32_bf16 v[52:55], v[36:39], v[152:155], v[52:55]
    s_add_u32 s26, s26, 4096
    v_rcp_f32 v89, v89
    v_mfma_f32_16x16x32_bf16 v[52:55], v[32:35], v[144:147], v[52:55]
    ds_read_b128 v[24:27], v4 offset:11264
    v_mul_f32 v73, v89, v73
    v_mfma_f32_16x16x32_bf16 v[52:55], v[28:31], v[136:139], v[52:55]
    s_waitcnt lgkmcnt(3)
    v_rcp_f32 v90, v90
    v_mfma_f32_16x16x32_bf16 v[52:55], v[40:43], v[160:163], v[52:55]
    ds_read_b128 v[28:31], v4 offset:12288
    v_mul_f32 v74, v90, v74
    v_mfma_f32_16x16x32_bf16 v[52:55], v[44:47], v[168:171], v[52:55]
    buffer_load_dwordx4 v4, s[12:15], s26 offen offset:0 sc1 lds
    v_mfma_f32_16x16x32_bf16 v[52:55], v[48:51], v[176:179], v[52:55]
    ds_read_b128 v[32:35], v4 offset:13312
    v_mul_f32 v76, v68, v76
    v_mfma_f32_16x16x32_bf16 v[56:59], v[48:51], v[180:183], v[56:59]
    s_cmp_lg_u32 s100, 2
    s_cbranch_scc1 nohold_50
    buffer_store_dwordx4 a[248:251], v4, s[12:15], s62 offen sc1
    buffer_store_dwordx4 a[252:255], v4, s[12:15], s63 offen sc1
nohold_50:
    v_mfma_f32_16x16x32_bf16 v[56:59], v[44:47], v[172:175], v[56:59]
    ds_read_b128 v[36:39], v4 offset:14336
    v_mul_f32 v77, v69, v77
    v_mfma_f32_16x16x32_bf16 v[56:59], v[40:43], v[164:167], v[56:59]
    s_waitcnt lgkmcnt(3)
    v_rcp_f32 v91, v91
    v_mfma_f32_16x16x32_bf16 v[56:59], v[16:19], v[188:191], v[56:59]
    ds_read_b128 v[40:43], v4 offset:15360
    v_mul_f32 v75, v91, v75
    v_mfma_f32_16x16x32_bf16 v[56:59], v[20:23], v[196:199], v[56:59]
    buffer_load_dwordx4 v4, s[12:15], s26 offen offset:1024 sc1 lds
    v_mfma_f32_16x16x32_bf16 v[56:59], v[24:27], v[204:207], v[56:59]
    ds_read_b128 v[44:47], v4 offset:16384
    v_mul_f32 v78, v70, v78
    v_mfma_f32_16x16x32_bf16 v[52:55], v[24:27], v[200:203], v[52:55]
    v_mul_f32 v79, v71, v79
    v_cvt_pk_bf16_f32 v76, v76, v77
    v_mfma_f32_16x16x32_bf16 v[52:55], v[20:23], v[192:195], v[52:55]
    ds_read_b128 v[48:51], v4 offset:17408
    v_cvt_pk_bf16_f32 v78, v78, v79
    v_mfma_f32_16x16x32_bf16 v[52:55], v[16:19], v[184:187], v[52:55]
    s_waitcnt lgkmcnt(3)
    v_accvgpr_write_b32 a98, v76
    v_accvgpr_write_b32 a99, v78
    v_mfma_f32_16x16x32_bf16 v[52:55], v[28:31], v[208:211], v[52:55]
    ds_read_b128 v[16:19], v4 offset:18432
    v_mul_f32 v80, v72, v80
    v_mfma_f32_16x16x32_bf16 v[52:55], v[32:35], v[216:219], v[52:55]
    buffer_load_dwordx4 v4, s[12:15], s26 offen offset:2048 sc1 lds
    v_mfma_f32_16x16x32_bf16 v[52:55], v[36:39], v[224:227], v[52:55]
    ds_read_b128 v[20:23], v4 offset:19456
    v_mul_f32 v81, v73, v81
    v_mfma_f32_16x16x32_bf16 v[56:59], v[36:39], v[228:231], v[56:59]
    v_mul_f32 v82, v74, v82
    v_mul_f32 v83, v75, v83
    v_mfma_f32_16x16x32_bf16 v[56:59], v[32:35], v[220:223], v[56:59]
    ds_read_b128 v[24:27], v4 offset:20480
    v_cvt_pk_bf16_f32 v80, v80, v81
    v_mfma_f32_16x16x32_bf16 v[56:59], v[28:31], v[212:215], v[56:59]
    s_waitcnt lgkmcnt(3)
    v_cvt_pk_bf16_f32 v82, v82, v83
    v_accvgpr_write_b32 a102, v80
    v_mfma_f32_16x16x32_bf16 v[56:59], v[40:43], v[236:239], v[56:59]
    ds_read_b128 v[28:31], v4 offset:21504
    v_accvgpr_write_b32 a103, v82
    v_mfma_f32_16x16x32_bf16 v[56:59], v[44:47], v[244:247], v[56:59]
    buffer_load_dwordx4 v4, s[12:15], s26 offen offset:3072 sc1 lds
    v_mfma_f32_16x16x32_bf16 v[56:59], v[48:51], v[252:255], v[56:59]
    ds_read_b128 v[32:35], v4 offset:22528
    s_add_u32 m0, s27, 81920
    v_mfma_f32_16x16x32_bf16 v[52:55], v[48:51], v[248:251], v[52:55]
    s_add_u32 s26, s26, 4096
    v_mfma_f32_16x16x32_bf16 v[52:55], v[44:47], v[240:243], v[52:55]
    ds_read_b128 v[36:39], v4 offset:23552
    v_mfma_f32_16x16x32_bf16 v[52:55], v[40:43], v[232:235], v[52:55]
    s_waitcnt lgkmcnt(3)
    v_mfma_f32_16x16x32_bf16 v[60:63], v[16:19], v[112:115], 0
    ds_read_b128 v[40:43], v4 offset:24576
    v_mfma_f32_16x16x32_bf16 v[60:63], v[20:23], v[120:123], v[60:63]
    buffer_load_dwordx4 v4, s[12:15], s26 offen offset:0 sc1 lds
    v_mfma_f32_16x16x32_bf16 v[60:63], v[24:27], v[128:131], v[60:63]
    ds_read_b128 v[44:47], v4 offset:25600
    v_mfma_f32_16x16x32_bf16 v[64:67], v[24:27], v[132:135], 0
    v_mul_f32 v84, v7, v52
    v_mul_f32 v85, v7, v53
    v_mfma_f32_16x16x32_bf16 v[64:67], v[20:23], v[124:127], v[64:67]
    ds_read_b128 v[48:51], v4 offset:26624
    v_mul_f32 v86, v7, v54
    v_mfma_f32_16x16x32_bf16 v[64:67], v[16:19], v[116:119], v[64:67]
    s_waitcnt lgkmcnt(3)
    v_exp_f32 v84, v84
    v_mfma_f32_16x16x32_bf16 v[64:67], v[28:31], v[140:143], v[64:67]
    ds_read_b128 v[16:19], v4 offset:27648
    v_mul_f32 v87, v7, v55
    v_mfma_f32_16x16x32_bf16 v[64:67], v[32:35], v[148:151], v[64:67]
    v_exp_f32 v85, v85
    v_mfma_f32_16x16x32_bf16 v[64:67], v[36:39], v[156:159], v[64:67]
    ds_read_b128 v[20:23], v4 offset:28672
    v_add_f32 v84, 1.0, v84
    v_mfma_f32_16x16x32_bf16 v[60:63], v[36:39], v[152:155], v[60:63]
    v_exp_f32 v86, v86
    v_mfma_f32_16x16x32_bf16 v[60:63], v[32:35], v[144:147], v[60:63]
    ds_read_b128 v[24:27], v4 offset:29696
    v_add_f32 v85, 1.0, v85
    v_mfma_f32_16x16x32_bf16 v[60:63], v[28:31], v[136:139], v[60:63]
    s_waitcnt lgkmcnt(3)
    v_exp_f32 v87, v87
    v_mfma_f32_16x16x32_bf16 v[60:63], v[40:43], v[160:163], v[60:63]
    ds_read_b128 v[28:31], v4 offset:30720
    v_add_f32 v86, 1.0, v86
    v_mfma_f32_16x16x32_bf16 v[60:63], v[44:47], v[168:171], v[60:63]
    v_rcp_f32 v84, v84
    v_mfma_f32_16x16x32_bf16 v[60:63], v[48:51], v[176:179], v[60:63]
    ds_read_b128 v[32:35], v4 offset:31744
    v_add_f32 v87, 1.0, v87
    v_mfma_f32_16x16x32_bf16 v[64:67], v[48:51], v[180:183], v[64:67]
    buffer_store_dwordx4 a[96:99], v4, s[12:15], s28 offen offset:2048 sc1
    v_mfma_f32_16x16x32_bf16 v[64:67], v[44:47], v[172:175], v[64:67]
    ds_read_b128 v[36:39], v4 offset:32768
    v_mul_f32 v52, v84, v52
    v_mfma_f32_16x16x32_bf16 v[64:67], v[40:43], v[164:167], v[64:67]
    s_waitcnt lgkmcnt(3)
    v_rcp_f32 v85, v85
    v_mfma_f32_16x16x32_bf16 v[64:67], v[16:19], v[188:191], v[64:67]
    ds_read_b128 v[40:43], v4 offset:33792
    v_mul_f32 v53, v85, v53
    v_mfma_f32_16x16x32_bf16 v[64:67], v[20:23], v[196:199], v[64:67]
    v_rcp_f32 v86, v86
    v_mfma_f32_16x16x32_bf16 v[64:67], v[24:27], v[204:207], v[64:67]
    ds_read_b128 v[44:47], v4 offset:34816
    s_add_u32 m0, s27, 110592
    v_mfma_f32_16x16x32_bf16 v[60:63], v[24:27], v[200:203], v[60:63]
    s_add_u32 s26, s26, 28672
    v_rcp_f32 v87, v87
    v_mfma_f32_16x16x32_bf16 v[60:63], v[20:23], v[192:195], v[60:63]
    ds_read_b128 v[48:51], v4 offset:35840
    s_waitcnt vmcnt(12)
    s_barrier
    v_mfma_f32_16x16x32_bf16 v[60:63], v[16:19], v[184:187], v[60:63]
    s_waitcnt lgkmcnt(3)
    v_mul_f32 v54, v86, v54
    v_mul_f32 v55, v87, v55
    v_mfma_f32_16x16x32_bf16 v[60:63], v[28:31], v[208:211], v[60:63]
    ds_read_b128 v[16:19], v4 offset:36864
    v_mul_f32 v88, v8, v56
    v_mfma_f32_16x16x32_bf16 v[60:63], v[32:35], v[216:219], v[60:63]
    buffer_load_dwordx4 v4, s[12:15], s26 offen offset:0 sc1 lds
    v_mfma_f32_16x16x32_bf16 v[60:63], v[36:39], v[224:227], v[60:63]
    ds_read_b128 v[20:23], v4 offset:37888
    v_mul_f32 v89, v8, v57
    v_mfma_f32_16x16x32_bf16 v[64:67], v[36:39], v[228:231], v[64:67]
    v_exp_f32 v88, v88
    v_mfma_f32_16x16x32_bf16 v[64:67], v[32:35], v[220:223], v[64:67]
    ds_read_b128 v[24:27], v4 offset:38912
    v_mul_f32 v90, v8, v58
    v_mfma_f32_16x16x32_bf16 v[64:67], v[28:31], v[212:215], v[64:67]
    s_waitcnt lgkmcnt(3)
    v_exp_f32 v89, v89
    v_mfma_f32_16x16x32_bf16 v[64:67], v[40:43], v[236:239], v[64:67]
    ds_read_b128 v[28:31], v4 offset:39936
    v_mul_f32 v91, v8, v59
    v_mfma_f32_16x16x32_bf16 v[64:67], v[44:47], v[244:247], v[64:67]
    buffer_load_dwordx4 v4, s[12:15], s26 offen offset:1024 sc1 lds
    v_mfma_f32_16x16x32_bf16 v[64:67], v[48:51], v[252:255], v[64:67]
    ds_read_b128 v[32:35], v4 offset:40960
    v_add_f32 v88, 1.0, v88
    v_mfma_f32_16x16x32_bf16 v[60:63], v[48:51], v[248:251], v[60:63]
    s_waitcnt vmcnt(12)
    v_cmp_gt_u32 vcc, 1, v11
    s_cbranch_vccnz late_27
late_27_ok:
    v_mfma_f32_16x16x32_bf16 v[60:63], v[44:47], v[240:243], v[60:63]
    ds_read_b128 v[36:39], v4 offset:41984
    v_add_f32 v89, 1.0, v89
    v_mfma_f32_16x16x32_bf16 v[60:63], v[40:43], v[232:235], v[60:63]
    s_waitcnt lgkmcnt(3)
    v_exp_f32 v90, v90
    v_mfma_f32_16x16x32_bf16 v[68:71], v[16:19], v[112:115], 0
    ds_read_b128 v[40:43], v4 offset:43008
    v_add_f32 v90, 1.0, v90
    v_mfma_f32_16x16x32_bf16 v[68:71], v[20:23], v[120:123], v[68:71]
    buffer_load_dwordx4 a[8:11], v4, s[12:15], s29 offen offset:0 sc1
    v_mfma_f32_16x16x32_bf16 v[68:71], v[24:27], v[128:131], v[68:71]
    ds_read_b128 v[44:47], v4 offset:44032
    v_mfma_f32_16x16x32_bf16 v[72:75], v[24:27], v[132:135], 0
    buffer_load_dwordx4 v4, s[12:15], s26 offen offset:2048 sc1 lds
    v_mfma_f32_16x16x32_bf16 v[72:75], v[20:23], v[124:127], v[72:75]
    ds_read_b128 v[48:51], v4 offset:45056
    v_mul_f32 v60, v52, v60
    v_mfma_f32_16x16x32_bf16 v[72:75], v[16:19], v[116:119], v[72:75]
    s_waitcnt lgkmcnt(3)
    v_exp_f32 v91, v91
    v_mfma_f32_16x16x32_bf16 v[72:75], v[28:31], v[140:143], v[72:75]
    ds_read_b128 v[16:19], v4 offset:46080
    v_add_f32 v91, 1.0, v91
    v_mfma_f32_16x16x32_bf16 v[72:75], v[32:35], v[148:151], v[72:75]
    buffer_load_dwordx4 v4, s[12:15], s26 offen offset:3072 sc1 lds
    v_mfma_f32_16x16x32_bf16 v[72:75], v[36:39], v[156:159], v[72:75]
    ds_read_b128 v[20:23], v4 offset:47104
    s_add_u32 m0, s27, 114688
    v_mfma_f32_16x16x32_bf16 v[68:71], v[36:39], v[152:155], v[68:71]
    s_add_u32 s26, s26, 4096
    v_rcp_f32 v88, v88
    v_mfma_f32_16x16x32_bf16 v[68:71], v[32:35], v[144:147], v[68:71]
    ds_read_b128 v[24:27], v4 offset:48128
    v_mul_f32 v56, v88, v56
    v_mfma_f32_16x16x32_bf16 v[68:71], v[28:31], v[136:139], v[68:71]
    s_waitcnt lgkmcnt(3)
    v_rcp_f32 v89, v89
    v_mfma_f32_16x16x32_bf16 v[68:71], v[40:43], v[160:163], v[68:71]
    ds_read_b128 v[28:31], v4 offset:49152
    v_mul_f32 v57, v89, v57
    v_mfma_f32_16x16x32_bf16 v[68:71], v[44:47], v[168:171], v[68:71]
    buffer_load_dwordx4 v4, s[12:15], s26 offen offset:0 sc1 lds
    v_mfma_f32_16x16x32_bf16 v[68:71], v[48:51], v[176:179], v[68:71]
    ds_read_b128 v[32:35], v4 offset:50176
    v_mul_f32 v61, v53, v61
    v_mfma_f32_16x16x32_bf16 v[72:75], v[48:51], v[180:183], v[72:75]
    buffer_load_dwordx4 a[12:15], v4, s[12:15], s29 offen offset:1024 sc1
    v_mfma_f32_16x16x32_bf16 v[72:75], v[44:47], v[172:175], v[72:75]
    ds_read_b128 v[36:39], v4 offset:51200
    v_mul_f32 v62, v54, v62
    v_mfma_f32_16x16x32_bf16 v[72:75], v[40:43], v[164:167], v[72:75]
    s_waitcnt lgkmcnt(3)
    v_rcp_f32 v90, v90
    v_mfma_f32_16x16x32_bf16 v[72:75], v[16:19], v[188:191], v[72:75]
    ds_read_b128 v[40:43], v4 offset:52224
    v_mul_f32 v58, v90, v58
    v_mfma_f32_16x16x32_bf16 v[72:75], v[20:23], v[196:199], v[72:75]
    buffer_load_dwordx4 v4, s[12:15], s26 offen offset:1024 sc1 lds
    v_mfma_f32_16x16x32_bf16 v[72:75], v[24:27], v[204:207], v[72:75]
    ds_read_b128 v[44:47], v4 offset:53248
    v_mul_f32 v63, v55, v63
    v_mfma_f32_16x16x32_bf16 v[68:71], v[24:27], v[200:203], v[68:71]
    v_rcp_f32 v91, v91
    v_mfma_f32_16x16x32_bf16 v[68:71], v[20:23], v[192:195], v[68:71]
    ds_read_b128 v[48:51], v4 offset:54272
    v_mul_f32 v59, v91, v59
    v_mfma_f32_16x16x32_bf16 v[68:71], v[16:19], v[184:187], v[68:71]
    s_waitcnt lgkmcnt(3)
    v_cvt_pk_bf16_f32 v60, v60, v61
    v_cvt_pk_bf16_f32 v62, v62, v63
    v_mfma_f32_16x16x32_bf16 v[68:71], v[28:31], v[208:211], v[68:71]
    ds_read_b128 v[16:19], v4 offset:55296
    v_accvgpr_write_b32 a128, v60
    v_mfma_f32_16x16x32_bf16 v[68:71], v[32:35], v[216:219], v[68:71]
    buffer_load_dwordx4 v4, s[12:15], s26 offen offset:2048 sc1 lds
    v_mfma_f32_16x16x32_bf16 v[68:71], v[36:39], v[224:227], v[68:71]
    ds_read_b128 v[20:23], v4 offset:56320
    v_accvgpr_write_b32 a129, v62
    v_mfma_f32_16x16x32_bf16 v[72:75], v[36:39], v[228:231], v[72:75]
    v_mul_f32 v64, v56, v64
    v_mul_f32 v65, v57, v65
    v_mfma_f32_16x16x32_bf16 v[72:75], v[32:35], v[220:223], v[72:75]
    ds_read_b128 v[24:27], v4 offset:57344
    v_mul_f32 v66, v58, v66
    v_mfma_f32_16x16x32_bf16 v[72:75], v[28:31], v[212:215], v[72:75]
    s_waitcnt lgkmcnt(3)
    v_mul_f32 v67, v59, v67
    v_cvt_pk_bf16_f32 v64, v64, v65
    v_mfma_f32_16x16x32_bf16 v[72:75], v[40:43], v[236:239], v[72:75]
    ds_read_b128 v[28:31], v4 offset:58368
    v_cvt_pk_bf16_f32 v66, v66, v67
    v_mfma_f32_16x16x32_bf16 v[72:75], v[44:47], v[244:247], v[72:75]
    buffer_load_dwordx4 v4, s[12:15], s26 offen offset:3072 sc1 lds
    v_mfma_f32_16x16x32_bf16 v[72:75], v[48:51], v[252:255], v[72:75]
    ds_read_b128 v[32:35], v4 offset:59392
    s_add_u32 m0, s27, 118784
    v_mfma_f32_16x16x32_bf16 v[68:71], v[48:51], v[248:251], v[68:71]
    buffer_load_dwordx4 a[16:19], v4, s[12:15], s30 offen offset:0 sc1
    v_mfma_f32_16x16x32_bf16 v[68:71], v[44:47], v[240:243], v[68:71]
    ds_read_b128 v[36:39], v4 offset:60416
    s_add_u32 s26, s26, 4096
    v_mfma_f32_16x16x32_bf16 v[68:71], v[40:43], v[232:235], v[68:71]
    s_waitcnt lgkmcnt(3)
    v_accvgpr_write_b32 a132, v64
    v_accvgpr_write_b32 a133, v66
hop_4:
    s_cbranch_execz back_4
    v_mfma_f32_16x16x32_bf16 v[76:79], v[16:19], v[112:115], 0
    ds_read_b128 v[40:43], v4 offset:61440
    v_mfma_f32_16x16x32_bf16 v[76:79], v[20:23], v[120:123], v[76:79]
    buffer_load_dwordx4 v4, s[12:15], s26 offen offset:0 sc1 lds
    v_mfma_f32_16x16x32_bf16 v[76:79], v[24:27], v[128:131], v[76:79]
    ds_read_b128 v[44:47], v4 offset:62464
    v_mfma_f32_16x16x32_bf16 v[80:83], v[24:27], v[132:135], 0
    v_mul_f32 v84, v7, v68
    v_mul_f32 v85, v7, v69
    v_mfma_f32_16x16x32_bf16 v[80:83], v[20:23], v[124:127], v[80:83]
    ds_read_b128 v[48:51], v4 offset:63488
    v_mul_f32 v86, v7, v70
    v_mfma_f32_16x16x32_bf16 v[80:83], v[16:19], v[116:119], v[80:83]
    s_waitcnt lgkmcnt(3)
    v_exp_f32 v84, v84
    v_mfma_f32_16x16x32_bf16 v[80:83], v[28:31], v[140:143], v[80:83]
    ds_read_b128 v[16:19], v4 offset:64512
    v_mul_f32 v87, v7, v71
    v_mfma_f32_16x16x32_bf16 v[80:83], v[32:35], v[148:151], v[80:83]
    v_exp_f32 v85, v85
    v_mfma_f32_16x16x32_bf16 v[80:83], v[36:39], v[156:159], v[80:83]
    ds_read_b128 v[20:23], v5 offset:0
    v_add_f32 v84, 1.0, v84
    v_mfma_f32_16x16x32_bf16 v[76:79], v[36:39], v[152:155], v[76:79]
    v_exp_f32 v86, v86
    v_mfma_f32_16x16x32_bf16 v[76:79], v[32:35], v[144:147], v[76:79]
    ds_read_b128 v[24:27], v5 offset:1024
    v_add_f32 v85, 1.0, v85
    v_mfma_f32_16x16x32_bf16 v[76:79], v[28:31], v[136:139], v[76:79]
    s_waitcnt lgkmcnt(3)
    v_exp_f32 v87, v87
    v_mfma_f32_16x16x32_bf16 v[76:79], v[40:43], v[160:163], v[76:79]
    ds_read_b128 v[28:31], v5 offset:2048
    v_add_f32 v86, 1.0, v86
    v_mfma_f32_16x16x32_bf16 v[76:79], v[44:47], v[168:171], v[76:79]
    v_rcp_f32 v84, v84
    v_mfma_f32_16x16x32_bf16 v[76:79], v[48:51], v[176:179], v[76:79]
    ds_read_b128 v[32:35], v5 offset:3072
    v_add_f32 v87, 1.0, v87
    v_mfma_f32_16x16x32_bf16 v[80:83], v[48:51], v[180:183], v[80:83]
    buffer_store_dwordx4 a[100:103], v4, s[12:15], s28 offen offset:3072 sc1
    v_mfma_f32_16x16x32_bf16 v[80:83], v[44:47], v[172:175], v[80:83]
    ds_read_b128 v[36:39], v5 offset:4096
    s_add_u32 s28, s28, 4096
    v_mfma_f32_16x16x32_bf16 v[80:83], v[40:43], v[164:167], v[80:83]
    s_waitcnt lgkmcnt(3)
    v_rcp_f32 v85, v85
    v_mfma_f32_16x16x32_bf16 v[80:83], v[16:19], v[188:191], v[80:83]
    ds_read_b128 v[40:43], v5 offset:5120
    v_mul_f32 v68, v84, v68
    v_mfma_f32_16x16x32_bf16 v[80:83], v[20:23], v[196:199], v[80:83]
    buffer_load_dwordx4 a[20:23], v4, s[12:15], s30 offen offset:1024 sc1
    v_mfma_f32_16x16x32_bf16 v[80:83], v[24:27], v[204:207], v[80:83]
    ds_read_b128 v[44:47], v5 offset:6144
    s_add_u32 m0, s27, 0
    v_mfma_f32_16x16x32_bf16 v[76:79], v[24:27], v[200:203], v[76:79]
    s_add_u32 s26, s26, 28672
    v_rcp_f32 v86, v86
    v_mfma_f32_16x16x32_bf16 v[76:79], v[20:23], v[192:195], v[76:79]
    ds_read_b128 v[48:51], v5 offset:7168
    s_waitcnt vmcnt(15)
    s_barrier
    v_mfma_f32_16x16x32_bf16 v[76:79], v[16:19], v[184:187], v[76:79]
    s_waitcnt lgkmcnt(3)
    v_rcp_f32 v87, v87
    v_mfma_f32_16x16x32_bf16 v[76:79], v[28:31], v[208:211], v[76:79]
    ds_read_b128 v[16:19], v5 offset:8192
    v_mul_f32 v69, v85, v69
    v_mfma_f32_16x16x32_bf16 v[76:79], v[32:35], v[216:219], v[76:79]
    buffer_load_dwordx4 v4, s[12:15], s26 offen offset:0 sc1 lds
    v_mfma_f32_16x16x32_bf16 v[76:79], v[36:39], v[224:227], v[76:79]
    ds_read_b128 v[20:23], v5 offset:9216
    v_mul_f32 v70, v86, v70
    v_mfma_f32_16x16x32_bf16 v[80:83], v[36:39], v[228:231], v[80:83]
    v_mul_f32 v71, v87, v71
    v_mul_f32 v88, v8, v72
    v_mfma_f32_16x16x32_bf16 v[80:83], v[32:35], v[220:223], v[80:83]
    ds_read_b128 v[24:27], v5 offset:10240
    v_mul_f32 v89, v8, v73
    v_mfma_f32_16x16x32_bf16 v[80:83], v[28:31], v[212:215], v[80:83]
    s_waitcnt lgkmcnt(3)
    v_exp_f32 v88, v88
    v_mfma_f32_16x16x32_bf16 v[80:83], v[40:43], v[236:239], v[80:83]
    ds_read_b128 v[28:31], v5 offset:11264
    v_mul_f32 v90, v8, v74
    v_mfma_f32_16x16x32_bf16 v[80:83], v[44:47], v[244:247], v[80:83]
    buffer_load_dwordx4 v4, s[12:15], s26 offen offset:1024 sc1 lds
    v_mfma_f32_16x16x32_bf16 v[80:83], v[48:51], v[252:255], v[80:83]
    ds_read_b128 v[32:35], v5 offset:12288
    v_mul_f32 v91, v8, v75
    v_mfma_f32_16x16x32_bf16 v[76:79], v[48:51], v[248:251], v[76:79]
    buffer_load_dwordx4 a[24:27], v4, s[12:15], s31 offen offset:0 sc1
    v_mfma_f32_16x16x32_bf16 v[76:79], v[44:47], v[240:243], v[76:79]
    ds_read_b128 v[36:39], v5 offset:13312
    v_add_f32 v88, 1.0, v88
    v_mfma_f32_16x16x32_bf16 v[76:79], v[40:43], v[232:235], v[76:79]
    s_waitcnt lgkmcnt(3)
    v_exp_f32 v89, v89
    v_mfma_f32_16x16x32_bf16 v[52:55], v[16:19], v[112:115], 0
    ds_read_b128 v[40:43], v5 offset:14336
    v_add_f32 v89, 1.0, v89
    v_mfma_f32_16x16x32_bf16 v[52:55], v[20:23], v[120:123], v[52:55]
    buffer_load_dwordx4 v4, s[12:15], s26 offen offset:2048 sc1 lds
    v_mfma_f32_16x16x32_bf16 v[52:55], v[24:27], v[128:131], v[52:55]
    ds_read_b128 v[44:47], v5 offset:15360
    v_mfma_f32_16x16x32_bf16 v[56:59], v[24:27], v[132:135], 0
    s_cmp_lt_u32 s100, 2
    s_cbranch_scc1 nohold_51
    s_cmp_lg_u32 s23, 1
    s_cbranch_scc1 nohold_51
    v_mov_b32 v15, 1
    s_mov_b64 exec, 1
    buffer_atomic_add v15, off, s[12:15], s99 sc1
    s_mov_b64 exec, -1
nohold_51:
    v_mfma_f32_16x16x32_bf16 v[56:59], v[20:23], v[124:127], v[56:59]
    ds_read_b128 v[48:51], v5 offset:16384
    v_mul_f32 v76, v68, v76
    v_mfma_f32_16x16x32_bf16 v[56:59], v[16:19], v[116:119], v[56:59]
    s_waitcnt lgkmcnt(3)
    v_exp_f32 v90, v90
    v_mfma_f32_16x16x32_bf16 v[56:59], v[28:31], v[140:143], v[56:59]
    ds_read_b128 v[16:19], v5 offset:17408
    v_add_f32 v90, 1.0, v90
    v_mfma_f32_16x16x32_bf16 v[56:59], v[32:35], v[148:151], v[56:59]
    buffer_load_dwordx4 v4, s[12:15], s26 offen offset:3072 sc1 lds
    v_mfma_f32_16x16x32_bf16 v[56:59], v[36:39], v[156:159], v[56:59]
    ds_read_b128 v[20:23], v5 offset:18432
    s_add_u32 m0, s27, 4096
    v_mfma_f32_16x16x32_bf16 v[52:55], v[36:39], v[152:155], v[52:55]
    s_add_u32 s26, s26, 4096
    v_exp_f32 v91, v91
    v_mfma_f32_16x16x32_bf16 v[52:55], v[32:35], v[144:147], v[52:55]
    ds_read_b128 v[24:27], v5 offset:19456
    v_add_f32 v91, 1.0, v91
    v_mfma_f32_16x16x32_bf16 v[52:55], v[28:31], v[136:139], v[52:55]
    s_waitcnt lgkmcnt(3)
    v_rcp_f32 v88, v88
    v_mfma_f32_16x16x32_bf16 v[52:55], v[40:43], v[160:163], v[52:55]
    ds_read_b128 v[28:31], v5 offset:20480
    v_mul_f32 v72, v88, v72
    v_mfma_f32_16x16x32_bf16 v[52:55], v[44:47], v[168:171], v[52:55]
    buffer_load_dwordx4 v4, s[12:15], s26 offen offset:0 sc1 lds
    v_mfma_f32_16x16x32_bf16 v[52:55], v[48:51], v[176:179], v[52:55]
    ds_read_b128 v[32:35], v5 offset:21504
    v_mul_f32 v77, v69, v77
    v_mfma_f32_16x16x32_bf16 v[56:59], v[48:51], v[180:183], v[56:59]
    buffer_load_dwordx4 a[28:31], v4, s[12:15], s31 offen offset:1024 sc1
    v_mfma_f32_16x16x32_bf16 v[56:59], v[44:47], v[172:175], v[56:59]
    ds_read_b128 v[36:39], v5 offset:22528
    v_mul_f32 v78, v70, v78
    v_mfma_f32_16x16x32_bf16 v[56:59], v[40:43], v[164:167], v[56:59]
    s_waitcnt lgkmcnt(3)
    v_rcp_f32 v89, v89
    v_mfma_f32_16x16x32_bf16 v[56:59], v[16:19], v[188:191], v[56:59]
    ds_read_b128 v[40:43], v5 offset:23552
    v_mul_f32 v73, v89, v73
    v_mfma_f32_16x16x32_bf16 v[56:59], v[20:23], v[196:199], v[56:59]
    buffer_load_dwordx4 v4, s[12:15], s26 offen offset:1024 sc1 lds
    v_mfma_f32_16x16x32_bf16 v[56:59], v[24:27], v[204:207], v[56:59]
    ds_read_b128 v[44:47], v5 offset:24576
    v_mul_f32 v79, v71, v79
    v_mfma_f32_16x16x32_bf16 v[52:55], v[24:27], v[200:203], v[52:55]
    v_rcp_f32 v90, v90
    v_mfma_f32_16x16x32_bf16 v[52:55], v[20:23], v[192:195], v[52:55]
    ds_read_b128 v[48:51], v5 offset:25600
    v_mul_f32 v74, v90, v74
    v_mfma_f32_16x16x32_bf16 v[52:55], v[16:19], v[184:187], v[52:55]
    s_waitcnt lgkmcnt(3)
    v_rcp_f32 v91, v91
    v_mfma_f32_16x16x32_bf16 v[52:55], v[28:31], v[208:211], v[52:55]
    ds_read_b128 v[16:19], v5 offset:26624
    v_mul_f32 v75, v91, v75
    v_mfma_f32_16x16x32_bf16 v[52:55], v[32:35], v[216:219], v[52:55]
    buffer_load_dwordx4 v4, s[12:15], s26 offen offset:2048 sc1 lds
    v_mfma_f32_16x16x32_bf16 v[52:55], v[36:39], v[224:227], v[52:55]
    ds_read_b128 v[20:23], v5 offset:27648
    v_cvt_pk_bf16_f32 v76, v76, v77
    v_mfma_f32_16x16x32_bf16 v[56:59], v[36:39], v[228:231], v[56:59]
    v_cvt_pk_bf16_f32 v78, v78, v79
    v_accvgpr_write_b32 a130, v76
    v_mfma_f32_16x16x32_bf16 v[56:59], v[32:35], v[220:223], v[56:59]
    ds_read_b128 v[24:27], v5 offset:28672
    v_accvgpr_write_b32 a131, v78
    v_mfma_f32_16x16x32_bf16 v[56:59], v[28:31], v[212:215], v[56:59]
    s_waitcnt lgkmcnt(3)
    v_mul_f32 v80, v72, v80
    v_mul_f32 v81, v73, v81
    v_mfma_f32_16x16x32_bf16 v[56:59], v[40:43], v[236:239], v[56:59]
    ds_read_b128 v[28:31], v5 offset:29696
    v_mul_f32 v82, v74, v82
    v_mfma_f32_16x16x32_bf16 v[56:59], v[44:47], v[244:247], v[56:59]
    buffer_load_dwordx4 v4, s[12:15], s26 offen offset:3072 sc1 lds
    v_mfma_f32_16x16x32_bf16 v[56:59], v[48:51], v[252:255], v[56:59]
    ds_read_b128 v[32:35], v5 offset:30720
    s_add_u32 m0, s27, 8192
    v_mfma_f32_16x16x32_bf16 v[52:55], v[48:51], v[248:251], v[52:55]
    s_add_u32 s26, s26, 4096
    v_mul_f32 v83, v75, v83
    v_cvt_pk_bf16_f32 v80, v80, v81
    v_mfma_f32_16x16x32_bf16 v[52:55], v[44:47], v[240:243], v[52:55]
    ds_read_b128 v[36:39], v5 offset:31744
    v_cvt_pk_bf16_f32 v82, v82, v83
    v_mfma_f32_16x16x32_bf16 v[52:55], v[40:43], v[232:235], v[52:55]
    s_waitcnt lgkmcnt(3)
    v_accvgpr_write_b32 a134, v80
    v_accvgpr_write_b32 a135, v82
    v_mfma_f32_16x16x32_bf16 v[60:63], v[16:19], v[112:115], 0
    ds_read_b128 v[40:43], v5 offset:32768
    v_mfma_f32_16x16x32_bf16 v[60:63], v[20:23], v[120:123], v[60:63]
    buffer_load_dwordx4 v4, s[12:15], s26 offen offset:0 sc1 lds
    v_mfma_f32_16x16x32_bf16 v[60:63], v[24:27], v[128:131], v[60:63]
    ds_read_b128 v[44:47], v5 offset:33792
    v_mfma_f32_16x16x32_bf16 v[64:67], v[24:27], v[132:135], 0
    buffer_load_dwordx4 a[40:43], v4, s[12:15], s29 offen offset:2048 sc1
    v_mfma_f32_16x16x32_bf16 v[64:67], v[20:23], v[124:127], v[64:67]
    ds_read_b128 v[48:51], v5 offset:34816
    v_mov_b32 v15, 2
    v_mfma_f32_16x16x32_bf16 v[64:67], v[16:19], v[116:119], v[64:67]
    s_waitcnt lgkmcnt(3)
    s_waitcnt vmcnt(13)
    v_mul_f32 v84, v7, v52
    v_mfma_f32_16x16x32_bf16 v[64:67], v[28:31], v[140:143], v[64:67]
    ds_read_b128 v[16:19], v5 offset:35840
    v_mul_f32 v85, v7, v53
    v_mfma_f32_16x16x32_bf16 v[64:67], v[32:35], v[148:151], v[64:67]
    buffer_store_dword v15, v12, s[12:15], s32 offen sc1
    v_mfma_f32_16x16x32_bf16 v[64:67], v[36:39], v[156:159], v[64:67]
    ds_read_b128 v[20:23], v5 offset:36864
    v_mul_f32 v86, v7, v54
    v_mfma_f32_16x16x32_bf16 v[60:63], v[36:39], v[152:155], v[60:63]
    v_exp_f32 v84, v84
    v_mfma_f32_16x16x32_bf16 v[60:63], v[32:35], v[144:147], v[60:63]
    ds_read_b128 v[24:27], v5 offset:37888
    v_mul_f32 v87, v7, v55
    v_mfma_f32_16x16x32_bf16 v[60:63], v[28:31], v[136:139], v[60:63]
    s_waitcnt lgkmcnt(3)
    v_exp_f32 v85, v85
    v_mfma_f32_16x16x32_bf16 v[60:63], v[40:43], v[160:163], v[60:63]
    ds_read_b128 v[28:31], v5 offset:38912
    v_add_f32 v84, 1.0, v84
    v_mfma_f32_16x16x32_bf16 v[60:63], v[44:47], v[168:171], v[60:63]
    v_exp_f32 v86, v86
    v_mfma_f32_16x16x32_bf16 v[60:63], v[48:51], v[176:179], v[60:63]
    ds_read_b128 v[32:35], v5 offset:39936
    v_add_f32 v85, 1.0, v85
    v_mfma_f32_16x16x32_bf16 v[64:67], v[48:51], v[180:183], v[64:67]
    buffer_store_dwordx4 a[128:131], v4, s[12:15], s28 offen offset:0 sc1
    v_mfma_f32_16x16x32_bf16 v[64:67], v[44:47], v[172:175], v[64:67]
    ds_read_b128 v[36:39], v5 offset:40960
    v_add_f32 v86, 1.0, v86
    v_mfma_f32_16x16x32_bf16 v[64:67], v[40:43], v[164:167], v[64:67]
    s_waitcnt lgkmcnt(3)
    v_exp_f32 v87, v87
    v_mfma_f32_16x16x32_bf16 v[64:67], v[16:19], v[188:191], v[64:67]
    ds_read_b128 v[40:43], v5 offset:41984
    v_add_f32 v87, 1.0, v87
    v_mfma_f32_16x16x32_bf16 v[64:67], v[20:23], v[196:199], v[64:67]
    buffer_load_dwordx4 a[44:47], v4, s[12:15], s29 offen offset:3072 sc1
    v_mfma_f32_16x16x32_bf16 v[64:67], v[24:27], v[204:207], v[64:67]
    ds_read_b128 v[44:47], v5 offset:43008
    s_add_u32 m0, s27, 36864
    v_mfma_f32_16x16x32_bf16 v[60:63], v[24:27], v[200:203], v[60:63]
    s_add_u32 s26, s26, 28672
    v_rcp_f32 v84, v84
    v_mfma_f32_16x16x32_bf16 v[60:63], v[20:23], v[192:195], v[60:63]
    ds_read_b128 v[48:51], v5 offset:44032
    s_barrier
    v_mfma_f32_16x16x32_bf16 v[60:63], v[16:19], v[184:187], v[60:63]
    s_waitcnt lgkmcnt(3)
    v_rcp_f32 v85, v85
    v_mfma_f32_16x16x32_bf16 v[60:63], v[28:31], v[208:211], v[60:63]
    ds_read_b128 v[16:19], v5 offset:45056
    s_add_u32 s29, s29, 4096
    v_mfma_f32_16x16x32_bf16 v[60:63], v[32:35], v[216:219], v[60:63]
    buffer_load_dwordx4 v4, s[12:15], s26 offen offset:0 sc1 lds
    v_mfma_f32_16x16x32_bf16 v[60:63], v[36:39], v[224:227], v[60:63]
    ds_read_b128 v[20:23], v5 offset:46080
    v_mul_f32 v52, v84, v52
    v_mfma_f32_16x16x32_bf16 v[64:67], v[36:39], v[228:231], v[64:67]
    v_rcp_f32 v86, v86
    v_mfma_f32_16x16x32_bf16 v[64:67], v[32:35], v[220:223], v[64:67]
    ds_read_b128 v[24:27], v5 offset:47104
    v_mul_f32 v53, v85, v53
    v_mfma_f32_16x16x32_bf16 v[64:67], v[28:31], v[212:215], v[64:67]
    s_waitcnt lgkmcnt(3)
    v_rcp_f32 v87, v87
    v_mfma_f32_16x16x32_bf16 v[64:67], v[40:43], v[236:239], v[64:67]
    ds_read_b128 v[28:31], v5 offset:48128
    v_mul_f32 v54, v86, v54
    v_mfma_f32_16x16x32_bf16 v[64:67], v[44:47], v[244:247], v[64:67]
    buffer_load_dwordx4 v4, s[12:15], s26 offen offset:1024 sc1 lds
    v_mfma_f32_16x16x32_bf16 v[64:67], v[48:51], v[252:255], v[64:67]
    ds_read_b128 v[32:35], v5 offset:49152
    v_mul_f32 v55, v87, v55
    v_mfma_f32_16x16x32_bf16 v[60:63], v[48:51], v[248:251], v[60:63]
    v_mul_f32 v88, v8, v56
    v_mul_f32 v89, v8, v57
    v_mfma_f32_16x16x32_bf16 v[60:63], v[44:47], v[240:243], v[60:63]
    ds_read_b128 v[36:39], v5 offset:50176
    v_mul_f32 v90, v8, v58
    v_mfma_f32_16x16x32_bf16 v[60:63], v[40:43], v[232:235], v[60:63]
    s_waitcnt lgkmcnt(3)
    v_exp_f32 v88, v88
    v_mfma_f32_16x16x32_bf16 v[68:71], v[16:19], v[112:115], 0
    ds_read_b128 v[40:43], v5 offset:51200
    v_mul_f32 v91, v8, v59
    v_mfma_f32_16x16x32_bf16 v[68:71], v[20:23], v[120:123], v[68:71]
    buffer_load_dwordx4 v4, s[12:15], s26 offen offset:2048 sc1 lds
    v_mfma_f32_16x16x32_bf16 v[68:71], v[24:27], v[128:131], v[68:71]
    ds_read_b128 v[44:47], v5 offset:52224
    v_add_f32 v88, 1.0, v88
    v_mfma_f32_16x16x32_bf16 v[72:75], v[24:27], v[132:135], 0
    buffer_load_dwordx4 a[48:51], v4, s[12:15], s30 offen offset:2048 sc1
    v_mfma_f32_16x16x32_bf16 v[72:75], v[20:23], v[124:127], v[72:75]
    ds_read_b128 v[48:51], v5 offset:53248
    v_mul_f32 v60, v52, v60
    v_mfma_f32_16x16x32_bf16 v[72:75], v[16:19], v[116:119], v[72:75]
    s_waitcnt lgkmcnt(3)
    v_exp_f32 v89, v89
    v_mfma_f32_16x16x32_bf16 v[72:75], v[28:31], v[140:143], v[72:75]
    ds_read_b128 v[16:19], v5 offset:54272
    v_add_f32 v89, 1.0, v89
    v_mfma_f32_16x16x32_bf16 v[72:75], v[32:35], v[148:151], v[72:75]
    buffer_load_dwordx4 v4, s[12:15], s26 offen offset:3072 sc1 lds
    v_mfma_f32_16x16x32_bf16 v[72:75], v[36:39], v[156:159], v[72:75]
    ds_read_b128 v[20:23], v5 offset:55296
    s_add_u32 m0, s27, 40960
    v_mfma_f32_16x16x32_bf16 v[68:71], v[36:39], v[152:155], v[68:71]
    s_add_u32 s26, s26, 4096
    v_exp_f32 v90, v90
    v_mfma_f32_16x16x32_bf16 v[68:71], v[32:35], v[144:147], v[68:71]
    ds_read_b128 v[24:27], v5 offset:56320
    v_add_f32 v90, 1.0, v90
    v_mfma_f32_16x16x32_bf16 v[68:71], v[28:31], v[136:139], v[68:71]
    s_waitcnt lgkmcnt(3)
    v_exp_f32 v91, v91
    v_mfma_f32_16x16x32_bf16 v[68:71], v[40:43], v[160:163], v[68:71]
    ds_read_b128 v[28:31], v5 offset:57344
    v_add_f32 v91, 1.0, v91
    v_mfma_f32_16x16x32_bf16 v[68:71], v[44:47], v[168:171], v[68:71]
    buffer_load_dwordx4 v4, s[12:15], s26 offen offset:0 sc1 lds
    v_mfma_f32_16x16x32_bf16 v[68:71], v[48:51], v[176:179], v[68:71]
    ds_read_b128 v[32:35], v5 offset:58368
    v_mul_f32 v61, v53, v61
    v_mfma_f32_16x16x32_bf16 v[72:75], v[48:51], v[180:183], v[72:75]
    v_rcp_f32 v88, v88
    v_mfma_f32_16x16x32_bf16 v[72:75], v[44:47], v[172:175], v[72:75]
    ds_read_b128 v[36:39], v5 offset:59392
    v_mul_f32 v56, v88, v56
    v_mfma_f32_16x16x32_bf16 v[72:75], v[40:43], v[164:167], v[72:75]
    s_waitcnt lgkmcnt(3)
    v_rcp_f32 v89, v89
    v_mfma_f32_16x16x32_bf16 v[72:75], v[16:19], v[188:191], v[72:75]
    ds_read_b128 v[40:43], v5 offset:60416
    v_mul_f32 v57, v89, v57
    v_mfma_f32_16x16x32_bf16 v[72:75], v[20:23], v[196:199], v[72:75]
    buffer_load_dwordx4 v4, s[12:15], s26 offen offset:1024 sc1 lds
    v_mfma_f32_16x16x32_bf16 v[72:75], v[24:27], v[204:207], v[72:75]
    ds_read_b128 v[44:47], v5 offset:61440
    v_mul_f32 v62, v54, v62
    v_mfma_f32_16x16x32_bf16 v[68:71], v[24:27], v[200:203], v[68:71]
    buffer_load_dwordx4 a[52:55], v4, s[12:15], s30 offen offset:3072 sc1
    v_mfma_f32_16x16x32_bf16 v[68:71], v[20:23], v[192:195], v[68:71]
    ds_read_b128 v[48:51], v5 offset:62464
    s_add_u32 s30, s30, 4096
    v_mfma_f32_16x16x32_bf16 v[68:71], v[16:19], v[184:187], v[68:71]
    s_waitcnt lgkmcnt(3)
    v_rcp_f32 v90, v90
    v_mfma_f32_16x16x32_bf16 v[68:71], v[28:31], v[208:211], v[68:71]
    ds_read_b128 v[16:19], v5 offset:63488
    v_mul_f32 v58, v90, v58
    v_mfma_f32_16x16x32_bf16 v[68:71], v[32:35], v[216:219], v[68:71]
    buffer_load_dwordx4 v4, s[12:15], s26 offen offset:2048 sc1 lds
    v_mfma_f32_16x16x32_bf16 v[68:71], v[36:39], v[224:227], v[68:71]
    ds_read_b128 v[20:23], v5 offset:64512
    v_mul_f32 v63, v55, v63
    v_mfma_f32_16x16x32_bf16 v[72:75], v[36:39], v[228:231], v[72:75]
    buffer_load_dword v11, v102, s[12:15], s32 offen sc1
    v_mfma_f32_16x16x32_bf16 v[72:75], v[32:35], v[220:223], v[72:75]
    ds_read_b128 v[24:27], v6 offset:0
    v_cvt_pk_bf16_f32 v60, v60, v61
    v_mfma_f32_16x16x32_bf16 v[72:75], v[28:31], v[212:215], v[72:75]
    s_waitcnt lgkmcnt(3)
    v_rcp_f32 v91, v91
    v_mfma_f32_16x16x32_bf16 v[72:75], v[40:43], v[236:239], v[72:75]
    ds_read_b128 v[28:31], v6 offset:1024
    v_mul_f32 v59, v91, v59
    v_mfma_f32_16x16x32_bf16 v[72:75], v[44:47], v[244:247], v[72:75]
    buffer_load_dwordx4 v4, s[12:15], s26 offen offset:3072 sc1 lds
    v_mfma_f32_16x16x32_bf16 v[72:75], v[48:51], v[252:255], v[72:75]
    ds_read_b128 v[32:35], v6 offset:2048
    s_add_u32 m0, s27, 45056
    v_mfma_f32_16x16x32_bf16 v[68:71], v[48:51], v[248:251], v[68:71]
    s_add_u32 s26, s26, 4096
    v_mov_b32 v15, 1
    v_cvt_pk_bf16_f32 v62, v62, v63
    v_mfma_f32_16x16x32_bf16 v[68:71], v[44:47], v[240:243], v[68:71]
    ds_read_b128 v[36:39], v6 offset:3072
    v_accvgpr_write_b32 a160, v60
    v_mfma_f32_16x16x32_bf16 v[68:71], v[40:43], v[232:235], v[68:71]
    s_waitcnt lgkmcnt(3)
    v_accvgpr_write_b32 a161, v62
    v_mul_f32 v64, v56, v64
    v_mfma_f32_16x16x32_bf16 v[76:79], v[16:19], v[112:115], 0
    ds_read_b128 v[40:43], v6 offset:4096
    v_mul_f32 v65, v57, v65
    v_mfma_f32_16x16x32_bf16 v[76:79], v[20:23], v[120:123], v[76:79]
    buffer_load_dwordx4 v4, s[12:15], s26 offen offset:0 sc1 lds
    v_mfma_f32_16x16x32_bf16 v[76:79], v[24:27], v[128:131], v[76:79]
    ds_read_b128 v[44:47], v6 offset:5120
    v_mul_f32 v66, v58, v66
    v_mfma_f32_16x16x32_bf16 v[80:83], v[24:27], v[132:135], 0
    buffer_store_dword v15, v13, s[12:15], s33 offen sc1
    v_mfma_f32_16x16x32_bf16 v[80:83], v[20:23], v[124:127], v[80:83]
    ds_read_b128 v[48:51], v6 offset:6144
    v_mul_f32 v67, v59, v67
    v_mfma_f32_16x16x32_bf16 v[80:83], v[16:19], v[116:119], v[80:83]
    s_waitcnt lgkmcnt(3)
    v_cvt_pk_bf16_f32 v64, v64, v65
    v_cvt_pk_bf16_f32 v66, v66, v67
    v_mfma_f32_16x16x32_bf16 v[80:83], v[28:31], v[140:143], v[80:83]
    ds_read_b128 v[16:19], v6 offset:7168
    v_accvgpr_write_b32 a164, v64
    v_mfma_f32_16x16x32_bf16 v[80:83], v[32:35], v[148:151], v[80:83]
    buffer_load_dwordx4 a[56:59], v4, s[12:15], s31 offen offset:2048 sc1
    v_mfma_f32_16x16x32_bf16 v[80:83], v[36:39], v[156:159], v[80:83]
    ds_read_b128 v[20:23], v6 offset:8192
    v_accvgpr_write_b32 a165, v66
    v_mfma_f32_16x16x32_bf16 v[76:79], v[36:39], v[152:155], v[76:79]
    v_mul_f32 v84, v7, v68
    v_mul_f32 v85, v7, v69
    v_mfma_f32_16x16x32_bf16 v[76:79], v[32:35], v[144:147], v[76:79]
    ds_read_b128 v[24:27], v6 offset:9216
    v_mul_f32 v86, v7, v70
    v_mfma_f32_16x16x32_bf16 v[76:79], v[28:31], v[136:139], v[76:79]
    s_waitcnt lgkmcnt(3)
    v_exp_f32 v84, v84
    v_mfma_f32_16x16x32_bf16 v[76:79], v[40:43], v[160:163], v[76:79]
    ds_read_b128 v[28:31], v6 offset:10240
    v_mul_f32 v87, v7, v71
    v_mfma_f32_16x16x32_bf16 v[76:79], v[44:47], v[168:171], v[76:79]
    v_exp_f32 v85, v85
    v_mfma_f32_16x16x32_bf16 v[76:79], v[48:51], v[176:179], v[76:79]
    ds_read_b128 v[32:35], v6 offset:11264
    v_add_f32 v84, 1.0, v84
    v_mfma_f32_16x16x32_bf16 v[80:83], v[48:51], v[180:183], v[80:83]
    buffer_store_dwordx4 a[132:135], v4, s[12:15], s28 offen offset:1024 sc1
    v_mfma_f32_16x16x32_bf16 v[80:83], v[44:47], v[172:175], v[80:83]
    ds_read_b128 v[36:39], v6 offset:12288
    v_add_f32 v85, 1.0, v85
    v_mfma_f32_16x16x32_bf16 v[80:83], v[40:43], v[164:167], v[80:83]
    s_waitcnt lgkmcnt(3)
    v_exp_f32 v86, v86
    v_mfma_f32_16x16x32_bf16 v[80:83], v[16:19], v[188:191], v[80:83]
    ds_read_b128 v[40:43], v6 offset:13312
    v_add_f32 v86, 1.0, v86
    v_mfma_f32_16x16x32_bf16 v[80:83], v[20:23], v[196:199], v[80:83]
    buffer_load_dwordx4 a[60:63], v4, s[12:15], s31 offen offset:3072 sc1
    v_mfma_f32_16x16x32_bf16 v[80:83], v[24:27], v[204:207], v[80:83]
    ds_read_b128 v[44:47], v6 offset:14336
    s_add_u32 m0, s27, 73728
    v_mfma_f32_16x16x32_bf16 v[76:79], v[24:27], v[200:203], v[76:79]
    s_add_u32 s26, s26, 28672
    v_exp_f32 v87, v87
    v_mfma_f32_16x16x32_bf16 v[76:79], v[20:23], v[192:195], v[76:79]
    ds_read_b128 v[48:51], v6 offset:15360
    s_waitcnt vmcnt(20)
    s_barrier
    v_mfma_f32_16x16x32_bf16 v[76:79], v[16:19], v[184:187], v[76:79]
    s_waitcnt lgkmcnt(3)
    v_rcp_f32 v84, v84
    v_mfma_f32_16x16x32_bf16 v[76:79], v[28:31], v[208:211], v[76:79]
    ds_read_b128 v[16:19], v4 offset:0
    s_add_u32 s31, s31, 4096
    v_mfma_f32_16x16x32_bf16 v[76:79], v[32:35], v[216:219], v[76:79]
    buffer_load_dwordx4 v4, s[12:15], s26 offen offset:0 sc1 lds
    v_mfma_f32_16x16x32_bf16 v[76:79], v[36:39], v[224:227], v[76:79]
    ds_read_b128 v[20:23], v4 offset:1024
    v_add_f32 v87, 1.0, v87
    v_mfma_f32_16x16x32_bf16 v[80:83], v[36:39], v[228:231], v[80:83]
    v_rcp_f32 v85, v85
    v_mfma_f32_16x16x32_bf16 v[80:83], v[32:35], v[220:223], v[80:83]
    ds_read_b128 v[24:27], v4 offset:2048
    v_mul_f32 v68, v84, v68
    v_mfma_f32_16x16x32_bf16 v[80:83], v[28:31], v[212:215], v[80:83]
    s_waitcnt lgkmcnt(3)
    v_rcp_f32 v86, v86
    v_mfma_f32_16x16x32_bf16 v[80:83], v[40:43], v[236:239], v[80:83]
    ds_read_b128 v[28:31], v4 offset:3072
    v_mul_f32 v69, v85, v69
    v_mfma_f32_16x16x32_bf16 v[80:83], v[44:47], v[244:247], v[80:83]
    buffer_load_dwordx4 v4, s[12:15], s26 offen offset:1024 sc1 lds
    v_mfma_f32_16x16x32_bf16 v[80:83], v[48:51], v[252:255], v[80:83]
    ds_read_b128 v[32:35], v4 offset:4096
    v_mul_f32 v70, v86, v70
    v_mfma_f32_16x16x32_bf16 v[76:79], v[48:51], v[248:251], v[76:79]
    v_rcp_f32 v87, v87
    v_mfma_f32_16x16x32_bf16 v[76:79], v[44:47], v[240:243], v[76:79]
    ds_read_b128 v[36:39], v4 offset:5120
    v_mul_f32 v71, v87, v71
    v_mfma_f32_16x16x32_bf16 v[76:79], v[40:43], v[232:235], v[76:79]
    s_waitcnt lgkmcnt(3)
    v_mul_f32 v88, v8, v72
    v_mul_f32 v89, v8, v73
    v_mfma_f32_16x16x32_bf16 v[52:55], v[16:19], v[112:115], 0
    ds_read_b128 v[40:43], v4 offset:6144
    v_mul_f32 v90, v8, v74
    v_mfma_f32_16x16x32_bf16 v[52:55], v[20:23], v[120:123], v[52:55]
    buffer_load_dwordx4 v4, s[12:15], s26 offen offset:2048 sc1 lds
    v_mfma_f32_16x16x32_bf16 v[52:55], v[24:27], v[128:131], v[52:55]
    ds_read_b128 v[44:47], v4 offset:7168
    v_mul_f32 v91, v8, v75
    v_mfma_f32_16x16x32_bf16 v[56:59], v[24:27], v[132:135], 0
    v_exp_f32 v88, v88
    v_mfma_f32_16x16x32_bf16 v[56:59], v[20:23], v[124:127], v[56:59]
    ds_read_b128 v[48:51], v4 offset:8192
    v_add_f32 v88, 1.0, v88
    v_mfma_f32_16x16x32_bf16 v[56:59], v[16:19], v[116:119], v[56:59]
    s_waitcnt lgkmcnt(3)
    v_exp_f32 v89, v89
    v_mfma_f32_16x16x32_bf16 v[56:59], v[28:31], v[140:143], v[56:59]
    ds_read_b128 v[16:19], v4 offset:9216
    v_add_f32 v89, 1.0, v89
    v_mfma_f32_16x16x32_bf16 v[56:59], v[32:35], v[148:151], v[56:59]
    buffer_load_dwordx4 v4, s[12:15], s26 offen offset:3072 sc1 lds
    v_mfma_f32_16x16x32_bf16 v[56:59], v[36:39], v[156:159], v[56:59]
    ds_read_b128 v[20:23], v4 offset:10240
    s_add_u32 m0, s27, 77824
    v_mfma_f32_16x16x32_bf16 v[52:55], v[36:39], v[152:155], v[52:55]
    s_add_u32 s26, s26, 4096
    v_exp_f32 v90, v90
    v_mfma_f32_16x16x32_bf16 v[52:55], v[32:35], v[144:147], v[52:55]
    ds_read_b128 v[24:27], v4 offset:11264
    v_add_f32 v90, 1.0, v90
    v_mfma_f32_16x16x32_bf16 v[52:55], v[28:31], v[136:139], v[52:55]
    s_waitcnt lgkmcnt(3)
    v_exp_f32 v91, v91
    v_mfma_f32_16x16x32_bf16 v[52:55], v[40:43], v[160:163], v[52:55]
    ds_read_b128 v[28:31], v4 offset:12288
    v_add_f32 v91, 1.0, v91
    v_mfma_f32_16x16x32_bf16 v[52:55], v[44:47], v[168:171], v[52:55]
    buffer_load_dwordx4 v4, s[12:15], s26 offen offset:0 sc1 lds
    v_mfma_f32_16x16x32_bf16 v[52:55], v[48:51], v[176:179], v[52:55]
    ds_read_b128 v[32:35], v4 offset:13312
    v_mul_f32 v76, v68, v76
    v_mfma_f32_16x16x32_bf16 v[56:59], v[48:51], v[180:183], v[56:59]
    s_waitcnt vmcnt(11)
    v_cmp_gt_u32 vcc, 2, v11
    s_cbranch_vccnz late_28
late_28_ok:
    v_mfma_f32_16x16x32_bf16 v[56:59], v[44:47], v[172:175], v[56:59]
    ds_read_b128 v[36:39], v4 offset:14336
    v_mul_f32 v77, v69, v77
    v_mfma_f32_16x16x32_bf16 v[56:59], v[40:43], v[164:167], v[56:59]
    s_waitcnt lgkmcnt(3)
    v_rcp_f32 v88, v88
    v_mfma_f32_16x16x32_bf16 v[56:59], v[16:19], v[188:191], v[56:59]
    ds_read_b128 v[40:43], v4 offset:15360
    v_mul_f32 v72, v88, v72
    v_mfma_f32_16x16x32_bf16 v[56:59], v[20:23], v[196:199], v[56:59]
    buffer_load_dwordx4 v4, s[12:15], s26 offen offset:1024 sc1 lds
    v_mfma_f32_16x16x32_bf16 v[56:59], v[24:27], v[204:207], v[56:59]
    ds_read_b128 v[44:47], v4 offset:16384
    v_mul_f32 v78, v70, v78
    v_mfma_f32_16x16x32_bf16 v[52:55], v[24:27], v[200:203], v[52:55]
    buffer_load_dwordx4 a[72:75], v4, s[12:15], s29 offen offset:0 sc1
    v_mfma_f32_16x16x32_bf16 v[52:55], v[20:23], v[192:195], v[52:55]
    ds_read_b128 v[48:51], v4 offset:17408
    v_mul_f32 v79, v71, v79
    v_mfma_f32_16x16x32_bf16 v[52:55], v[16:19], v[184:187], v[52:55]
    s_waitcnt lgkmcnt(3)
    v_rcp_f32 v89, v89
    v_mfma_f32_16x16x32_bf16 v[52:55], v[28:31], v[208:211], v[52:55]
    ds_read_b128 v[16:19], v4 offset:18432
    v_mul_f32 v73, v89, v73
    v_mfma_f32_16x16x32_bf16 v[52:55], v[32:35], v[216:219], v[52:55]
    buffer_load_dwordx4 v4, s[12:15], s26 offen offset:2048 sc1 lds
    v_mfma_f32_16x16x32_bf16 v[52:55], v[36:39], v[224:227], v[52:55]
    ds_read_b128 v[20:23], v4 offset:19456
    v_cvt_pk_bf16_f32 v76, v76, v77
    v_mfma_f32_16x16x32_bf16 v[56:59], v[36:39], v[228:231], v[56:59]
    v_rcp_f32 v90, v90
    v_mfma_f32_16x16x32_bf16 v[56:59], v[32:35], v[220:223], v[56:59]
    ds_read_b128 v[24:27], v4 offset:20480
    v_mul_f32 v74, v90, v74
    v_mfma_f32_16x16x32_bf16 v[56:59], v[28:31], v[212:215], v[56:59]
    s_waitcnt lgkmcnt(3)
    v_rcp_f32 v91, v91
    v_mfma_f32_16x16x32_bf16 v[56:59], v[40:43], v[236:239], v[56:59]
    ds_read_b128 v[28:31], v4 offset:21504
    v_mul_f32 v75, v91, v75
    v_mfma_f32_16x16x32_bf16 v[56:59], v[44:47], v[244:247], v[56:59]
    buffer_load_dwordx4 v4, s[12:15], s26 offen offset:3072 sc1 lds
    v_mfma_f32_16x16x32_bf16 v[56:59], v[48:51], v[252:255], v[56:59]
    ds_read_b128 v[32:35], v4 offset:22528
    s_add_u32 m0, s27, 81920
    v_mfma_f32_16x16x32_bf16 v[52:55], v[48:51], v[248:251], v[52:55]
    s_add_u32 s26, s26, 4096
    v_cvt_pk_bf16_f32 v78, v78, v79
    v_accvgpr_write_b32 a162, v76
    v_mfma_f32_16x16x32_bf16 v[52:55], v[44:47], v[240:243], v[52:55]
    ds_read_b128 v[36:39], v4 offset:23552
    v_accvgpr_write_b32 a163, v78
    v_mfma_f32_16x16x32_bf16 v[52:55], v[40:43], v[232:235], v[52:55]
    s_waitcnt lgkmcnt(3)
    v_mul_f32 v80, v72, v80
    v_mul_f32 v81, v73, v81
    v_mfma_f32_16x16x32_bf16 v[60:63], v[16:19], v[112:115], 0
    ds_read_b128 v[40:43], v4 offset:24576
    v_mul_f32 v82, v74, v82
    v_mfma_f32_16x16x32_bf16 v[60:63], v[20:23], v[120:123], v[60:63]
    buffer_load_dwordx4 v4, s[12:15], s26 offen offset:0 sc1 lds
hop_5:
    s_cbranch_execz back_5
    v_mfma_f32_16x16x32_bf16 v[60:63], v[24:27], v[128:131], v[60:63]
    ds_read_b128 v[44:47], v4 offset:25600
    v_mul_f32 v83, v75, v83
    v_mfma_f32_16x16x32_bf16 v[64:67], v[24:27], v[132:135], 0
    buffer_load_dwordx4 a[76:79], v4, s[12:15], s29 offen offset:1024 sc1
    v_mfma_f32_16x16x32_bf16 v[64:67], v[20:23], v[124:127], v[64:67]
    ds_read_b128 v[48:51], v4 offset:26624
    v_cvt_pk_bf16_f32 v80, v80, v81
    v_mfma_f32_16x16x32_bf16 v[64:67], v[16:19], v[116:119], v[64:67]
    s_waitcnt lgkmcnt(3)
    v_cvt_pk_bf16_f32 v82, v82, v83
    v_accvgpr_write_b32 a166, v80
    v_mfma_f32_16x16x32_bf16 v[64:67], v[28:31], v[140:143], v[64:67]
    ds_read_b128 v[16:19], v4 offset:27648
    v_accvgpr_write_b32 a167, v82
    v_mfma_f32_16x16x32_bf16 v[64:67], v[32:35], v[148:151], v[64:67]
    v_mul_f32 v84, v7, v52
    v_mul_f32 v85, v7, v53
    v_mfma_f32_16x16x32_bf16 v[64:67], v[36:39], v[156:159], v[64:67]
    ds_read_b128 v[20:23], v4 offset:28672
    v_mul_f32 v86, v7, v54
    v_mfma_f32_16x16x32_bf16 v[60:63], v[36:39], v[152:155], v[60:63]
    v_exp_f32 v84, v84
    v_mfma_f32_16x16x32_bf16 v[60:63], v[32:35], v[144:147], v[60:63]
    ds_read_b128 v[24:27], v4 offset:29696
    v_mul_f32 v87, v7, v55
    v_mfma_f32_16x16x32_bf16 v[60:63], v[28:31], v[136:139], v[60:63]
    s_waitcnt lgkmcnt(3)
    v_exp_f32 v85, v85
    v_mfma_f32_16x16x32_bf16 v[60:63], v[40:43], v[160:163], v[60:63]
    ds_read_b128 v[28:31], v4 offset:30720
    v_add_f32 v84, 1.0, v84
    v_mfma_f32_16x16x32_bf16 v[60:63], v[44:47], v[168:171], v[60:63]
    v_exp_f32 v86, v86
    v_mfma_f32_16x16x32_bf16 v[60:63], v[48:51], v[176:179], v[60:63]
    ds_read_b128 v[32:35], v4 offset:31744
    v_add_f32 v85, 1.0, v85
    v_mfma_f32_16x16x32_bf16 v[64:67], v[48:51], v[180:183], v[64:67]
    buffer_store_dwordx4 a[160:163], v4, s[12:15], s28 offen offset:2048 sc1
    v_mfma_f32_16x16x32_bf16 v[64:67], v[44:47], v[172:175], v[64:67]
    ds_read_b128 v[36:39], v4 offset:32768
    v_add_f32 v86, 1.0, v86
    v_mfma_f32_16x16x32_bf16 v[64:67], v[40:43], v[164:167], v[64:67]
    s_waitcnt lgkmcnt(3)
    v_exp_f32 v87, v87
    v_mfma_f32_16x16x32_bf16 v[64:67], v[16:19], v[188:191], v[64:67]
    ds_read_b128 v[40:43], v4 offset:33792
    v_add_f32 v87, 1.0, v87
    v_mfma_f32_16x16x32_bf16 v[64:67], v[20:23], v[196:199], v[64:67]
    buffer_load_dwordx4 a[80:83], v4, s[12:15], s30 offen offset:0 sc1
    v_mfma_f32_16x16x32_bf16 v[64:67], v[24:27], v[204:207], v[64:67]
    ds_read_b128 v[44:47], v4 offset:34816
    s_add_u32 m0, s27, 110592
    v_mfma_f32_16x16x32_bf16 v[60:63], v[24:27], v[200:203], v[60:63]
    s_add_u32 s26, s26, 28672
    v_rcp_f32 v84, v84
    v_mfma_f32_16x16x32_bf16 v[60:63], v[20:23], v[192:195], v[60:63]
    ds_read_b128 v[48:51], v4 offset:35840
    s_waitcnt vmcnt(17)
    s_barrier
    v_mfma_f32_16x16x32_bf16 v[60:63], v[16:19], v[184:187], v[60:63]
    s_waitcnt lgkmcnt(3)
    v_rcp_f32 v85, v85
    v_mfma_f32_16x16x32_bf16 v[60:63], v[28:31], v[208:211], v[60:63]
    ds_read_b128 v[16:19], v4 offset:36864
    s_lshl_b32 s41, s21, 8
    v_mfma_f32_16x16x32_bf16 v[60:63], v[32:35], v[216:219], v[60:63]
    buffer_load_dwordx4 v4, s[12:15], s26 offen offset:0 sc1 lds
    v_mfma_f32_16x16x32_bf16 v[60:63], v[36:39], v[224:227], v[60:63]
    ds_read_b128 v[20:23], v4 offset:37888
    s_add_u32 s41, s41, 16875520
    v_mfma_f32_16x16x32_bf16 v[64:67], v[36:39], v[228:231], v[64:67]
    s_lshl_b32 s42, 36, s3
    v_rcp_f32 v86, v86
    v_mfma_f32_16x16x32_bf16 v[64:67], v[32:35], v[220:223], v[64:67]
    ds_read_b128 v[24:27], v4 offset:38912
    v_mul_f32 v52, v84, v52
    v_mfma_f32_16x16x32_bf16 v[64:67], v[28:31], v[212:215], v[64:67]
    s_waitcnt lgkmcnt(3)
    v_rcp_f32 v87, v87
    v_mfma_f32_16x16x32_bf16 v[64:67], v[40:43], v[236:239], v[64:67]
    ds_read_b128 v[28:31], v4 offset:39936
    v_mul_f32 v53, v85, v53
    v_mfma_f32_16x16x32_bf16 v[64:67], v[44:47], v[244:247], v[64:67]
    buffer_load_dword v11, off, s[12:15], s41 sc1
    v_mfma_f32_16x16x32_bf16 v[64:67], v[48:51], v[252:255], v[64:67]
    ds_read_b128 v[32:35], v4 offset:40960
    v_mul_f32 v54, v86, v54
    v_mfma_f32_16x16x32_bf16 v[60:63], v[48:51], v[248:251], v[60:63]
    buffer_load_dwordx4 v4, s[12:15], s26 offen offset:1024 sc1 lds
    v_mfma_f32_16x16x32_bf16 v[60:63], v[44:47], v[240:243], v[60:63]
    ds_read_b128 v[36:39], v4 offset:41984
    v_mul_f32 v55, v87, v55
    v_mfma_f32_16x16x32_bf16 v[60:63], v[40:43], v[232:235], v[60:63]
    s_waitcnt lgkmcnt(3)
    v_mul_f32 v88, v8, v56
    v_mul_f32 v89, v8, v57
    v_mfma_f32_16x16x32_bf16 v[68:71], v[16:19], v[112:115], 0
    ds_read_b128 v[40:43], v4 offset:43008
    v_mul_f32 v90, v8, v58
    v_mfma_f32_16x16x32_bf16 v[68:71], v[20:23], v[120:123], v[68:71]
    buffer_load_dwordx4 v4, s[12:15], s26 offen offset:2048 sc1 lds
    v_mfma_f32_16x16x32_bf16 v[68:71], v[24:27], v[128:131], v[68:71]
    ds_read_b128 v[44:47], v4 offset:44032
    v_mul_f32 v91, v8, v59
    v_mfma_f32_16x16x32_bf16 v[72:75], v[24:27], v[132:135], 0
    buffer_load_dwordx4 a[84:87], v4, s[12:15], s30 offen offset:1024 sc1
    v_mfma_f32_16x16x32_bf16 v[72:75], v[20:23], v[124:127], v[72:75]
    ds_read_b128 v[48:51], v4 offset:45056
    v_mul_f32 v60, v52, v60
    v_mfma_f32_16x16x32_bf16 v[72:75], v[16:19], v[116:119], v[72:75]
    s_waitcnt lgkmcnt(3)
    v_exp_f32 v88, v88
    v_mfma_f32_16x16x32_bf16 v[72:75], v[28:31], v[140:143], v[72:75]
    ds_read_b128 v[16:19], v4 offset:46080
    v_add_f32 v88, 1.0, v88
    v_mfma_f32_16x16x32_bf16 v[72:75], v[32:35], v[148:151], v[72:75]
    buffer_load_dwordx4 v4, s[12:15], s26 offen offset:3072 sc1 lds
    v_mfma_f32_16x16x32_bf16 v[72:75], v[36:39], v[156:159], v[72:75]
    ds_read_b128 v[20:23], v4 offset:47104
    s_add_u32 m0, s27, 114688
    v_mfma_f32_16x16x32_bf16 v[68:71], v[36:39], v[152:155], v[68:71]
    s_add_u32 s26, s26, 4096
    v_exp_f32 v89, v89
    v_mfma_f32_16x16x32_bf16 v[68:71], v[32:35], v[144:147], v[68:71]
    ds_read_b128 v[24:27], v4 offset:48128
    v_add_f32 v89, 1.0, v89
    v_mfma_f32_16x16x32_bf16 v[68:71], v[28:31], v[136:139], v[68:71]
    s_waitcnt lgkmcnt(3)
    v_exp_f32 v90, v90
    v_mfma_f32_16x16x32_bf16 v[68:71], v[40:43], v[160:163], v[68:71]
    ds_read_b128 v[28:31], v4 offset:49152
    v_add_f32 v90, 1.0, v90
    v_mfma_f32_16x16x32_bf16 v[68:71], v[44:47], v[168:171], v[68:71]
    buffer_load_dwordx4 v4, s[12:15], s26 offen offset:0 sc1 lds
    v_mfma_f32_16x16x32_bf16 v[68:71], v[48:51], v[176:179], v[68:71]
    ds_read_b128 v[32:35], v4 offset:50176
    v_mul_f32 v61, v53, v61
    v_mfma_f32_16x16x32_bf16 v[72:75], v[48:51], v[180:183], v[72:75]
    v_exp_f32 v91, v91
    v_mfma_f32_16x16x32_bf16 v[72:75], v[44:47], v[172:175], v[72:75]
    ds_read_b128 v[36:39], v4 offset:51200
    v_add_f32 v91, 1.0, v91
    v_mfma_f32_16x16x32_bf16 v[72:75], v[40:43], v[164:167], v[72:75]
    s_waitcnt lgkmcnt(3)
    v_rcp_f32 v88, v88
    v_mfma_f32_16x16x32_bf16 v[72:75], v[16:19], v[188:191], v[72:75]
    ds_read_b128 v[40:43], v4 offset:52224
    v_mul_f32 v56, v88, v56
    v_mfma_f32_16x16x32_bf16 v[72:75], v[20:23], v[196:199], v[72:75]
    buffer_store_dwordx4 a[164:167], v4, s[12:15], s28 offen offset:3072 sc1
    s_add_u32 s28, s28, 4096
    v_mfma_f32_16x16x32_bf16 v[72:75], v[24:27], v[204:207], v[72:75]
    ds_read_b128 v[44:47], v4 offset:53248
    v_mul_f32 v62, v54, v62
    v_mfma_f32_16x16x32_bf16 v[68:71], v[24:27], v[200:203], v[68:71]
    buffer_load_dwordx4 v4, s[12:15], s26 offen offset:1024 sc1 lds
    v_mfma_f32_16x16x32_bf16 v[68:71], v[20:23], v[192:195], v[68:71]
    ds_read_b128 v[48:51], v4 offset:54272
    v_mul_f32 v63, v55, v63
    v_mfma_f32_16x16x32_bf16 v[68:71], v[16:19], v[184:187], v[68:71]
    s_waitcnt lgkmcnt(3)
    v_rcp_f32 v89, v89
    v_mfma_f32_16x16x32_bf16 v[68:71], v[28:31], v[208:211], v[68:71]
    ds_read_b128 v[16:19], v4 offset:55296
    v_mul_f32 v57, v89, v57
    v_mfma_f32_16x16x32_bf16 v[68:71], v[32:35], v[216:219], v[68:71]
    buffer_load_dwordx4 a[88:91], v4, s[12:15], s31 offen offset:0 sc1
    v_mfma_f32_16x16x32_bf16 v[68:71], v[36:39], v[224:227], v[68:71]
    ds_read_b128 v[20:23], v4 offset:56320
    v_cvt_pk_bf16_f32 v60, v60, v61
    v_mfma_f32_16x16x32_bf16 v[72:75], v[36:39], v[228:231], v[72:75]
    buffer_load_dwordx4 v4, s[12:15], s26 offen offset:2048 sc1 lds
    v_mfma_f32_16x16x32_bf16 v[72:75], v[32:35], v[220:223], v[72:75]
    ds_read_b128 v[24:27], v4 offset:57344
    v_rcp_f32 v90, v90
    v_mfma_f32_16x16x32_bf16 v[72:75], v[28:31], v[212:215], v[72:75]
    s_waitcnt lgkmcnt(3)
    v_rcp_f32 v91, v91
    v_mfma_f32_16x16x32_bf16 v[72:75], v[40:43], v[236:239], v[72:75]
    ds_read_b128 v[28:31], v4 offset:58368
    v_mul_f32 v58, v90, v58
    v_mfma_f32_16x16x32_bf16 v[72:75], v[44:47], v[244:247], v[72:75]
    buffer_load_dwordx4 v4, s[12:15], s26 offen offset:3072 sc1 lds
    v_mfma_f32_16x16x32_bf16 v[72:75], v[48:51], v[252:255], v[72:75]
    ds_read_b128 v[32:35], v4 offset:59392
    v_mul_f32 v59, v91, v59
    v_mfma_f32_16x16x32_bf16 v[68:71], v[48:51], v[248:251], v[68:71]
    s_add_u32 m0, s27, 118784
    s_add_u32 s26, s26, 4096
    v_cvt_pk_bf16_f32 v62, v62, v63
    v_mfma_f32_16x16x32_bf16 v[68:71], v[44:47], v[240:243], v[68:71]
    ds_read_b128 v[36:39], v4 offset:60416
    v_accvgpr_write_b32 a192, v60
    v_mfma_f32_16x16x32_bf16 v[68:71], v[40:43], v[232:235], v[68:71]
    s_waitcnt lgkmcnt(3)
    v_accvgpr_write_b32 a193, v62
    v_mul_f32 v64, v56, v64
    v_mfma_f32_16x16x32_bf16 v[76:79], v[16:19], v[112:115], 0
    ds_read_b128 v[40:43], v4 offset:61440
    v_mul_f32 v65, v57, v65
    v_mfma_f32_16x16x32_bf16 v[76:79], v[20:23], v[120:123], v[76:79]
    buffer_load_dwordx4 v4, s[12:15], s26 offen offset:0 sc1 lds
    v_mfma_f32_16x16x32_bf16 v[76:79], v[24:27], v[128:131], v[76:79]
    ds_read_b128 v[44:47], v4 offset:62464
    v_mul_f32 v66, v58, v66
    v_mfma_f32_16x16x32_bf16 v[80:83], v[24:27], v[132:135], 0
    buffer_load_dwordx4 a[92:95], v4, s[12:15], s31 offen offset:1024 sc1
    v_mfma_f32_16x16x32_bf16 v[80:83], v[20:23], v[124:127], v[80:83]
    ds_read_b128 v[48:51], v4 offset:63488
    v_mul_f32 v67, v59, v67
    v_mfma_f32_16x16x32_bf16 v[80:83], v[16:19], v[116:119], v[80:83]
    s_waitcnt lgkmcnt(3)
    v_cvt_pk_bf16_f32 v64, v64, v65
    v_cvt_pk_bf16_f32 v66, v66, v67
    v_mfma_f32_16x16x32_bf16 v[80:83], v[28:31], v[140:143], v[80:83]
    ds_read_b128 v[16:19], v4 offset:64512
    v_accvgpr_write_b32 a196, v64
    v_mfma_f32_16x16x32_bf16 v[80:83], v[32:35], v[148:151], v[80:83]
    v_accvgpr_write_b32 a197, v66
    v_mul_f32 v84, v7, v68
    v_mfma_f32_16x16x32_bf16 v[80:83], v[36:39], v[156:159], v[80:83]
    ds_read_b128 v[20:23], v5 offset:0
    v_mul_f32 v85, v7, v69
    v_mfma_f32_16x16x32_bf16 v[76:79], v[36:39], v[152:155], v[76:79]
    v_exp_f32 v84, v84
    v_mfma_f32_16x16x32_bf16 v[76:79], v[32:35], v[144:147], v[76:79]
    ds_read_b128 v[24:27], v5 offset:1024
    v_mul_f32 v86, v7, v70
    v_mfma_f32_16x16x32_bf16 v[76:79], v[28:31], v[136:139], v[76:79]
    s_waitcnt lgkmcnt(3)
    v_exp_f32 v85, v85
    v_mfma_f32_16x16x32_bf16 v[76:79], v[40:43], v[160:163], v[76:79]
    ds_read_b128 v[28:31], v5 offset:2048
    v_mul_f32 v87, v7, v71
    v_mfma_f32_16x16x32_bf16 v[76:79], v[44:47], v[168:171], v[76:79]
    v_exp_f32 v86, v86
    v_mfma_f32_16x16x32_bf16 v[76:79], v[48:51], v[176:179], v[76:79]
    ds_read_b128 v[32:35], v5 offset:3072
    v_add_f32 v84, 1.0, v84
    v_mfma_f32_16x16x32_bf16 v[80:83], v[48:51], v[180:183], v[80:83]
    v_exp_f32 v87, v87
    v_mfma_f32_16x16x32_bf16 v[80:83], v[44:47], v[172:175], v[80:83]
    ds_read_b128 v[36:39], v5 offset:4096
    v_add_f32 v85, 1.0, v85
    v_mfma_f32_16x16x32_bf16 v[80:83], v[40:43], v[164:167], v[80:83]
    s_waitcnt lgkmcnt(3)
    v_rcp_f32 v84, v84
    v_mfma_f32_16x16x32_bf16 v[80:83], v[16:19], v[188:191], v[80:83]
    ds_read_b128 v[40:43], v5 offset:5120
    v_add_f32 v86, 1.0, v86
    v_mfma_f32_16x16x32_bf16 v[80:83], v[20:23], v[196:199], v[80:83]
    v_rcp_f32 v85, v85
    v_mfma_f32_16x16x32_bf16 v[80:83], v[24:27], v[204:207], v[80:83]
    ds_read_b128 v[44:47], v5 offset:6144
    s_add_u32 m0, s27, 0
    v_mfma_f32_16x16x32_bf16 v[76:79], v[24:27], v[200:203], v[76:79]
    s_add_u32 s26, s26, 28672
    v_rcp_f32 v86, v86
    v_mfma_f32_16x16x32_bf16 v[76:79], v[20:23], v[192:195], v[76:79]
    ds_read_b128 v[48:51], v5 offset:7168
    s_waitcnt vmcnt(17)
    s_barrier
    v_mfma_f32_16x16x32_bf16 v[76:79], v[16:19], v[184:187], v[76:79]
    s_waitcnt lgkmcnt(3)
    v_add_f32 v87, 1.0, v87
    v_mul_f32 v68, v84, v68
    v_mfma_f32_16x16x32_bf16 v[76:79], v[28:31], v[208:211], v[76:79]
    ds_read_b128 v[16:19], v5 offset:8192
    v_mul_f32 v69, v85, v69
    v_mfma_f32_16x16x32_bf16 v[76:79], v[32:35], v[216:219], v[76:79]
    buffer_load_dwordx4 v4, s[12:15], s26 offen offset:0 sc1 lds
    v_mfma_f32_16x16x32_bf16 v[76:79], v[36:39], v[224:227], v[76:79]
    ds_read_b128 v[20:23], v5 offset:9216
    v_mul_f32 v70, v86, v70
    v_mfma_f32_16x16x32_bf16 v[80:83], v[36:39], v[228:231], v[80:83]
    buffer_load_dwordx4 a[104:107], v4, s[12:15], s29 offen offset:2048 sc1
    v_mfma_f32_16x16x32_bf16 v[80:83], v[32:35], v[220:223], v[80:83]
    ds_read_b128 v[24:27], v5 offset:10240
    v_mul_f32 v88, v8, v72
    v_mfma_f32_16x16x32_bf16 v[80:83], v[28:31], v[212:215], v[80:83]
    s_waitcnt lgkmcnt(3)
    v_rcp_f32 v87, v87
    v_mfma_f32_16x16x32_bf16 v[80:83], v[40:43], v[236:239], v[80:83]
    ds_read_b128 v[28:31], v5 offset:11264
    v_mul_f32 v71, v87, v71
    v_mfma_f32_16x16x32_bf16 v[80:83], v[44:47], v[244:247], v[80:83]
    buffer_load_dwordx4 v4, s[12:15], s26 offen offset:1024 sc1 lds
    v_mfma_f32_16x16x32_bf16 v[80:83], v[48:51], v[252:255], v[80:83]
    ds_read_b128 v[32:35], v5 offset:12288
    v_mul_f32 v89, v8, v73
    v_mfma_f32_16x16x32_bf16 v[76:79], v[48:51], v[248:251], v[76:79]
    v_exp_f32 v88, v88
    v_mfma_f32_16x16x32_bf16 v[76:79], v[44:47], v[240:243], v[76:79]
    ds_read_b128 v[36:39], v5 offset:13312
    v_mul_f32 v90, v8, v74
    v_mfma_f32_16x16x32_bf16 v[76:79], v[40:43], v[232:235], v[76:79]
    s_waitcnt lgkmcnt(3)
    v_exp_f32 v89, v89
    v_mfma_f32_16x16x32_bf16 v[52:55], v[16:19], v[112:115], 0
    ds_read_b128 v[40:43], v5 offset:14336
    v_mov_b32 v15, 3
    v_mfma_f32_16x16x32_bf16 v[52:55], v[20:23], v[120:123], v[52:55]
    buffer_load_dwordx4 v4, s[12:15], s26 offen offset:2048 sc1 lds
    v_mfma_f32_16x16x32_bf16 v[52:55], v[24:27], v[128:131], v[52:55]
    ds_read_b128 v[44:47], v5 offset:15360
    s_waitcnt vmcnt(10)
    v_mfma_f32_16x16x32_bf16 v[56:59], v[24:27], v[132:135], 0
    buffer_store_dword v15, v12, s[12:15], s32 offen sc1
    v_mfma_f32_16x16x32_bf16 v[56:59], v[20:23], v[124:127], v[56:59]
    ds_read_b128 v[48:51], v5 offset:16384
    v_mul_f32 v91, v8, v75
    v_mfma_f32_16x16x32_bf16 v[56:59], v[16:19], v[116:119], v[56:59]
    s_waitcnt lgkmcnt(3)
    v_exp_f32 v90, v90
    v_mfma_f32_16x16x32_bf16 v[56:59], v[28:31], v[140:143], v[56:59]
    ds_read_b128 v[16:19], v5 offset:17408
    v_add_f32 v88, 1.0, v88
    v_mfma_f32_16x16x32_bf16 v[56:59], v[32:35], v[148:151], v[56:59]
    v_cmp_gt_u32 vcc, s42, v11
    s_cbranch_vccnz late_26
late_26_ok:
    v_mfma_f32_16x16x32_bf16 v[56:59], v[36:39], v[156:159], v[56:59]
    ds_read_b128 v[20:23], v5 offset:18432
    v_add_f32 v89, 1.0, v89
    v_mfma_f32_16x16x32_bf16 v[52:55], v[36:39], v[152:155], v[52:55]
    buffer_load_dwordx4 v4, s[12:15], s26 offen offset:3072 sc1 lds
    buffer_load_dwordx4 a[108:111], v4, s[12:15], s29 offen offset:3072 sc1
    v_mfma_f32_16x16x32_bf16 v[52:55], v[32:35], v[144:147], v[52:55]
    ds_read_b128 v[24:27], v5 offset:19456
    s_add_u32 m0, s27, 4096
    v_mfma_f32_16x16x32_bf16 v[52:55], v[28:31], v[136:139], v[52:55]
    s_waitcnt lgkmcnt(3)
    v_exp_f32 v91, v91
    v_mfma_f32_16x16x32_bf16 v[52:55], v[40:43], v[160:163], v[52:55]
    ds_read_b128 v[28:31], v5 offset:20480
    s_add_u32 s26, s26, 4096
    v_mfma_f32_16x16x32_bf16 v[52:55], v[44:47], v[168:171], v[52:55]
    s_add_u32 s29, s29, 4096
    v_rcp_f32 v88, v88
    v_mfma_f32_16x16x32_bf16 v[52:55], v[48:51], v[176:179], v[52:55]
    ds_read_b128 v[32:35], v5 offset:21504
    v_add_f32 v90, 1.0, v90
    v_mfma_f32_16x16x32_bf16 v[56:59], v[48:51], v[180:183], v[56:59]
    buffer_load_dwordx4 v4, s[12:15], s26 offen offset:0 sc1 lds
    v_mfma_f32_16x16x32_bf16 v[56:59], v[44:47], v[172:175], v[56:59]
    ds_read_b128 v[36:39], v5 offset:22528
    v_add_f32 v91, 1.0, v91
    v_mfma_f32_16x16x32_bf16 v[56:59], v[40:43], v[164:167], v[56:59]
    s_waitcnt lgkmcnt(3)
    v_rcp_f32 v89, v89
    v_mfma_f32_16x16x32_bf16 v[56:59], v[16:19], v[188:191], v[56:59]
    ds_read_b128 v[40:43], v5 offset:23552
    v_mul_f32 v72, v88, v72
    v_mfma_f32_16x16x32_bf16 v[56:59], v[20:23], v[196:199], v[56:59]
    buffer_load_dwordx4 v4, s[12:15], s26 offen offset:1024 sc1 lds
    v_mfma_f32_16x16x32_bf16 v[56:59], v[24:27], v[204:207], v[56:59]
    ds_read_b128 v[44:47], v5 offset:24576
    v_mul_f32 v73, v89, v73
    v_mfma_f32_16x16x32_bf16 v[52:55], v[24:27], v[200:203], v[52:55]
    v_rcp_f32 v90, v90
    v_mfma_f32_16x16x32_bf16 v[52:55], v[20:23], v[192:195], v[52:55]
    ds_read_b128 v[48:51], v5 offset:25600
    v_mul_f32 v74, v90, v74
    v_mfma_f32_16x16x32_bf16 v[52:55], v[16:19], v[184:187], v[52:55]
    s_waitcnt lgkmcnt(3)
    v_rcp_f32 v91, v91
    v_mfma_f32_16x16x32_bf16 v[52:55], v[28:31], v[208:211], v[52:55]
    ds_read_b128 v[16:19], v5 offset:26624
    v_mul_f32 v75, v91, v75
    v_mfma_f32_16x16x32_bf16 v[52:55], v[32:35], v[216:219], v[52:55]
    buffer_load_dwordx4 v4, s[12:15], s26 offen offset:2048 sc1 lds
    v_mfma_f32_16x16x32_bf16 v[52:55], v[36:39], v[224:227], v[52:55]
    ds_read_b128 v[20:23], v5 offset:27648
    v_mul_f32 v76, v68, v76
    v_mfma_f32_16x16x32_bf16 v[56:59], v[36:39], v[228:231], v[56:59]
    buffer_load_dwordx4 a[112:115], v4, s[12:15], s30 offen offset:2048 sc1
    v_mfma_f32_16x16x32_bf16 v[56:59], v[32:35], v[220:223], v[56:59]
    ds_read_b128 v[24:27], v5 offset:28672
    v_mul_f32 v77, v69, v77
    v_mfma_f32_16x16x32_bf16 v[56:59], v[28:31], v[212:215], v[56:59]
    s_waitcnt lgkmcnt(3)
    v_mul_f32 v78, v70, v78
    v_mul_f32 v79, v71, v79
    v_mfma_f32_16x16x32_bf16 v[56:59], v[40:43], v[236:239], v[56:59]
    ds_read_b128 v[28:31], v5 offset:29696
    v_cvt_pk_bf16_f32 v76, v76, v77
    v_mfma_f32_16x16x32_bf16 v[56:59], v[44:47], v[244:247], v[56:59]
    buffer_load_dwordx4 v4, s[12:15], s26 offen offset:3072 sc1 lds
    v_mfma_f32_16x16x32_bf16 v[56:59], v[48:51], v[252:255], v[56:59]
    ds_read_b128 v[32:35], v5 offset:30720
    s_add_u32 m0, s27, 8192
    v_mfma_f32_16x16x32_bf16 v[52:55], v[48:51], v[248:251], v[52:55]
    s_add_u32 s26, s26, 4096
    v_cvt_pk_bf16_f32 v78, v78, v79
    v_accvgpr_write_b32 a194, v76
    v_mfma_f32_16x16x32_bf16 v[52:55], v[44:47], v[240:243], v[52:55]
    ds_read_b128 v[36:39], v5 offset:31744
    v_accvgpr_write_b32 a195, v78
    v_mfma_f32_16x16x32_bf16 v[52:55], v[40:43], v[232:235], v[52:55]
    s_waitcnt lgkmcnt(3)
    v_mul_f32 v80, v72, v80
    v_mul_f32 v81, v73, v81
    v_mfma_f32_16x16x32_bf16 v[60:63], v[16:19], v[112:115], 0
    ds_read_b128 v[40:43], v5 offset:32768
    v_mul_f32 v82, v74, v82
    v_mfma_f32_16x16x32_bf16 v[60:63], v[20:23], v[120:123], v[60:63]
    buffer_load_dwordx4 v4, s[12:15], s26 offen offset:0 sc1 lds
    v_mfma_f32_16x16x32_bf16 v[60:63], v[24:27], v[128:131], v[60:63]
    ds_read_b128 v[44:47], v5 offset:33792
    v_mul_f32 v83, v75, v83
    v_mfma_f32_16x16x32_bf16 v[64:67], v[24:27], v[132:135], 0
    v_cvt_pk_bf16_f32 v80, v80, v81
    v_cvt_pk_bf16_f32 v82, v82, v83
    v_mfma_f32_16x16x32_bf16 v[64:67], v[20:23], v[124:127], v[64:67]
    ds_read_b128 v[48:51], v5 offset:34816
    v_accvgpr_write_b32 a198, v80
    v_mfma_f32_16x16x32_bf16 v[64:67], v[16:19], v[116:119], v[64:67]
    s_waitcnt lgkmcnt(3)
    v_accvgpr_write_b32 a199, v82
    v_mul_f32 v84, v7, v52
    v_mfma_f32_16x16x32_bf16 v[64:67], v[28:31], v[140:143], v[64:67]
    ds_read_b128 v[16:19], v5 offset:35840
    v_mul_f32 v85, v7, v53
    v_mfma_f32_16x16x32_bf16 v[64:67], v[32:35], v[148:151], v[64:67]
    buffer_load_dwordx4 a[116:119], v4, s[12:15], s30 offen offset:3072 sc1
    v_mfma_f32_16x16x32_bf16 v[64:67], v[36:39], v[156:159], v[64:67]
    ds_read_b128 v[20:23], v5 offset:36864
    s_add_u32 s30, s30, 4096
    v_mfma_f32_16x16x32_bf16 v[60:63], v[36:39], v[152:155], v[60:63]
    v_exp_f32 v84, v84
    v_mfma_f32_16x16x32_bf16 v[60:63], v[32:35], v[144:147], v[60:63]
    ds_read_b128 v[24:27], v5 offset:37888
    v_mul_f32 v86, v7, v54
    v_mfma_f32_16x16x32_bf16 v[60:63], v[28:31], v[136:139], v[60:63]
    s_waitcnt lgkmcnt(3)
    v_exp_f32 v85, v85
    v_mfma_f32_16x16x32_bf16 v[60:63], v[40:43], v[160:163], v[60:63]
    ds_read_b128 v[28:31], v5 offset:38912
    v_mul_f32 v87, v7, v55
    v_mfma_f32_16x16x32_bf16 v[60:63], v[44:47], v[168:171], v[60:63]
    v_exp_f32 v86, v86
    v_mfma_f32_16x16x32_bf16 v[60:63], v[48:51], v[176:179], v[60:63]
    ds_read_b128 v[32:35], v5 offset:39936
    v_add_f32 v84, 1.0, v84
    v_mfma_f32_16x16x32_bf16 v[64:67], v[48:51], v[180:183], v[64:67]
    buffer_store_dwordx4 a[192:195], v4, s[12:15], s28 offen offset:0 sc1
    v_mfma_f32_16x16x32_bf16 v[64:67], v[44:47], v[172:175], v[64:67]
    ds_read_b128 v[36:39], v5 offset:40960
    v_add_f32 v85, 1.0, v85
    v_mfma_f32_16x16x32_bf16 v[64:67], v[40:43], v[164:167], v[64:67]
    s_waitcnt lgkmcnt(3)
    v_exp_f32 v87, v87
    v_mfma_f32_16x16x32_bf16 v[64:67], v[16:19], v[188:191], v[64:67]
    ds_read_b128 v[40:43], v5 offset:41984
    v_add_f32 v86, 1.0, v86
    v_mfma_f32_16x16x32_bf16 v[64:67], v[20:23], v[196:199], v[64:67]
    v_rcp_f32 v84, v84
    v_mfma_f32_16x16x32_bf16 v[64:67], v[24:27], v[204:207], v[64:67]
    ds_read_b128 v[44:47], v5 offset:43008
    s_add_u32 m0, s27, 36864
    v_mfma_f32_16x16x32_bf16 v[60:63], v[24:27], v[200:203], v[60:63]
    buffer_load_dword v11, v102, s[12:15], s32 offen sc1
    v_mfma_f32_16x16x32_bf16 v[60:63], v[20:23], v[192:195], v[60:63]
    ds_read_b128 v[48:51], v5 offset:44032
    s_waitcnt vmcnt(17)
    s_barrier
    v_mfma_f32_16x16x32_bf16 v[60:63], v[16:19], v[184:187], v[60:63]
    s_waitcnt lgkmcnt(3)
    v_rcp_f32 v85, v85
    v_mfma_f32_16x16x32_bf16 v[60:63], v[28:31], v[208:211], v[60:63]
    ds_read_b128 v[16:19], v5 offset:45056
    s_add_u32 s26, s26, 28672
    v_mfma_f32_16x16x32_bf16 v[60:63], v[32:35], v[216:219], v[60:63]
    buffer_load_dwordx4 v4, s[12:15], s26 offen offset:0 sc1 lds
    v_mfma_f32_16x16x32_bf16 v[60:63], v[36:39], v[224:227], v[60:63]
    ds_read_b128 v[20:23], v5 offset:46080
    v_add_f32 v87, 1.0, v87
    v_mfma_f32_16x16x32_bf16 v[64:67], v[36:39], v[228:231], v[64:67]
    buffer_load_dwordx4 a[120:123], v4, s[12:15], s31 offen offset:2048 sc1
    v_mfma_f32_16x16x32_bf16 v[64:67], v[32:35], v[220:223], v[64:67]
    ds_read_b128 v[24:27], v5 offset:47104
    v_mul_f32 v52, v84, v52
    v_mfma_f32_16x16x32_bf16 v[64:67], v[28:31], v[212:215], v[64:67]
    s_waitcnt lgkmcnt(3)
    v_rcp_f32 v86, v86
    v_mfma_f32_16x16x32_bf16 v[64:67], v[40:43], v[236:239], v[64:67]
    ds_read_b128 v[28:31], v5 offset:48128
    v_mul_f32 v53, v85, v53
    v_mfma_f32_16x16x32_bf16 v[64:67], v[44:47], v[244:247], v[64:67]
    buffer_load_dwordx4 v4, s[12:15], s26 offen offset:1024 sc1 lds
    v_mfma_f32_16x16x32_bf16 v[64:67], v[48:51], v[252:255], v[64:67]
    ds_read_b128 v[32:35], v5 offset:49152
    v_mul_f32 v54, v86, v54
    v_mfma_f32_16x16x32_bf16 v[60:63], v[48:51], v[248:251], v[60:63]
    v_rcp_f32 v87, v87
    v_mfma_f32_16x16x32_bf16 v[60:63], v[44:47], v[240:243], v[60:63]
    ds_read_b128 v[36:39], v5 offset:50176
    v_mul_f32 v55, v87, v55
    v_mfma_f32_16x16x32_bf16 v[60:63], v[40:43], v[232:235], v[60:63]
    s_waitcnt lgkmcnt(3)
    v_mul_f32 v88, v8, v56
    v_mul_f32 v89, v8, v57
    v_mfma_f32_16x16x32_bf16 v[68:71], v[16:19], v[112:115], 0
    ds_read_b128 v[40:43], v5 offset:51200
    v_mul_f32 v90, v8, v58
    v_mfma_f32_16x16x32_bf16 v[68:71], v[20:23], v[120:123], v[68:71]
    buffer_load_dwordx4 v4, s[12:15], s26 offen offset:2048 sc1 lds
    v_mfma_f32_16x16x32_bf16 v[68:71], v[24:27], v[128:131], v[68:71]
    ds_read_b128 v[44:47], v5 offset:52224
    v_mul_f32 v91, v8, v59
    v_mfma_f32_16x16x32_bf16 v[72:75], v[24:27], v[132:135], 0
    v_exp_f32 v88, v88
    v_mfma_f32_16x16x32_bf16 v[72:75], v[20:23], v[124:127], v[72:75]
    ds_read_b128 v[48:51], v5 offset:53248
    v_add_f32 v88, 1.0, v88
    v_mfma_f32_16x16x32_bf16 v[72:75], v[16:19], v[116:119], v[72:75]
    s_waitcnt lgkmcnt(3)
    v_exp_f32 v89, v89
    v_mfma_f32_16x16x32_bf16 v[72:75], v[28:31], v[140:143], v[72:75]
    ds_read_b128 v[16:19], v5 offset:54272
    v_add_f32 v89, 1.0, v89
    v_mfma_f32_16x16x32_bf16 v[72:75], v[32:35], v[148:151], v[72:75]
    buffer_store_dwordx4 a[196:199], v4, s[12:15], s28 offen offset:1024 sc1
    v_mfma_f32_16x16x32_bf16 v[72:75], v[36:39], v[156:159], v[72:75]
    ds_read_b128 v[20:23], v5 offset:55296
    v_mul_f32 v60, v52, v60
    v_mfma_f32_16x16x32_bf16 v[68:71], v[36:39], v[152:155], v[68:71]
    buffer_load_dwordx4 v4, s[12:15], s26 offen offset:3072 sc1 lds
    v_mfma_f32_16x16x32_bf16 v[68:71], v[32:35], v[144:147], v[68:71]
    ds_read_b128 v[24:27], v5 offset:56320
    s_add_u32 m0, s27, 40960
    v_mfma_f32_16x16x32_bf16 v[68:71], v[28:31], v[136:139], v[68:71]
    s_waitcnt lgkmcnt(3)
    v_exp_f32 v90, v90
    v_mfma_f32_16x16x32_bf16 v[68:71], v[40:43], v[160:163], v[68:71]
    ds_read_b128 v[28:31], v5 offset:57344
    s_add_u32 s26, s26, 4096
    v_mfma_f32_16x16x32_bf16 v[68:71], v[44:47], v[168:171], v[68:71]
    buffer_load_dwordx4 a[124:127], v4, s[12:15], s31 offen offset:3072 sc1
    v_mfma_f32_16x16x32_bf16 v[68:71], v[48:51], v[176:179], v[68:71]
    ds_read_b128 v[32:35], v5 offset:58368
    s_add_u32 s31, s31, 4096
    v_mfma_f32_16x16x32_bf16 v[72:75], v[48:51], v[180:183], v[72:75]
    buffer_load_dwordx4 v4, s[12:15], s26 offen offset:0 sc1 lds
    v_mfma_f32_16x16x32_bf16 v[72:75], v[44:47], v[172:175], v[72:75]
    ds_read_b128 v[36:39], v5 offset:59392
    v_add_f32 v90, 1.0, v90
    v_mfma_f32_16x16x32_bf16 v[72:75], v[40:43], v[164:167], v[72:75]
    s_waitcnt lgkmcnt(3)
    v_exp_f32 v91, v91
    v_mfma_f32_16x16x32_bf16 v[72:75], v[16:19], v[188:191], v[72:75]
    ds_read_b128 v[40:43], v5 offset:60416
    v_add_f32 v91, 1.0, v91
    v_mfma_f32_16x16x32_bf16 v[72:75], v[20:23], v[196:199], v[72:75]
    buffer_load_dwordx4 v4, s[12:15], s26 offen offset:1024 sc1 lds
    v_mfma_f32_16x16x32_bf16 v[72:75], v[24:27], v[204:207], v[72:75]
    ds_read_b128 v[44:47], v5 offset:61440
    v_mul_f32 v61, v53, v61
    v_mfma_f32_16x16x32_bf16 v[68:71], v[24:27], v[200:203], v[68:71]
    v_rcp_f32 v88, v88
    v_mfma_f32_16x16x32_bf16 v[68:71], v[20:23], v[192:195], v[68:71]
    ds_read_b128 v[48:51], v5 offset:62464
    v_mul_f32 v56, v88, v56
    v_mfma_f32_16x16x32_bf16 v[68:71], v[16:19], v[184:187], v[68:71]
    s_waitcnt lgkmcnt(3)
    v_rcp_f32 v89, v89
    v_mfma_f32_16x16x32_bf16 v[68:71], v[28:31], v[208:211], v[68:71]
    ds_read_b128 v[16:19], v5 offset:63488
    v_mul_f32 v57, v89, v57
    v_mfma_f32_16x16x32_bf16 v[68:71], v[32:35], v[216:219], v[68:71]
    buffer_load_dwordx4 v4, s[12:15], s26 offen offset:2048 sc1 lds
    v_mfma_f32_16x16x32_bf16 v[68:71], v[36:39], v[224:227], v[68:71]
    ds_read_b128 v[20:23], v5 offset:64512
    v_mul_f32 v62, v54, v62
    v_mfma_f32_16x16x32_bf16 v[72:75], v[36:39], v[228:231], v[72:75]
    v_rcp_f32 v90, v90
    v_mfma_f32_16x16x32_bf16 v[72:75], v[32:35], v[220:223], v[72:75]
    ds_read_b128 v[24:27], v6 offset:0
    v_mul_f32 v58, v90, v58
    v_mfma_f32_16x16x32_bf16 v[72:75], v[28:31], v[212:215], v[72:75]
    s_waitcnt lgkmcnt(3)
    v_rcp_f32 v91, v91
    v_mfma_f32_16x16x32_bf16 v[72:75], v[40:43], v[236:239], v[72:75]
    ds_read_b128 v[28:31], v6 offset:1024
    v_mul_f32 v59, v91, v59
    v_mfma_f32_16x16x32_bf16 v[72:75], v[44:47], v[244:247], v[72:75]
    buffer_load_dwordx4 v4, s[12:15], s26 offen offset:3072 sc1 lds
    v_mfma_f32_16x16x32_bf16 v[72:75], v[48:51], v[252:255], v[72:75]
    ds_read_b128 v[32:35], v6 offset:2048
    s_add_u32 m0, s27, 45056
    v_mfma_f32_16x16x32_bf16 v[68:71], v[48:51], v[248:251], v[68:71]
    s_add_u32 s26, s26, 4096
    v_mul_f32 v63, v55, v63
    v_cvt_pk_bf16_f32 v60, v60, v61
    v_mfma_f32_16x16x32_bf16 v[68:71], v[44:47], v[240:243], v[68:71]
    ds_read_b128 v[36:39], v6 offset:3072
    v_cvt_pk_bf16_f32 v62, v62, v63
    v_mfma_f32_16x16x32_bf16 v[68:71], v[40:43], v[232:235], v[68:71]
    s_waitcnt lgkmcnt(3)
    v_accvgpr_write_b32 a224, v60
    v_accvgpr_write_b32 a225, v62
    v_mfma_f32_16x16x32_bf16 v[76:79], v[16:19], v[112:115], 0
    ds_read_b128 v[40:43], v6 offset:4096
    v_mul_f32 v64, v56, v64
    v_mfma_f32_16x16x32_bf16 v[76:79], v[20:23], v[120:123], v[76:79]
    buffer_load_dwordx4 v4, s[12:15], s26 offen offset:0 sc1 lds
    v_mfma_f32_16x16x32_bf16 v[76:79], v[24:27], v[128:131], v[76:79]
hop_6:
    s_cbranch_execz back_6
    ds_read_b128 v[44:47], v6 offset:5120
    v_mul_f32 v65, v57, v65
    v_mfma_f32_16x16x32_bf16 v[80:83], v[24:27], v[132:135], 0
    v_mul_f32 v66, v58, v66
    v_mul_f32 v67, v59, v67
    v_mfma_f32_16x16x32_bf16 v[80:83], v[20:23], v[124:127], v[80:83]
    ds_read_b128 v[48:51], v6 offset:6144
    v_cvt_pk_bf16_f32 v64, v64, v65
    v_mfma_f32_16x16x32_bf16 v[80:83], v[16:19], v[116:119], v[80:83]
    s_waitcnt lgkmcnt(3)
    v_cvt_pk_bf16_f32 v66, v66, v67
    v_accvgpr_write_b32 a228, v64
    v_mfma_f32_16x16x32_bf16 v[80:83], v[28:31], v[140:143], v[80:83]
    ds_read_b128 v[16:19], v6 offset:7168
    v_accvgpr_write_b32 a229, v66
    v_mfma_f32_16x16x32_bf16 v[80:83], v[32:35], v[148:151], v[80:83]
    s_waitcnt vmcnt(12)
    v_cmp_gt_u32 vcc, 3, v11
    s_cbranch_vccnz late_29
late_29_ok:
    v_mfma_f32_16x16x32_bf16 v[80:83], v[36:39], v[156:159], v[80:83]
    ds_read_b128 v[20:23], v6 offset:8192
    v_mul_f32 v84, v7, v68
    v_mfma_f32_16x16x32_bf16 v[76:79], v[36:39], v[152:155], v[76:79]
    buffer_load_dwordx4 a[136:139], v4, s[12:15], s29 offen offset:0 sc1
    v_mfma_f32_16x16x32_bf16 v[76:79], v[32:35], v[144:147], v[76:79]
    ds_read_b128 v[24:27], v6 offset:9216
    v_mul_f32 v85, v7, v69
    v_mfma_f32_16x16x32_bf16 v[76:79], v[28:31], v[136:139], v[76:79]
    s_waitcnt lgkmcnt(3)
    v_exp_f32 v84, v84
    v_mfma_f32_16x16x32_bf16 v[76:79], v[40:43], v[160:163], v[76:79]
    ds_read_b128 v[28:31], v6 offset:10240
    v_mul_f32 v86, v7, v70
    v_mfma_f32_16x16x32_bf16 v[76:79], v[44:47], v[168:171], v[76:79]
    v_exp_f32 v85, v85
    v_mfma_f32_16x16x32_bf16 v[76:79], v[48:51], v[176:179], v[76:79]
    ds_read_b128 v[32:35], v6 offset:11264
    v_mul_f32 v87, v7, v71
    v_mfma_f32_16x16x32_bf16 v[80:83], v[48:51], v[180:183], v[80:83]
    buffer_load_dwordx4 a[140:143], v4, s[12:15], s29 offen offset:1024 sc1
    v_mfma_f32_16x16x32_bf16 v[80:83], v[44:47], v[172:175], v[80:83]
    ds_read_b128 v[36:39], v6 offset:12288
    v_add_f32 v84, 1.0, v84
    v_mfma_f32_16x16x32_bf16 v[80:83], v[40:43], v[164:167], v[80:83]
    s_waitcnt lgkmcnt(3)
    v_exp_f32 v86, v86
    v_mfma_f32_16x16x32_bf16 v[80:83], v[16:19], v[188:191], v[80:83]
    ds_read_b128 v[40:43], v6 offset:13312
    v_add_f32 v85, 1.0, v85
    v_mfma_f32_16x16x32_bf16 v[80:83], v[20:23], v[196:199], v[80:83]
    v_exp_f32 v87, v87
    v_mfma_f32_16x16x32_bf16 v[80:83], v[24:27], v[204:207], v[80:83]
    ds_read_b128 v[44:47], v6 offset:14336
    s_add_u32 m0, s27, 73728
    v_mfma_f32_16x16x32_bf16 v[76:79], v[24:27], v[200:203], v[76:79]
    s_add_u32 s26, s26, 28672
    v_rcp_f32 v84, v84
    v_mfma_f32_16x16x32_bf16 v[76:79], v[20:23], v[192:195], v[76:79]
    ds_read_b128 v[48:51], v6 offset:15360
    s_barrier
    v_mfma_f32_16x16x32_bf16 v[76:79], v[16:19], v[184:187], v[76:79]
    s_waitcnt lgkmcnt(3)
    v_rcp_f32 v85, v85
    v_mfma_f32_16x16x32_bf16 v[76:79], v[28:31], v[208:211], v[76:79]
    ds_read_b128 v[16:19], v4 offset:0
    v_add_f32 v86, 1.0, v86
    v_mfma_f32_16x16x32_bf16 v[76:79], v[32:35], v[216:219], v[76:79]
    buffer_load_dwordx4 v4, s[12:15], s26 offen offset:0 sc1 lds
    v_mfma_f32_16x16x32_bf16 v[76:79], v[36:39], v[224:227], v[76:79]
    ds_read_b128 v[20:23], v4 offset:1024
    v_add_f32 v87, 1.0, v87
    v_mfma_f32_16x16x32_bf16 v[80:83], v[36:39], v[228:231], v[80:83]
    buffer_load_dwordx4 a[144:147], v4, s[12:15], s30 offen offset:0 sc1
    v_mfma_f32_16x16x32_bf16 v[80:83], v[32:35], v[220:223], v[80:83]
    ds_read_b128 v[24:27], v4 offset:2048
    v_mov_b32 v15, 4
    v_mfma_f32_16x16x32_bf16 v[80:83], v[28:31], v[212:215], v[80:83]
    s_waitcnt lgkmcnt(3)
    v_rcp_f32 v86, v86
    v_mfma_f32_16x16x32_bf16 v[80:83], v[40:43], v[236:239], v[80:83]
    ds_read_b128 v[28:31], v4 offset:3072
    s_waitcnt vmcnt(11)
    v_mfma_f32_16x16x32_bf16 v[80:83], v[44:47], v[244:247], v[80:83]
    buffer_load_dwordx4 v4, s[12:15], s26 offen offset:1024 sc1 lds
    v_mfma_f32_16x16x32_bf16 v[80:83], v[48:51], v[252:255], v[80:83]
    ds_read_b128 v[32:35], v4 offset:4096
    v_mul_f32 v68, v84, v68
    v_mfma_f32_16x16x32_bf16 v[76:79], v[48:51], v[248:251], v[76:79]
    buffer_store_dword v15, v12, s[12:15], s32 offen sc1
    v_mfma_f32_16x16x32_bf16 v[76:79], v[44:47], v[240:243], v[76:79]
    ds_read_b128 v[36:39], v4 offset:5120
    v_mul_f32 v69, v85, v69
    v_mfma_f32_16x16x32_bf16 v[76:79], v[40:43], v[232:235], v[76:79]
    s_waitcnt lgkmcnt(3)
    v_rcp_f32 v87, v87
    v_mfma_f32_16x16x32_bf16 v[52:55], v[16:19], v[112:115], 0
    ds_read_b128 v[40:43], v4 offset:6144
    v_mul_f32 v70, v86, v70
    v_mfma_f32_16x16x32_bf16 v[52:55], v[20:23], v[120:123], v[52:55]
    buffer_load_dwordx4 a[148:151], v4, s[12:15], s30 offen offset:1024 sc1
    v_mfma_f32_16x16x32_bf16 v[52:55], v[24:27], v[128:131], v[52:55]
    ds_read_b128 v[44:47], v4 offset:7168
    v_mul_f32 v71, v87, v71
    v_mfma_f32_16x16x32_bf16 v[56:59], v[24:27], v[132:135], 0
    buffer_load_dwordx4 v4, s[12:15], s26 offen offset:2048 sc1 lds
    v_mfma_f32_16x16x32_bf16 v[56:59], v[20:23], v[124:127], v[56:59]
    ds_read_b128 v[48:51], v4 offset:8192
    v_mul_f32 v88, v8, v72
    v_mfma_f32_16x16x32_bf16 v[56:59], v[16:19], v[116:119], v[56:59]
    s_waitcnt lgkmcnt(3)
    v_exp_f32 v88, v88
    v_mfma_f32_16x16x32_bf16 v[56:59], v[28:31], v[140:143], v[56:59]
    ds_read_b128 v[16:19], v4 offset:9216
    v_mul_f32 v89, v8, v73
    v_mfma_f32_16x16x32_bf16 v[56:59], v[32:35], v[148:151], v[56:59]
    buffer_load_dwordx4 v4, s[12:15], s26 offen offset:3072 sc1 lds
    v_mfma_f32_16x16x32_bf16 v[56:59], v[36:39], v[156:159], v[56:59]
    ds_read_b128 v[20:23], v4 offset:10240
    s_add_u32 m0, s27, 77824
    v_mfma_f32_16x16x32_bf16 v[52:55], v[36:39], v[152:155], v[52:55]
    buffer_load_dwordx4 a[152:155], v4, s[12:15], s31 offen offset:0 sc1
    v_mfma_f32_16x16x32_bf16 v[52:55], v[32:35], v[144:147], v[52:55]
    ds_read_b128 v[24:27], v4 offset:11264
    s_add_u32 s26, s26, 4096
    v_mfma_f32_16x16x32_bf16 v[52:55], v[28:31], v[136:139], v[52:55]
    s_waitcnt lgkmcnt(3)
    v_exp_f32 v89, v89
    v_mfma_f32_16x16x32_bf16 v[52:55], v[40:43], v[160:163], v[52:55]
    ds_read_b128 v[28:31], v4 offset:12288
    v_mul_f32 v90, v8, v74
    v_mfma_f32_16x16x32_bf16 v[52:55], v[44:47], v[168:171], v[52:55]
    buffer_load_dwordx4 v4, s[12:15], s26 offen offset:0 sc1 lds
    v_mfma_f32_16x16x32_bf16 v[52:55], v[48:51], v[176:179], v[52:55]
    ds_read_b128 v[32:35], v4 offset:13312
    v_mul_f32 v91, v8, v75
    v_mfma_f32_16x16x32_bf16 v[56:59], v[48:51], v[180:183], v[56:59]
    buffer_load_dwordx4 a[156:159], v4, s[12:15], s31 offen offset:1024 sc1
    v_mfma_f32_16x16x32_bf16 v[56:59], v[44:47], v[172:175], v[56:59]
    ds_read_b128 v[36:39], v4 offset:14336
    v_exp_f32 v90, v90
    v_mfma_f32_16x16x32_bf16 v[56:59], v[40:43], v[164:167], v[56:59]
    s_waitcnt lgkmcnt(3)
    v_exp_f32 v91, v91
    v_mfma_f32_16x16x32_bf16 v[56:59], v[16:19], v[188:191], v[56:59]
    ds_read_b128 v[40:43], v4 offset:15360
    v_add_f32 v88, 1.0, v88
    v_mfma_f32_16x16x32_bf16 v[56:59], v[20:23], v[196:199], v[56:59]
    buffer_load_dwordx4 v4, s[12:15], s26 offen offset:1024 sc1 lds
    v_mfma_f32_16x16x32_bf16 v[56:59], v[24:27], v[204:207], v[56:59]
    ds_read_b128 v[44:47], v4 offset:16384
    v_add_f32 v89, 1.0, v89
    v_mfma_f32_16x16x32_bf16 v[52:55], v[24:27], v[200:203], v[52:55]
    v_rcp_f32 v88, v88
    v_mfma_f32_16x16x32_bf16 v[52:55], v[20:23], v[192:195], v[52:55]
    ds_read_b128 v[48:51], v4 offset:17408
    v_add_f32 v90, 1.0, v90
    v_mfma_f32_16x16x32_bf16 v[52:55], v[16:19], v[184:187], v[52:55]
    s_waitcnt lgkmcnt(3)
    v_rcp_f32 v89, v89
    v_mfma_f32_16x16x32_bf16 v[52:55], v[28:31], v[208:211], v[52:55]
    ds_read_b128 v[16:19], v4 offset:18432
    v_add_f32 v91, 1.0, v91
    v_mfma_f32_16x16x32_bf16 v[52:55], v[32:35], v[216:219], v[52:55]
    buffer_load_dwordx4 v4, s[12:15], s26 offen offset:2048 sc1 lds
    v_mfma_f32_16x16x32_bf16 v[52:55], v[36:39], v[224:227], v[52:55]
    ds_read_b128 v[20:23], v4 offset:19456
    v_mul_f32 v72, v88, v72
    v_mfma_f32_16x16x32_bf16 v[56:59], v[36:39], v[228:231], v[56:59]
    buffer_load_dwordx4 a[168:171], v4, s[12:15], s29 offen offset:2048 sc1
    v_mfma_f32_16x16x32_bf16 v[56:59], v[32:35], v[220:223], v[56:59]
    ds_read_b128 v[24:27], v4 offset:20480
    v_rcp_f32 v90, v90
    v_mfma_f32_16x16x32_bf16 v[56:59], v[28:31], v[212:215], v[56:59]
    s_waitcnt lgkmcnt(3)
    v_rcp_f32 v91, v91
    v_mfma_f32_16x16x32_bf16 v[56:59], v[40:43], v[236:239], v[56:59]
    ds_read_b128 v[28:31], v4 offset:21504
    v_mul_f32 v73, v89, v73
    v_mfma_f32_16x16x32_bf16 v[56:59], v[44:47], v[244:247], v[56:59]
    buffer_load_dwordx4 v4, s[12:15], s26 offen offset:3072 sc1 lds
    v_mfma_f32_16x16x32_bf16 v[56:59], v[48:51], v[252:255], v[56:59]
    ds_read_b128 v[32:35], v4 offset:22528
    v_mul_f32 v74, v90, v74
    v_mfma_f32_16x16x32_bf16 v[52:55], v[48:51], v[248:251], v[52:55]
    buffer_load_dwordx4 a[172:175], v4, s[12:15], s29 offen offset:3072 sc1
    v_mfma_f32_16x16x32_bf16 v[52:55], v[44:47], v[240:243], v[52:55]
    ds_read_b128 v[36:39], v4 offset:23552
    v_mul_f32 v75, v91, v75
    v_mfma_f32_16x16x32_bf16 v[52:55], v[40:43], v[232:235], v[52:55]
    s_waitcnt lgkmcnt(3)
    s_add_u32 m0, s27, 81920
    s_add_u32 s26, s26, 4096
    v_mfma_f32_16x16x32_bf16 v[60:63], v[16:19], v[112:115], 0
    ds_read_b128 v[40:43], v4 offset:24576
    v_mul_f32 v76, v68, v76
    v_mfma_f32_16x16x32_bf16 v[60:63], v[20:23], v[120:123], v[60:63]
    buffer_load_dwordx4 v4, s[12:15], s26 offen offset:0 sc1 lds
    v_mfma_f32_16x16x32_bf16 v[60:63], v[24:27], v[128:131], v[60:63]
    ds_read_b128 v[44:47], v4 offset:25600
    v_mul_f32 v77, v69, v77
    v_mfma_f32_16x16x32_bf16 v[64:67], v[24:27], v[132:135], 0
    s_add_u32 s29, s29, 4096
    v_mul_f32 v78, v70, v78
    v_mul_f32 v79, v71, v79
    v_mfma_f32_16x16x32_bf16 v[64:67], v[20:23], v[124:127], v[64:67]
    ds_read_b128 v[48:51], v4 offset:26624
    v_cvt_pk_bf16_f32 v76, v76, v77
    v_mfma_f32_16x16x32_bf16 v[64:67], v[16:19], v[116:119], v[64:67]
    s_waitcnt lgkmcnt(3)
    v_cvt_pk_bf16_f32 v78, v78, v79
    v_accvgpr_write_b32 a226, v76
    v_mfma_f32_16x16x32_bf16 v[64:67], v[28:31], v[140:143], v[64:67]
    ds_read_b128 v[16:19], v4 offset:27648
    v_accvgpr_write_b32 a227, v78
    v_mfma_f32_16x16x32_bf16 v[64:67], v[32:35], v[148:151], v[64:67]
    buffer_load_dword v11, v102, s[12:15], s32 offen sc1
    v_mfma_f32_16x16x32_bf16 v[64:67], v[36:39], v[156:159], v[64:67]
    ds_read_b128 v[20:23], v4 offset:28672
    v_mul_f32 v80, v72, v80
    v_mfma_f32_16x16x32_bf16 v[60:63], v[36:39], v[152:155], v[60:63]
    buffer_load_dwordx4 a[176:179], v4, s[12:15], s30 offen offset:2048 sc1
    v_mfma_f32_16x16x32_bf16 v[60:63], v[32:35], v[144:147], v[60:63]
    ds_read_b128 v[24:27], v4 offset:29696
    v_mul_f32 v81, v73, v81
    v_mfma_f32_16x16x32_bf16 v[60:63], v[28:31], v[136:139], v[60:63]
    s_waitcnt lgkmcnt(3)
    v_mul_f32 v82, v74, v82
    v_mul_f32 v83, v75, v83
    v_mfma_f32_16x16x32_bf16 v[60:63], v[40:43], v[160:163], v[60:63]
    ds_read_b128 v[28:31], v4 offset:30720
    v_cvt_pk_bf16_f32 v80, v80, v81
    v_mfma_f32_16x16x32_bf16 v[60:63], v[44:47], v[168:171], v[60:63]
    v_cvt_pk_bf16_f32 v82, v82, v83
    v_accvgpr_write_b32 a230, v80
    v_mfma_f32_16x16x32_bf16 v[60:63], v[48:51], v[176:179], v[60:63]
    ds_read_b128 v[32:35], v4 offset:31744
    v_accvgpr_write_b32 a231, v82
    v_mfma_f32_16x16x32_bf16 v[64:67], v[48:51], v[180:183], v[64:67]
    buffer_store_dwordx4 a[224:227], v4, s[12:15], s28 offen offset:2048 sc1
    v_mfma_f32_16x16x32_bf16 v[64:67], v[44:47], v[172:175], v[64:67]
    ds_read_b128 v[36:39], v4 offset:32768
    v_mul_f32 v84, v7, v52
    v_mfma_f32_16x16x32_bf16 v[64:67], v[40:43], v[164:167], v[64:67]
    s_waitcnt lgkmcnt(3)
    v_exp_f32 v84, v84
    v_mfma_f32_16x16x32_bf16 v[64:67], v[16:19], v[188:191], v[64:67]
    ds_read_b128 v[40:43], v4 offset:33792
    v_mul_f32 v85, v7, v53
    v_mfma_f32_16x16x32_bf16 v[64:67], v[20:23], v[196:199], v[64:67]
    buffer_load_dwordx4 a[180:183], v4, s[12:15], s30 offen offset:3072 sc1
    v_mfma_f32_16x16x32_bf16 v[64:67], v[24:27], v[204:207], v[64:67]
    ds_read_b128 v[44:47], v4 offset:34816
    s_add_u32 s30, s30, 4096
    v_mfma_f32_16x16x32_bf16 v[60:63], v[24:27], v[200:203], v[60:63]
    s_add_u32 m0, s27, 110592
    v_exp_f32 v85, v85
    v_mfma_f32_16x16x32_bf16 v[60:63], v[20:23], v[192:195], v[60:63]
    ds_read_b128 v[48:51], v4 offset:35840
    s_waitcnt vmcnt(22)
    s_barrier
    v_mfma_f32_16x16x32_bf16 v[60:63], v[16:19], v[184:187], v[60:63]
    s_waitcnt lgkmcnt(3)
    v_mul_f32 v86, v7, v54
    s_add_u32 s26, s26, 28672
    v_mfma_f32_16x16x32_bf16 v[60:63], v[28:31], v[208:211], v[60:63]
    ds_read_b128 v[16:19], v4 offset:36864
    v_exp_f32 v86, v86
    v_mfma_f32_16x16x32_bf16 v[60:63], v[32:35], v[216:219], v[60:63]
    buffer_load_dwordx4 v4, s[12:15], s26 offen offset:0 sc1 lds
    v_mfma_f32_16x16x32_bf16 v[60:63], v[36:39], v[224:227], v[60:63]
    ds_read_b128 v[20:23], v4 offset:37888
    v_mul_f32 v87, v7, v55
    v_mfma_f32_16x16x32_bf16 v[64:67], v[36:39], v[228:231], v[64:67]
    v_exp_f32 v87, v87
    v_mfma_f32_16x16x32_bf16 v[64:67], v[32:35], v[220:223], v[64:67]
    ds_read_b128 v[24:27], v4 offset:38912
    v_add_f32 v84, 1.0, v84
    v_mfma_f32_16x16x32_bf16 v[64:67], v[28:31], v[212:215], v[64:67]
    s_waitcnt lgkmcnt(3)
    v_rcp_f32 v84, v84
    v_mfma_f32_16x16x32_bf16 v[64:67], v[40:43], v[236:239], v[64:67]
    ds_read_b128 v[28:31], v4 offset:39936
    v_add_f32 v85, 1.0, v85
    v_mfma_f32_16x16x32_bf16 v[64:67], v[44:47], v[244:247], v[64:67]
    buffer_load_dwordx4 a[184:187], v4, s[12:15], s31 offen offset:2048 sc1
    v_mfma_f32_16x16x32_bf16 v[64:67], v[48:51], v[252:255], v[64:67]
    ds_read_b128 v[32:35], v4 offset:40960
    v_add_f32 v86, 1.0, v86
    v_mfma_f32_16x16x32_bf16 v[60:63], v[48:51], v[248:251], v[60:63]
    buffer_load_dwordx4 v4, s[12:15], s26 offen offset:1024 sc1 lds
    v_rcp_f32 v85, v85
    v_mfma_f32_16x16x32_bf16 v[60:63], v[44:47], v[240:243], v[60:63]
    ds_read_b128 v[36:39], v4 offset:41984
    v_add_f32 v87, 1.0, v87
    v_mfma_f32_16x16x32_bf16 v[60:63], v[40:43], v[232:235], v[60:63]
    s_waitcnt lgkmcnt(3)
    v_rcp_f32 v86, v86
    v_mfma_f32_16x16x32_bf16 v[68:71], v[16:19], v[112:115], 0
    ds_read_b128 v[40:43], v4 offset:43008
    v_mul_f32 v52, v84, v52
    v_mfma_f32_16x16x32_bf16 v[68:71], v[20:23], v[120:123], v[68:71]
    buffer_load_dwordx4 a[188:191], v4, s[12:15], s31 offen offset:3072 sc1
    v_mfma_f32_16x16x32_bf16 v[68:71], v[24:27], v[128:131], v[68:71]
    ds_read_b128 v[44:47], v4 offset:44032
    s_add_u32 s31, s31, 4096
    v_mfma_f32_16x16x32_bf16 v[72:75], v[24:27], v[132:135], 0
    buffer_load_dwordx4 v4, s[12:15], s26 offen offset:2048 sc1 lds
    v_rcp_f32 v87, v87
    v_mfma_f32_16x16x32_bf16 v[72:75], v[20:23], v[124:127], v[72:75]
    ds_read_b128 v[48:51], v4 offset:45056
    v_mul_f32 v53, v85, v53
    v_mfma_f32_16x16x32_bf16 v[72:75], v[16:19], v[116:119], v[72:75]
    s_waitcnt lgkmcnt(3)
    v_mul_f32 v54, v86, v54
    v_mul_f32 v55, v87, v55
    v_mfma_f32_16x16x32_bf16 v[72:75], v[28:31], v[140:143], v[72:75]
    ds_read_b128 v[16:19], v4 offset:46080
    v_mul_f32 v88, v8, v56
    v_mfma_f32_16x16x32_bf16 v[72:75], v[32:35], v[148:151], v[72:75]
    buffer_load_dwordx4 v4, s[12:15], s26 offen offset:3072 sc1 lds
    v_mfma_f32_16x16x32_bf16 v[72:75], v[36:39], v[156:159], v[72:75]
    ds_read_b128 v[20:23], v4 offset:47104
    v_mul_f32 v89, v8, v57
    v_mfma_f32_16x16x32_bf16 v[68:71], v[36:39], v[152:155], v[68:71]
    s_add_u32 m0, s27, 114688
    v_exp_f32 v88, v88
    v_mfma_f32_16x16x32_bf16 v[68:71], v[32:35], v[144:147], v[68:71]
    ds_read_b128 v[24:27], v4 offset:48128
    s_add_u32 s26, s26, 4096
    v_mfma_f32_16x16x32_bf16 v[68:71], v[28:31], v[136:139], v[68:71]
    s_waitcnt lgkmcnt(3)
    v_exp_f32 v89, v89
    v_mfma_f32_16x16x32_bf16 v[68:71], v[40:43], v[160:163], v[68:71]
    ds_read_b128 v[28:31], v4 offset:49152
    v_mul_f32 v90, v8, v58
    v_mfma_f32_16x16x32_bf16 v[68:71], v[44:47], v[168:171], v[68:71]
    buffer_load_dwordx4 v4, s[12:15], s26 offen offset:0 sc1 lds
    v_mfma_f32_16x16x32_bf16 v[68:71], v[48:51], v[176:179], v[68:71]
    ds_read_b128 v[32:35], v4 offset:50176
    v_mul_f32 v91, v8, v59
    v_mfma_f32_16x16x32_bf16 v[72:75], v[48:51], v[180:183], v[72:75]
    v_exp_f32 v90, v90
    v_mfma_f32_16x16x32_bf16 v[72:75], v[44:47], v[172:175], v[72:75]
    ds_read_b128 v[36:39], v4 offset:51200
    v_add_f32 v88, 1.0, v88
    v_mfma_f32_16x16x32_bf16 v[72:75], v[40:43], v[164:167], v[72:75]
    s_waitcnt lgkmcnt(3)
    v_exp_f32 v91, v91
    v_mfma_f32_16x16x32_bf16 v[72:75], v[16:19], v[188:191], v[72:75]
    ds_read_b128 v[40:43], v4 offset:52224
    v_add_f32 v89, 1.0, v89
    v_mfma_f32_16x16x32_bf16 v[72:75], v[20:23], v[196:199], v[72:75]
    buffer_load_dwordx4 v4, s[12:15], s26 offen offset:1024 sc1 lds
    v_mfma_f32_16x16x32_bf16 v[72:75], v[24:27], v[204:207], v[72:75]
    ds_read_b128 v[44:47], v4 offset:53248
    v_add_f32 v90, 1.0, v90
    v_mfma_f32_16x16x32_bf16 v[68:71], v[24:27], v[200:203], v[68:71]
    s_waitcnt vmcnt(11)
    v_cmp_gt_u32 vcc, 4, v11
    s_cbranch_vccnz late_30
late_30_ok:
    v_mfma_f32_16x16x32_bf16 v[68:71], v[20:23], v[192:195], v[68:71]
    ds_read_b128 v[48:51], v4 offset:54272
    v_rcp_f32 v88, v88
    v_mfma_f32_16x16x32_bf16 v[68:71], v[16:19], v[184:187], v[68:71]
    s_waitcnt lgkmcnt(3)
    v_rcp_f32 v89, v89
    v_mfma_f32_16x16x32_bf16 v[68:71], v[28:31], v[208:211], v[68:71]
    ds_read_b128 v[16:19], v4 offset:55296
    v_add_f32 v91, 1.0, v91
    v_mfma_f32_16x16x32_bf16 v[68:71], v[32:35], v[216:219], v[68:71]
    buffer_load_dwordx4 a[200:203], v4, s[12:15], s29 offen offset:0 sc1
    v_mfma_f32_16x16x32_bf16 v[68:71], v[36:39], v[224:227], v[68:71]
    ds_read_b128 v[20:23], v4 offset:56320
    v_mul_f32 v56, v88, v56
    v_mfma_f32_16x16x32_bf16 v[72:75], v[36:39], v[228:231], v[72:75]
    buffer_load_dwordx4 v4, s[12:15], s26 offen offset:2048 sc1 lds
    v_mfma_f32_16x16x32_bf16 v[72:75], v[32:35], v[220:223], v[72:75]
    ds_read_b128 v[24:27], v4 offset:57344
    v_rcp_f32 v90, v90
    v_mfma_f32_16x16x32_bf16 v[72:75], v[28:31], v[212:215], v[72:75]
    s_waitcnt lgkmcnt(3)
    v_rcp_f32 v91, v91
    v_mfma_f32_16x16x32_bf16 v[72:75], v[40:43], v[236:239], v[72:75]
    ds_read_b128 v[28:31], v4 offset:58368
    v_mul_f32 v57, v89, v57
    v_mfma_f32_16x16x32_bf16 v[72:75], v[44:47], v[244:247], v[72:75]
    buffer_load_dwordx4 a[204:207], v4, s[12:15], s29 offen offset:1024 sc1
    v_mfma_f32_16x16x32_bf16 v[72:75], v[48:51], v[252:255], v[72:75]
    ds_read_b128 v[32:35], v4 offset:59392
    v_mul_f32 v58, v90, v58
    v_mfma_f32_16x16x32_bf16 v[68:71], v[48:51], v[248:251], v[68:71]
    buffer_load_dwordx4 v4, s[12:15], s26 offen offset:3072 sc1 lds
    v_mfma_f32_16x16x32_bf16 v[68:71], v[44:47], v[240:243], v[68:71]
    ds_read_b128 v[36:39], v4 offset:60416
    v_mul_f32 v59, v91, v59
    v_mfma_f32_16x16x32_bf16 v[68:71], v[40:43], v[232:235], v[68:71]
    s_waitcnt lgkmcnt(3)
    s_add_u32 m0, s27, 118784
    s_add_u32 s26, s26, 4096
    v_mfma_f32_16x16x32_bf16 v[76:79], v[16:19], v[112:115], 0
    ds_read_b128 v[40:43], v4 offset:61440
    v_mul_f32 v60, v52, v60
    v_mfma_f32_16x16x32_bf16 v[76:79], v[20:23], v[120:123], v[76:79]
    buffer_load_dwordx4 v4, s[12:15], s26 offen offset:0 sc1 lds
    v_mfma_f32_16x16x32_bf16 v[76:79], v[24:27], v[128:131], v[76:79]
    ds_read_b128 v[44:47], v4 offset:62464
    v_mul_f32 v61, v53, v61
    v_mfma_f32_16x16x32_bf16 v[80:83], v[24:27], v[132:135], 0
    buffer_load_dwordx4 a[208:211], v4, s[12:15], s30 offen offset:0 sc1
    v_mul_f32 v62, v54, v62
    v_mfma_f32_16x16x32_bf16 v[80:83], v[20:23], v[124:127], v[80:83]
    ds_read_b128 v[48:51], v4 offset:63488
    v_mul_f32 v63, v55, v63
    v_mfma_f32_16x16x32_bf16 v[80:83], v[16:19], v[116:119], v[80:83]
    s_waitcnt lgkmcnt(3)
    v_cvt_pk_bf16_f32 v104, v60, v61
    v_cvt_pk_bf16_f32 v105, v62, v63
    v_mfma_f32_16x16x32_bf16 v[80:83], v[28:31], v[140:143], v[80:83]
    ds_read_b128 v[16:19], v4 offset:64512
    v_mul_f32 v84, v7, v68
    v_mfma_f32_16x16x32_bf16 v[80:83], v[32:35], v[148:151], v[80:83]
    v_exp_f32 v84, v84
    v_mfma_f32_16x16x32_bf16 v[80:83], v[36:39], v[156:159], v[80:83]
    ds_read_b128 v[20:23], v5 offset:0
    v_mul_f32 v64, v56, v64
    v_mfma_f32_16x16x32_bf16 v[76:79], v[36:39], v[152:155], v[76:79]
    buffer_load_dwordx4 a[212:215], v4, s[12:15], s30 offen offset:1024 sc1
    v_mul_f32 v85, v7, v69
    v_mfma_f32_16x16x32_bf16 v[76:79], v[32:35], v[144:147], v[76:79]
    ds_read_b128 v[24:27], v5 offset:1024
    v_mul_f32 v65, v57, v65
    v_exp_f32 v85, v85
    v_mfma_f32_16x16x32_bf16 v[76:79], v[28:31], v[136:139], v[76:79]
    s_waitcnt lgkmcnt(3)
    v_mul_f32 v66, v58, v66
    v_mul_f32 v86, v7, v70
    v_mfma_f32_16x16x32_bf16 v[76:79], v[40:43], v[160:163], v[76:79]
    ds_read_b128 v[28:31], v5 offset:2048
    v_exp_f32 v86, v86
    v_mfma_f32_16x16x32_bf16 v[76:79], v[44:47], v[168:171], v[76:79]
    v_mul_f32 v67, v59, v67
    v_cvt_pk_bf16_f32 v108, v64, v65
    v_mfma_f32_16x16x32_bf16 v[76:79], v[48:51], v[176:179], v[76:79]
    ds_read_b128 v[32:35], v5 offset:3072
    v_mul_f32 v87, v7, v71
    v_exp_f32 v87, v87
    v_mfma_f32_16x16x32_bf16 v[80:83], v[48:51], v[180:183], v[80:83]
    buffer_store_dwordx4 a[228:231], v4, s[12:15], s28 offen offset:3072 sc1
    v_cvt_pk_bf16_f32 v109, v66, v67
    v_mfma_f32_16x16x32_bf16 v[80:83], v[44:47], v[172:175], v[80:83]
    ds_read_b128 v[36:39], v5 offset:4096
    v_add_f32 v84, 1.0, v84
    v_mfma_f32_16x16x32_bf16 v[80:83], v[40:43], v[164:167], v[80:83]
    s_waitcnt lgkmcnt(3)
    v_rcp_f32 v84, v84
    v_mfma_f32_16x16x32_bf16 v[80:83], v[16:19], v[188:191], v[80:83]
    ds_read_b128 v[40:43], v5 offset:5120
    v_add_f32 v85, 1.0, v85
    v_mfma_f32_16x16x32_bf16 v[80:83], v[20:23], v[196:199], v[80:83]
    s_add_u32 s28, s28, 4096
    v_rcp_f32 v85, v85
    buffer_load_dwordx4 a[216:219], v4, s[12:15], s31 offen offset:0 sc1
    v_mfma_f32_16x16x32_bf16 v[80:83], v[24:27], v[204:207], v[80:83]
    ds_read_b128 v[44:47], v5 offset:6144
    v_add_f32 v86, 1.0, v86
    v_mfma_f32_16x16x32_bf16 v[76:79], v[24:27], v[200:203], v[76:79]
    s_add_u32 m0, s27, 0
    v_rcp_f32 v86, v86
    v_mfma_f32_16x16x32_bf16 v[76:79], v[20:23], v[192:195], v[76:79]
    ds_read_b128 v[48:51], v5 offset:7168
    s_barrier
    v_mfma_f32_16x16x32_bf16 v[76:79], v[16:19], v[184:187], v[76:79]
    s_waitcnt lgkmcnt(3)
    v_add_f32 v87, 1.0, v87
    s_add_u32 s26, s26, 28672
    v_mfma_f32_16x16x32_bf16 v[76:79], v[28:31], v[208:211], v[76:79]
    ds_read_b128 v[16:19], v5 offset:8192
    v_rcp_f32 v87, v87
    v_mfma_f32_16x16x32_bf16 v[76:79], v[32:35], v[216:219], v[76:79]
    buffer_load_dwordx4 a[220:223], v4, s[12:15], s31 offen offset:1024 sc1
    v_mul_f32 v68, v84, v68
    v_mfma_f32_16x16x32_bf16 v[76:79], v[36:39], v[224:227], v[76:79]
    ds_read_b128 v[20:23], v5 offset:9216
    v_mul_f32 v69, v85, v69
    v_mfma_f32_16x16x32_bf16 v[80:83], v[36:39], v[228:231], v[80:83]
    buffer_load_dwordx4 v4, s[12:15], s26 offen offset:0 sc1 lds
    v_mul_f32 v70, v86, v70
    v_mfma_f32_16x16x32_bf16 v[80:83], v[32:35], v[220:223], v[80:83]
    ds_read_b128 v[24:27], v5 offset:10240
    v_mul_f32 v71, v87, v71
    v_mfma_f32_16x16x32_bf16 v[80:83], v[28:31], v[212:215], v[80:83]
    s_waitcnt lgkmcnt(3)
    v_mul_f32 v88, v8, v72
    v_exp_f32 v88, v88
    v_mfma_f32_16x16x32_bf16 v[80:83], v[40:43], v[236:239], v[80:83]
    ds_read_b128 v[28:31], v5 offset:11264
    v_mul_f32 v89, v8, v73
    v_mfma_f32_16x16x32_bf16 v[80:83], v[44:47], v[244:247], v[80:83]
    buffer_load_dwordx4 v4, s[12:15], s26 offen offset:1024 sc1 lds
    v_mfma_f32_16x16x32_bf16 v[80:83], v[48:51], v[252:255], v[80:83]
    ds_read_b128 v[32:35], v5 offset:12288
    v_exp_f32 v89, v89
    v_mfma_f32_16x16x32_bf16 v[76:79], v[48:51], v[248:251], v[76:79]
    v_mul_f32 v90, v8, v74
    v_mul_f32 v91, v8, v75
    v_mfma_f32_16x16x32_bf16 v[76:79], v[44:47], v[240:243], v[76:79]
    ds_read_b128 v[36:39], v5 offset:13312
    v_exp_f32 v90, v90
    v_mfma_f32_16x16x32_bf16 v[76:79], v[40:43], v[232:235], v[76:79]
    s_waitcnt lgkmcnt(3)
    v_exp_f32 v91, v91
    v_mfma_f32_16x16x32_bf16 v[136:139], v[16:19], a[0:3], 0
    ds_read_b128 v[40:43], v5 offset:14336
    v_add_f32 v88, 1.0, v88
    v_mfma_f32_16x16x32_bf16 v[136:139], v[20:23], a[32:35], v[136:139]
    buffer_load_dwordx4 v4, s[12:15], s26 offen offset:2048 sc1 lds
    v_mfma_f32_16x16x32_bf16 v[136:139], v[24:27], a[64:67], v[136:139]
    ds_read_b128 v[44:47], v5 offset:15360
    v_add_f32 v89, 1.0, v89
    v_mfma_f32_16x16x32_bf16 v[140:143], v[24:27], a[68:71], 0
    v_rcp_f32 v88, v88
    v_mfma_f32_16x16x32_bf16 v[140:143], v[20:23], a[36:39], v[140:143]
    ds_read_b128 v[48:51], v5 offset:16384
    v_add_f32 v90, 1.0, v90
    v_mfma_f32_16x16x32_bf16 v[140:143], v[16:19], a[4:7], v[140:143]
    s_waitcnt lgkmcnt(3)
    v_rcp_f32 v89, v89
    v_mfma_f32_16x16x32_bf16 v[140:143], v[28:31], a[100:103], v[140:143]
    ds_read_b128 v[16:19], v5 offset:17408
    v_add_f32 v91, 1.0, v91
    v_mfma_f32_16x16x32_bf16 v[140:143], v[32:35], a[132:135], v[140:143]
    v_rcp_f32 v90, v90
    v_mfma_f32_16x16x32_bf16 v[140:143], v[36:39], a[164:167], v[140:143]
    ds_read_b128 v[20:23], v5 offset:18432
    v_mul_f32 v72, v88, v72
    v_mfma_f32_16x16x32_bf16 v[136:139], v[36:39], a[160:163], v[136:139]
    buffer_load_dwordx4 v4, s[12:15], s26 offen offset:3072 sc1 lds
    v_mfma_f32_16x16x32_bf16 v[136:139], v[32:35], a[128:131], v[136:139]
    ds_read_b128 v[24:27], v5 offset:19456
    v_rcp_f32 v91, v91
    v_mfma_f32_16x16x32_bf16 v[136:139], v[28:31], a[96:99], v[136:139]
    s_waitcnt lgkmcnt(3)
    v_mul_f32 v73, v89, v73
    s_add_u32 m0, s27, 4096
    v_mfma_f32_16x16x32_bf16 v[136:139], v[40:43], a[8:11], v[136:139]
    ds_read_b128 v[28:31], v5 offset:20480
    s_add_u32 s26, s26, 4096
    v_mfma_f32_16x16x32_bf16 v[136:139], v[44:47], a[16:19], v[136:139]
    v_mul_f32 v74, v90, v74
    v_mul_f32 v75, v91, v75
    v_mfma_f32_16x16x32_bf16 v[136:139], v[48:51], a[24:27], v[136:139]
    ds_read_b128 v[32:35], v5 offset:21504
    v_mul_f32 v76, v68, v76
    v_mfma_f32_16x16x32_bf16 v[140:143], v[48:51], a[28:31], v[140:143]
    buffer_load_dwordx4 v4, s[12:15], s26 offen offset:0 sc1 lds
    v_mfma_f32_16x16x32_bf16 v[140:143], v[44:47], a[20:23], v[140:143]
    ds_read_b128 v[36:39], v5 offset:22528
    v_mul_f32 v77, v69, v77
    v_mfma_f32_16x16x32_bf16 v[140:143], v[40:43], a[12:15], v[140:143]
    s_waitcnt lgkmcnt(3)
    v_mul_f32 v78, v70, v78
    v_mul_f32 v79, v71, v79
    v_mfma_f32_16x16x32_bf16 v[140:143], v[16:19], a[44:47], v[140:143]
    ds_read_b128 v[40:43], v5 offset:23552
    v_cvt_pk_bf16_f32 v106, v76, v77
    v_mfma_f32_16x16x32_bf16 v[140:143], v[20:23], a[52:55], v[140:143]
    buffer_load_dwordx4 v4, s[12:15], s26 offen offset:1024 sc1 lds
    v_mfma_f32_16x16x32_bf16 v[140:143], v[24:27], a[60:63], v[140:143]
    ds_read_b128 v[44:47], v5 offset:24576
    v_cvt_pk_bf16_f32 v107, v78, v79
    v_mfma_f32_16x16x32_bf16 v[136:139], v[24:27], a[56:59], v[136:139]
    v_mul_f32 v80, v72, v80
    v_mul_f32 v81, v73, v81
    v_mfma_f32_16x16x32_bf16 v[136:139], v[20:23], a[48:51], v[136:139]
    ds_read_b128 v[48:51], v5 offset:25600
    v_mul_f32 v82, v74, v82
    v_mfma_f32_16x16x32_bf16 v[136:139], v[16:19], a[40:43], v[136:139]
    s_waitcnt lgkmcnt(3)
    v_mul_f32 v83, v75, v83
    v_cvt_pk_bf16_f32 v110, v80, v81
    v_mfma_f32_16x16x32_bf16 v[136:139], v[28:31], a[72:75], v[136:139]
    ds_read_b128 v[16:19], v5 offset:26624
    v_cvt_pk_bf16_f32 v111, v82, v83
    v_mfma_f32_16x16x32_bf16 v[136:139], v[32:35], a[80:83], v[136:139]
    buffer_load_dwordx4 v4, s[12:15], s26 offen offset:2048 sc1 lds
    v_mfma_f32_16x16x32_bf16 v[136:139], v[36:39], a[88:91], v[136:139]
    ds_read_b128 v[20:23], v5 offset:27648
    v_mfma_f32_16x16x32_bf16 v[140:143], v[36:39], a[92:95], v[140:143]
    buffer_store_dwordx4 v[104:107], v4, s[12:15], s28 offen offset:0 sc1
    v_mfma_f32_16x16x32_bf16 v[140:143], v[32:35], a[84:87], v[140:143]
    ds_read_b128 v[24:27], v5 offset:28672
    v_mfma_f32_16x16x32_bf16 v[140:143], v[28:31], a[76:79], v[140:143]
    s_waitcnt lgkmcnt(3)
    v_mfma_f32_16x16x32_bf16 v[140:143], v[40:43], a[108:111], v[140:143]
    ds_read_b128 v[28:31], v5 offset:29696
    v_mfma_f32_16x16x32_bf16 v[140:143], v[44:47], a[116:119], v[140:143]
    buffer_load_dwordx4 v4, s[12:15], s26 offen offset:3072 sc1 lds
    v_mfma_f32_16x16x32_bf16 v[140:143], v[48:51], a[124:127], v[140:143]
    ds_read_b128 v[32:35], v5 offset:30720
    s_add_u32 m0, s27, 8192
    v_mfma_f32_16x16x32_bf16 v[136:139], v[48:51], a[120:123], v[136:139]
    buffer_store_dwordx4 v[108:111], v4, s[12:15], s28 offen offset:1024 sc1
    v_mfma_f32_16x16x32_bf16 v[136:139], v[44:47], a[112:115], v[136:139]
    ds_read_b128 v[36:39], v5 offset:31744
    s_add_u32 s26, s26, 4096
    v_mfma_f32_16x16x32_bf16 v[136:139], v[40:43], a[104:107], v[136:139]
    s_waitcnt lgkmcnt(3)
    v_mfma_f32_16x16x32_bf16 v[136:139], v[16:19], a[136:139], v[136:139]
    ds_read_b128 v[40:43], v5 offset:32768
hop_7:
    s_cbranch_execz back_7
    v_mfma_f32_16x16x32_bf16 v[136:139], v[20:23], a[144:147], v[136:139]
    buffer_load_dwordx4 v4, s[12:15], s26 offen offset:0 sc1 lds
    v_mfma_f32_16x16x32_bf16 v[136:139], v[24:27], a[152:155], v[136:139]
    ds_read_b128 v[44:47], v5 offset:33792
    v_mfma_f32_16x16x32_bf16 v[140:143], v[24:27], a[156:159], v[140:143]
    v_mfma_f32_16x16x32_bf16 v[140:143], v[20:23], a[148:151], v[140:143]
    ds_read_b128 v[48:51], v5 offset:34816
    v_mfma_f32_16x16x32_bf16 v[140:143], v[16:19], a[140:143], v[140:143]
    s_waitcnt vmcnt(25) lgkmcnt(3)
    v_mfma_f32_16x16x32_bf16 v[140:143], v[28:31], a[172:175], v[140:143]
    ds_read_b128 v[16:19], v5 offset:35840
    v_mfma_f32_16x16x32_bf16 v[140:143], v[32:35], a[180:183], v[140:143]
    v_mfma_f32_16x16x32_bf16 v[140:143], v[36:39], a[188:191], v[140:143]
    ds_read_b128 v[20:23], v5 offset:36864
    v_mfma_f32_16x16x32_bf16 v[136:139], v[36:39], a[184:187], v[136:139]
    v_mfma_f32_16x16x32_bf16 v[136:139], v[32:35], a[176:179], v[136:139]
    ds_read_b128 v[24:27], v5 offset:37888
    v_mfma_f32_16x16x32_bf16 v[136:139], v[28:31], a[168:171], v[136:139]
    s_waitcnt vmcnt(11) lgkmcnt(3)
    v_mfma_f32_16x16x32_bf16 v[136:139], v[40:43], a[200:203], v[136:139]
    ds_read_b128 v[28:31], v5 offset:38912
    v_mfma_f32_16x16x32_bf16 v[136:139], v[44:47], a[208:211], v[136:139]
    v_mfma_f32_16x16x32_bf16 v[136:139], v[48:51], a[216:219], v[136:139]
    ds_read_b128 v[32:35], v5 offset:39936
    v_mfma_f32_16x16x32_bf16 v[140:143], v[48:51], a[220:223], v[140:143]
    v_mfma_f32_16x16x32_bf16 v[140:143], v[44:47], a[212:215], v[140:143]
    ds_read_b128 v[36:39], v5 offset:40960
    v_mfma_f32_16x16x32_bf16 v[140:143], v[40:43], a[204:207], v[140:143]
    s_waitcnt lgkmcnt(3)
    v_mfma_f32_16x16x32_bf16 v[148:151], v[16:19], a[4:7], 0
    ds_read_b128 v[40:43], v5 offset:41984
    v_mfma_f32_16x16x32_bf16 v[148:151], v[20:23], a[36:39], v[148:151]
    v_mfma_f32_16x16x32_bf16 v[148:151], v[24:27], a[68:71], v[148:151]
    ds_read_b128 v[44:47], v5 offset:43008
    s_add_u32 m0, s27, 36864
    v_mfma_f32_16x16x32_bf16 v[144:147], v[24:27], a[64:67], 0
    s_add_u32 s26, s26, 28672
    v_mfma_f32_16x16x32_bf16 v[144:147], v[20:23], a[32:35], v[144:147]
    ds_read_b128 v[48:51], v5 offset:44032
    s_barrier
    v_mfma_f32_16x16x32_bf16 v[144:147], v[16:19], a[0:3], v[144:147]
    s_waitcnt lgkmcnt(3)
    v_mfma_f32_16x16x32_bf16 v[144:147], v[28:31], a[96:99], v[144:147]
    ds_read_b128 v[16:19], v5 offset:45056
    v_mfma_f32_16x16x32_bf16 v[144:147], v[32:35], a[128:131], v[144:147]
    buffer_load_dwordx4 v4, s[12:15], s26 offen offset:0 sc1 lds
    v_mfma_f32_16x16x32_bf16 v[144:147], v[36:39], a[160:163], v[144:147]
    ds_read_b128 v[20:23], v5 offset:46080
    v_mfma_f32_16x16x32_bf16 v[148:151], v[36:39], a[164:167], v[148:151]
    v_mfma_f32_16x16x32_bf16 v[148:151], v[32:35], a[132:135], v[148:151]
    ds_read_b128 v[24:27], v5 offset:47104
    v_mfma_f32_16x16x32_bf16 v[148:151], v[28:31], a[100:103], v[148:151]
    s_waitcnt lgkmcnt(3)
    v_mfma_f32_16x16x32_bf16 v[148:151], v[40:43], a[12:15], v[148:151]
    ds_read_b128 v[28:31], v5 offset:48128
    v_mfma_f32_16x16x32_bf16 v[148:151], v[44:47], a[20:23], v[148:151]
    buffer_load_dwordx4 v4, s[12:15], s26 offen offset:1024 sc1 lds
    v_mfma_f32_16x16x32_bf16 v[148:151], v[48:51], a[28:31], v[148:151]
    ds_read_b128 v[32:35], v5 offset:49152
    v_mfma_f32_16x16x32_bf16 v[144:147], v[48:51], a[24:27], v[144:147]
    v_mfma_f32_16x16x32_bf16 v[144:147], v[44:47], a[16:19], v[144:147]
    ds_read_b128 v[36:39], v5 offset:50176
    v_mfma_f32_16x16x32_bf16 v[144:147], v[40:43], a[8:11], v[144:147]
    s_waitcnt lgkmcnt(3)
    v_mfma_f32_16x16x32_bf16 v[144:147], v[16:19], a[40:43], v[144:147]
    ds_read_b128 v[40:43], v5 offset:51200
    v_mfma_f32_16x16x32_bf16 v[144:147], v[20:23], a[48:51], v[144:147]
    buffer_load_dwordx4 v4, s[12:15], s26 offen offset:2048 sc1 lds
    v_mfma_f32_16x16x32_bf16 v[144:147], v[24:27], a[56:59], v[144:147]
    ds_read_b128 v[44:47], v5 offset:52224
    v_mfma_f32_16x16x32_bf16 v[148:151], v[24:27], a[60:63], v[148:151]
    v_mfma_f32_16x16x32_bf16 v[148:151], v[20:23], a[52:55], v[148:151]
    ds_read_b128 v[48:51], v5 offset:53248
    v_mfma_f32_16x16x32_bf16 v[148:151], v[16:19], a[44:47], v[148:151]
    s_waitcnt lgkmcnt(3)
    v_mfma_f32_16x16x32_bf16 v[148:151], v[28:31], a[76:79], v[148:151]
    ds_read_b128 v[16:19], v5 offset:54272
    v_mfma_f32_16x16x32_bf16 v[148:151], v[32:35], a[84:87], v[148:151]
    buffer_load_dwordx4 v4, s[12:15], s26 offen offset:3072 sc1 lds
    v_mfma_f32_16x16x32_bf16 v[148:151], v[36:39], a[92:95], v[148:151]
    ds_read_b128 v[20:23], v5 offset:55296
    s_add_u32 m0, s27, 40960
    v_mfma_f32_16x16x32_bf16 v[144:147], v[36:39], a[88:91], v[144:147]
    s_add_u32 s26, s26, 4096
    v_mfma_f32_16x16x32_bf16 v[144:147], v[32:35], a[80:83], v[144:147]
    ds_read_b128 v[24:27], v5 offset:56320
    v_mov_b32 v15, 5
    v_mfma_f32_16x16x32_bf16 v[144:147], v[28:31], a[72:75], v[144:147]
    s_waitcnt lgkmcnt(3)
    s_waitcnt vmcnt(5)
    v_mfma_f32_16x16x32_bf16 v[144:147], v[40:43], a[104:107], v[144:147]
    ds_read_b128 v[28:31], v5 offset:57344
    v_mfma_f32_16x16x32_bf16 v[144:147], v[44:47], a[112:115], v[144:147]
    buffer_load_dwordx4 v4, s[12:15], s26 offen offset:0 sc1 lds
    v_mfma_f32_16x16x32_bf16 v[144:147], v[48:51], a[120:123], v[144:147]
    ds_read_b128 v[32:35], v5 offset:58368
    v_mfma_f32_16x16x32_bf16 v[148:151], v[48:51], a[124:127], v[148:151]
    buffer_store_dword v15, v12, s[12:15], s32 offen sc1
    v_mfma_f32_16x16x32_bf16 v[148:151], v[44:47], a[116:119], v[148:151]
    ds_read_b128 v[36:39], v5 offset:59392
    v_mfma_f32_16x16x32_bf16 v[148:151], v[40:43], a[108:111], v[148:151]
    s_waitcnt lgkmcnt(3)
    v_mfma_f32_16x16x32_bf16 v[148:151], v[16:19], a[140:143], v[148:151]
    ds_read_b128 v[40:43], v5 offset:60416
    v_mfma_f32_16x16x32_bf16 v[148:151], v[20:23], a[148:151], v[148:151]
    buffer_load_dwordx4 v4, s[12:15], s26 offen offset:1024 sc1 lds
    v_mfma_f32_16x16x32_bf16 v[148:151], v[24:27], a[156:159], v[148:151]
    ds_read_b128 v[44:47], v5 offset:61440
    v_mfma_f32_16x16x32_bf16 v[144:147], v[24:27], a[152:155], v[144:147]
    v_mfma_f32_16x16x32_bf16 v[144:147], v[20:23], a[144:147], v[144:147]
    ds_read_b128 v[48:51], v5 offset:62464
    v_mfma_f32_16x16x32_bf16 v[144:147], v[16:19], a[136:139], v[144:147]
    s_waitcnt lgkmcnt(3)
    v_mfma_f32_16x16x32_bf16 v[144:147], v[28:31], a[168:171], v[144:147]
    ds_read_b128 v[16:19], v5 offset:63488
    v_mfma_f32_16x16x32_bf16 v[144:147], v[32:35], a[176:179], v[144:147]
    buffer_load_dwordx4 v4, s[12:15], s26 offen offset:2048 sc1 lds
    v_mfma_f32_16x16x32_bf16 v[144:147], v[36:39], a[184:187], v[144:147]
    ds_read_b128 v[20:23], v5 offset:64512
    v_mfma_f32_16x16x32_bf16 v[148:151], v[36:39], a[188:191], v[148:151]
    v_mfma_f32_16x16x32_bf16 v[148:151], v[32:35], a[180:183], v[148:151]
    ds_read_b128 v[24:27], v6 offset:0
    v_mfma_f32_16x16x32_bf16 v[148:151], v[28:31], a[172:175], v[148:151]
    s_waitcnt lgkmcnt(3)
    v_mfma_f32_16x16x32_bf16 v[148:151], v[40:43], a[204:207], v[148:151]
    ds_read_b128 v[28:31], v6 offset:1024
    v_mfma_f32_16x16x32_bf16 v[148:151], v[44:47], a[212:215], v[148:151]
    buffer_load_dwordx4 v4, s[12:15], s26 offen offset:3072 sc1 lds
    v_mfma_f32_16x16x32_bf16 v[148:151], v[48:51], a[220:223], v[148:151]
    ds_read_b128 v[32:35], v6 offset:2048
    s_add_u32 m0, s27, 45056
    v_mfma_f32_16x16x32_bf16 v[144:147], v[48:51], a[216:219], v[144:147]
    s_add_u32 s26, s26, 4096
    v_mfma_f32_16x16x32_bf16 v[144:147], v[44:47], a[208:211], v[144:147]
    ds_read_b128 v[36:39], v6 offset:3072
    v_mfma_f32_16x16x32_bf16 v[144:147], v[40:43], a[200:203], v[144:147]
    s_waitcnt lgkmcnt(3)
    v_mfma_f32_16x16x32_bf16 v[152:155], v[16:19], a[0:3], 0
    ds_read_b128 v[40:43], v6 offset:4096
    v_mfma_f32_16x16x32_bf16 v[152:155], v[20:23], a[32:35], v[152:155]
    buffer_load_dwordx4 v4, s[12:15], s26 offen offset:0 sc1 lds
    v_mfma_f32_16x16x32_bf16 v[152:155], v[24:27], a[64:67], v[152:155]
    ds_read_b128 v[44:47], v6 offset:5120
    v_mfma_f32_16x16x32_bf16 v[156:159], v[24:27], a[68:71], 0
    v_mfma_f32_16x16x32_bf16 v[156:159], v[20:23], a[36:39], v[156:159]
    ds_read_b128 v[48:51], v6 offset:6144
    v_mfma_f32_16x16x32_bf16 v[156:159], v[16:19], a[4:7], v[156:159]
    s_waitcnt lgkmcnt(3)
    v_mfma_f32_16x16x32_bf16 v[156:159], v[28:31], a[100:103], v[156:159]
    ds_read_b128 v[16:19], v6 offset:7168
    v_mfma_f32_16x16x32_bf16 v[156:159], v[32:35], a[132:135], v[156:159]
    v_mfma_f32_16x16x32_bf16 v[156:159], v[36:39], a[164:167], v[156:159]
    ds_read_b128 v[20:23], v6 offset:8192
    v_mfma_f32_16x16x32_bf16 v[152:155], v[36:39], a[160:163], v[152:155]
    v_mfma_f32_16x16x32_bf16 v[152:155], v[32:35], a[128:131], v[152:155]
    ds_read_b128 v[24:27], v6 offset:9216
    v_mfma_f32_16x16x32_bf16 v[152:155], v[28:31], a[96:99], v[152:155]
    s_waitcnt lgkmcnt(3)
    v_mfma_f32_16x16x32_bf16 v[152:155], v[40:43], a[8:11], v[152:155]
    ds_read_b128 v[28:31], v6 offset:10240
    v_mfma_f32_16x16x32_bf16 v[152:155], v[44:47], a[16:19], v[152:155]
    v_mfma_f32_16x16x32_bf16 v[152:155], v[48:51], a[24:27], v[152:155]
    ds_read_b128 v[32:35], v6 offset:11264
    v_mfma_f32_16x16x32_bf16 v[156:159], v[48:51], a[28:31], v[156:159]
    v_mfma_f32_16x16x32_bf16 v[156:159], v[44:47], a[20:23], v[156:159]
    ds_read_b128 v[36:39], v6 offset:12288
    v_mfma_f32_16x16x32_bf16 v[156:159], v[40:43], a[12:15], v[156:159]
    s_waitcnt lgkmcnt(3)
    v_mfma_f32_16x16x32_bf16 v[156:159], v[16:19], a[44:47], v[156:159]
    ds_read_b128 v[40:43], v6 offset:13312
    v_mfma_f32_16x16x32_bf16 v[156:159], v[20:23], a[52:55], v[156:159]
    v_mfma_f32_16x16x32_bf16 v[156:159], v[24:27], a[60:63], v[156:159]
    ds_read_b128 v[44:47], v6 offset:14336
    s_add_u32 m0, s27, 73728
    v_mfma_f32_16x16x32_bf16 v[152:155], v[24:27], a[56:59], v[152:155]
    s_add_u32 s26, s26, 28672
    v_mfma_f32_16x16x32_bf16 v[152:155], v[20:23], a[48:51], v[152:155]
    ds_read_b128 v[48:51], v6 offset:15360
    s_waitcnt vmcnt(10)
    s_barrier
    v_mfma_f32_16x16x32_bf16 v[152:155], v[16:19], a[40:43], v[152:155]
    s_waitcnt lgkmcnt(3)
    v_mfma_f32_16x16x32_bf16 v[152:155], v[28:31], a[72:75], v[152:155]
    ds_read_b128 v[16:19], v4 offset:0
    v_mfma_f32_16x16x32_bf16 v[152:155], v[32:35], a[80:83], v[152:155]
    buffer_load_dwordx4 v4, s[12:15], s26 offen offset:0 sc1 lds
    v_mfma_f32_16x16x32_bf16 v[152:155], v[36:39], a[88:91], v[152:155]
    ds_read_b128 v[20:23], v4 offset:1024
    v_mfma_f32_16x16x32_bf16 v[156:159], v[36:39], a[92:95], v[156:159]
    buffer_load_dword v11, v102, s[12:15], s32 offen sc1
    v_mfma_f32_16x16x32_bf16 v[156:159], v[32:35], a[84:87], v[156:159]
    ds_read_b128 v[24:27], v4 offset:2048
    v_mfma_f32_16x16x32_bf16 v[156:159], v[28:31], a[76:79], v[156:159]
    s_waitcnt lgkmcnt(3)
    v_mfma_f32_16x16x32_bf16 v[156:159], v[40:43], a[108:111], v[156:159]
    ds_read_b128 v[28:31], v4 offset:3072
    v_mfma_f32_16x16x32_bf16 v[156:159], v[44:47], a[116:119], v[156:159]
    buffer_load_dwordx4 v4, s[12:15], s26 offen offset:1024 sc1 lds
    v_mfma_f32_16x16x32_bf16 v[156:159], v[48:51], a[124:127], v[156:159]
    ds_read_b128 v[32:35], v4 offset:4096
    v_mfma_f32_16x16x32_bf16 v[152:155], v[48:51], a[120:123], v[152:155]
    v_mfma_f32_16x16x32_bf16 v[152:155], v[44:47], a[112:115], v[152:155]
    ds_read_b128 v[36:39], v4 offset:5120
    v_mfma_f32_16x16x32_bf16 v[152:155], v[40:43], a[104:107], v[152:155]
    s_waitcnt lgkmcnt(3)
    v_mfma_f32_16x16x32_bf16 v[152:155], v[16:19], a[136:139], v[152:155]
    ds_read_b128 v[40:43], v4 offset:6144
    v_mfma_f32_16x16x32_bf16 v[152:155], v[20:23], a[144:147], v[152:155]
    buffer_load_dwordx4 v4, s[12:15], s26 offen offset:2048 sc1 lds
    v_mfma_f32_16x16x32_bf16 v[152:155], v[24:27], a[152:155], v[152:155]
    ds_read_b128 v[44:47], v4 offset:7168
    v_mfma_f32_16x16x32_bf16 v[156:159], v[24:27], a[156:159], v[156:159]
    v_mfma_f32_16x16x32_bf16 v[156:159], v[20:23], a[148:151], v[156:159]
    ds_read_b128 v[48:51], v4 offset:8192
    v_mfma_f32_16x16x32_bf16 v[156:159], v[16:19], a[140:143], v[156:159]
    s_waitcnt lgkmcnt(3)
    v_mfma_f32_16x16x32_bf16 v[156:159], v[28:31], a[172:175], v[156:159]
    ds_read_b128 v[16:19], v4 offset:9216
    v_mfma_f32_16x16x32_bf16 v[156:159], v[32:35], a[180:183], v[156:159]
    buffer_load_dwordx4 v4, s[12:15], s26 offen offset:3072 sc1 lds
    v_mfma_f32_16x16x32_bf16 v[156:159], v[36:39], a[188:191], v[156:159]
    ds_read_b128 v[20:23], v4 offset:10240
    s_add_u32 m0, s27, 77824
    v_mfma_f32_16x16x32_bf16 v[152:155], v[36:39], a[184:187], v[152:155]
    s_add_u32 s26, s26, 4096
    v_mfma_f32_16x16x32_bf16 v[152:155], v[32:35], a[176:179], v[152:155]
    ds_read_b128 v[24:27], v4 offset:11264
    v_mfma_f32_16x16x32_bf16 v[152:155], v[28:31], a[168:171], v[152:155]
    s_waitcnt lgkmcnt(3)
    v_mfma_f32_16x16x32_bf16 v[152:155], v[40:43], a[200:203], v[152:155]
    ds_read_b128 v[28:31], v4 offset:12288
    v_mfma_f32_16x16x32_bf16 v[152:155], v[44:47], a[208:211], v[152:155]
    buffer_load_dwordx4 v4, s[12:15], s26 offen offset:0 sc1 lds
    v_mfma_f32_16x16x32_bf16 v[152:155], v[48:51], a[216:219], v[152:155]
    ds_read_b128 v[32:35], v4 offset:13312
    v_mfma_f32_16x16x32_bf16 v[156:159], v[48:51], a[220:223], v[156:159]
    v_mfma_f32_16x16x32_bf16 v[156:159], v[44:47], a[212:215], v[156:159]
    ds_read_b128 v[36:39], v4 offset:14336
    v_mfma_f32_16x16x32_bf16 v[156:159], v[40:43], a[204:207], v[156:159]
    s_waitcnt lgkmcnt(3)
    v_mfma_f32_16x16x32_bf16 v[164:167], v[16:19], a[4:7], 0
    ds_read_b128 v[40:43], v4 offset:15360
    v_mfma_f32_16x16x32_bf16 v[164:167], v[20:23], a[36:39], v[164:167]
    buffer_load_dwordx4 v4, s[12:15], s26 offen offset:1024 sc1 lds
    v_mfma_f32_16x16x32_bf16 v[164:167], v[24:27], a[68:71], v[164:167]
    ds_read_b128 v[44:47], v4 offset:16384
    v_mfma_f32_16x16x32_bf16 v[160:163], v[24:27], a[64:67], 0
    v_mfma_f32_16x16x32_bf16 v[160:163], v[20:23], a[32:35], v[160:163]
    ds_read_b128 v[48:51], v4 offset:17408
    v_mfma_f32_16x16x32_bf16 v[160:163], v[16:19], a[0:3], v[160:163]
    s_waitcnt lgkmcnt(3)
    v_mfma_f32_16x16x32_bf16 v[160:163], v[28:31], a[96:99], v[160:163]
    ds_read_b128 v[16:19], v4 offset:18432
    v_mfma_f32_16x16x32_bf16 v[160:163], v[32:35], a[128:131], v[160:163]
    buffer_load_dwordx4 v4, s[12:15], s26 offen offset:2048 sc1 lds
    v_mfma_f32_16x16x32_bf16 v[160:163], v[36:39], a[160:163], v[160:163]
    ds_read_b128 v[20:23], v4 offset:19456
    v_mfma_f32_16x16x32_bf16 v[164:167], v[36:39], a[164:167], v[164:167]
    v_mfma_f32_16x16x32_bf16 v[164:167], v[32:35], a[132:135], v[164:167]
    ds_read_b128 v[24:27], v4 offset:20480
    v_mfma_f32_16x16x32_bf16 v[164:167], v[28:31], a[100:103], v[164:167]
    s_waitcnt lgkmcnt(3)
    v_mfma_f32_16x16x32_bf16 v[164:167], v[40:43], a[12:15], v[164:167]
    ds_read_b128 v[28:31], v4 offset:21504
    v_mfma_f32_16x16x32_bf16 v[164:167], v[44:47], a[20:23], v[164:167]
    buffer_load_dwordx4 v4, s[12:15], s26 offen offset:3072 sc1 lds
    v_mfma_f32_16x16x32_bf16 v[164:167], v[48:51], a[28:31], v[164:167]
    ds_read_b128 v[32:35], v4 offset:22528
    s_add_u32 m0, s27, 81920
    v_mfma_f32_16x16x32_bf16 v[160:163], v[48:51], a[24:27], v[160:163]
    s_add_u32 s26, s26, 4096
    v_mfma_f32_16x16x32_bf16 v[160:163], v[44:47], a[16:19], v[160:163]
    ds_read_b128 v[36:39], v4 offset:23552
    v_mfma_f32_16x16x32_bf16 v[160:163], v[40:43], a[8:11], v[160:163]
    s_waitcnt lgkmcnt(3)
    v_mfma_f32_16x16x32_bf16 v[160:163], v[16:19], a[40:43], v[160:163]
    ds_read_b128 v[40:43], v4 offset:24576
    v_mfma_f32_16x16x32_bf16 v[160:163], v[20:23], a[48:51], v[160:163]
    buffer_load_dwordx4 v4, s[12:15], s26 offen offset:0 sc1 lds
    v_mfma_f32_16x16x32_bf16 v[160:163], v[24:27], a[56:59], v[160:163]
    ds_read_b128 v[44:47], v4 offset:25600
    v_mfma_f32_16x16x32_bf16 v[164:167], v[24:27], a[60:63], v[164:167]
    s_waitcnt vmcnt(8)
    v_cmp_gt_u32 vcc, 5, v11
    s_cbranch_vccnz late_31
late_31_ok:
    v_mfma_f32_16x16x32_bf16 v[164:167], v[20:23], a[52:55], v[164:167]
    ds_read_b128 v[48:51], v4 offset:26624
    v_mfma_f32_16x16x32_bf16 v[164:167], v[16:19], a[44:47], v[164:167]
    s_waitcnt lgkmcnt(3)
    v_mfma_f32_16x16x32_bf16 v[164:167], v[28:31], a[76:79], v[164:167]
    ds_read_b128 v[16:19], v4 offset:27648
    v_mfma_f32_16x16x32_bf16 v[164:167], v[32:35], a[84:87], v[164:167]
    buffer_load_dwordx4 a[232:235], v4, s[12:15], s29 offen offset:2048 sc1
    v_mfma_f32_16x16x32_bf16 v[164:167], v[36:39], a[92:95], v[164:167]
    ds_read_b128 v[20:23], v4 offset:28672
    v_mfma_f32_16x16x32_bf16 v[160:163], v[36:39], a[88:91], v[160:163]
    buffer_load_dwordx4 a[236:239], v4, s[12:15], s29 offen offset:3072 sc1
    v_mfma_f32_16x16x32_bf16 v[160:163], v[32:35], a[80:83], v[160:163]
    ds_read_b128 v[24:27], v4 offset:29696
    s_add_u32 s29, s29, 4096
    v_mfma_f32_16x16x32_bf16 v[160:163], v[28:31], a[72:75], v[160:163]
    s_waitcnt lgkmcnt(3)
    v_mfma_f32_16x16x32_bf16 v[160:163], v[40:43], a[104:107], v[160:163]
    ds_read_b128 v[28:31], v4 offset:30720
    v_mfma_f32_16x16x32_bf16 v[160:163], v[44:47], a[112:115], v[160:163]
    buffer_load_dwordx4 a[240:243], v4, s[12:15], s30 offen offset:2048 sc1
    v_mfma_f32_16x16x32_bf16 v[160:163], v[48:51], a[120:123], v[160:163]
    ds_read_b128 v[32:35], v4 offset:31744
    v_mfma_f32_16x16x32_bf16 v[164:167], v[48:51], a[124:127], v[164:167]
    buffer_load_dwordx4 a[244:247], v4, s[12:15], s30 offen offset:3072 sc1
    v_mfma_f32_16x16x32_bf16 v[164:167], v[44:47], a[116:119], v[164:167]
    ds_read_b128 v[36:39], v4 offset:32768
    s_add_u32 s30, s30, 4096
    v_mfma_f32_16x16x32_bf16 v[164:167], v[40:43], a[108:111], v[164:167]
    s_waitcnt lgkmcnt(3)
    v_mfma_f32_16x16x32_bf16 v[164:167], v[16:19], a[140:143], v[164:167]
    ds_read_b128 v[40:43], v4 offset:33792
    v_mfma_f32_16x16x32_bf16 v[164:167], v[20:23], a[148:151], v[164:167]
    buffer_load_dwordx4 a[248:251], v4, s[12:15], s31 offen offset:2048 sc1
    v_mfma_f32_16x16x32_bf16 v[164:167], v[24:27], a[156:159], v[164:167]
    ds_read_b128 v[44:47], v4 offset:34816
    s_add_u32 m0, s27, 110592
    v_mfma_f32_16x16x32_bf16 v[160:163], v[24:27], a[152:155], v[160:163]
    buffer_load_dwordx4 a[252:255], v4, s[12:15], s31 offen offset:3072 sc1
    v_mfma_f32_16x16x32_bf16 v[160:163], v[20:23], a[144:147], v[160:163]
    ds_read_b128 v[48:51], v4 offset:35840
    s_barrier
    v_mfma_f32_16x16x32_bf16 v[160:163], v[16:19], a[136:139], v[160:163]
    s_waitcnt lgkmcnt(3)
    s_add_u32 s26, s26, 28672
    s_add_u32 s31, s31, 4096
    v_mfma_f32_16x16x32_bf16 v[160:163], v[28:31], a[168:171], v[160:163]
    ds_read_b128 v[16:19], v4 offset:36864
    v_mfma_f32_16x16x32_bf16 v[160:163], v[32:35], a[176:179], v[160:163]
    buffer_load_dwordx4 v4, s[12:15], s26 offen offset:0 sc1 lds
    v_mfma_f32_16x16x32_bf16 v[160:163], v[36:39], a[184:187], v[160:163]
    ds_read_b128 v[20:23], v4 offset:37888
    v_mfma_f32_16x16x32_bf16 v[164:167], v[36:39], a[188:191], v[164:167]
    buffer_load_dwordx4 v[112:115], v4, s[12:15], s29 offen offset:0 sc1
    v_mfma_f32_16x16x32_bf16 v[164:167], v[32:35], a[180:183], v[164:167]
    ds_read_b128 v[24:27], v4 offset:38912
    v_mfma_f32_16x16x32_bf16 v[164:167], v[28:31], a[172:175], v[164:167]
    s_waitcnt lgkmcnt(3)
    v_mfma_f32_16x16x32_bf16 v[164:167], v[40:43], a[204:207], v[164:167]
    ds_read_b128 v[28:31], v4 offset:39936
    v_mfma_f32_16x16x32_bf16 v[164:167], v[44:47], a[212:215], v[164:167]
    buffer_load_dwordx4 v[116:119], v4, s[12:15], s29 offen offset:1024 sc1
    v_mfma_f32_16x16x32_bf16 v[164:167], v[48:51], a[220:223], v[164:167]
    ds_read_b128 v[32:35], v4 offset:40960
    v_mfma_f32_16x16x32_bf16 v[160:163], v[48:51], a[216:219], v[160:163]
    buffer_load_dwordx4 v4, s[12:15], s26 offen offset:1024 sc1 lds
    buffer_load_dwordx4 v[120:123], v4, s[12:15], s30 offen offset:0 sc1
    v_mfma_f32_16x16x32_bf16 v[160:163], v[44:47], a[208:211], v[160:163]
    ds_read_b128 v[36:39], v4 offset:41984
    v_mfma_f32_16x16x32_bf16 v[160:163], v[40:43], a[200:203], v[160:163]
    s_waitcnt lgkmcnt(3)
    v_mfma_f32_16x16x32_bf16 v[136:139], v[16:19], a[192:195], v[136:139]
    ds_read_b128 v[40:43], v4 offset:43008
    v_mfma_f32_16x16x32_bf16 v[136:139], v[20:23], a[224:227], v[136:139]
    buffer_load_dwordx4 v[124:127], v4, s[12:15], s30 offen offset:1024 sc1
    v_mfma_f32_16x16x32_bf16 v[136:139], v[24:27], v[104:107], v[136:139]
    ds_read_b128 v[44:47], v4 offset:44032
    v_mfma_f32_16x16x32_bf16 v[140:143], v[24:27], v[108:111], v[140:143]
    buffer_load_dwordx4 v4, s[12:15], s26 offen offset:2048 sc1 lds
    buffer_load_dwordx4 v[128:131], v4, s[12:15], s31 offen offset:0 sc1
    v_mfma_f32_16x16x32_bf16 v[140:143], v[20:23], a[228:231], v[140:143]
    ds_read_b128 v[48:51], v4 offset:45056
    v_mfma_f32_16x16x32_bf16 v[140:143], v[16:19], a[196:199], v[140:143]
    s_waitcnt lgkmcnt(3)
    v_mfma_f32_16x16x32_bf16 v[148:151], v[28:31], a[196:199], v[148:151]
    ds_read_b128 v[16:19], v4 offset:46080
    v_mfma_f32_16x16x32_bf16 v[148:151], v[32:35], a[228:231], v[148:151]
    buffer_load_dwordx4 v[132:135], v4, s[12:15], s31 offen offset:1024 sc1
    v_mfma_f32_16x16x32_bf16 v[148:151], v[36:39], v[108:111], v[148:151]
    ds_read_b128 v[20:23], v4 offset:47104
    v_mfma_f32_16x16x32_bf16 v[144:147], v[36:39], v[104:107], v[144:147]
    buffer_load_dwordx4 v4, s[12:15], s26 offen offset:3072 sc1 lds
    v_mfma_f32_16x16x32_bf16 v[144:147], v[32:35], a[224:227], v[144:147]
    ds_read_b128 v[24:27], v4 offset:48128
    s_add_u32 m0, s27, 114688
    v_mfma_f32_16x16x32_bf16 v[144:147], v[28:31], a[192:195], v[144:147]
    s_waitcnt lgkmcnt(3)
    s_add_u32 s26, s26, 4096
    v_mfma_f32_16x16x32_bf16 v[152:155], v[40:43], a[192:195], v[152:155]
    ds_read_b128 v[28:31], v4 offset:49152
    v_mfma_f32_16x16x32_bf16 v[152:155], v[44:47], a[224:227], v[152:155]
    buffer_load_dwordx4 v4, s[12:15], s26 offen offset:0 sc1 lds
    v_mfma_f32_16x16x32_bf16 v[152:155], v[48:51], v[104:107], v[152:155]
    ds_read_b128 v[32:35], v4 offset:50176
    v_mfma_f32_16x16x32_bf16 v[156:159], v[48:51], v[108:111], v[156:159]
    v_mfma_f32_16x16x32_bf16 v[156:159], v[44:47], a[228:231], v[156:159]
    ds_read_b128 v[36:39], v4 offset:51200
    v_mfma_f32_16x16x32_bf16 v[156:159], v[40:43], a[196:199], v[156:159]
    s_waitcnt lgkmcnt(3)
    v_mfma_f32_16x16x32_bf16 v[164:167], v[16:19], a[196:199], v[164:167]
    ds_read_b128 v[40:43], v4 offset:52224
    v_mfma_f32_16x16x32_bf16 v[164:167], v[20:23], a[228:231], v[164:167]
    buffer_load_dwordx4 v4, s[12:15], s26 offen offset:1024 sc1 lds
    v_mfma_f32_16x16x32_bf16 v[164:167], v[24:27], v[108:111], v[164:167]
    ds_read_b128 v[44:47], v4 offset:53248
    v_mfma_f32_16x16x32_bf16 v[160:163], v[24:27], v[104:107], v[160:163]
    v_mfma_f32_16x16x32_bf16 v[160:163], v[20:23], a[224:227], v[160:163]
    ds_read_b128 v[48:51], v4 offset:54272
    v_mfma_f32_16x16x32_bf16 v[160:163], v[16:19], a[192:195], v[160:163]
    s_waitcnt vmcnt(12) lgkmcnt(3)
    v_mfma_f32_16x16x32_bf16 v[136:139], v[28:31], a[232:235], v[136:139]
    ds_read_b128 v[16:19], v4 offset:55296
    v_mfma_f32_16x16x32_bf16 v[136:139], v[32:35], a[240:243], v[136:139]
    buffer_load_dwordx4 v4, s[12:15], s26 offen offset:2048 sc1 lds
    v_mfma_f32_16x16x32_bf16 v[136:139], v[36:39], a[248:251], v[136:139]
    ds_read_b128 v[20:23], v4 offset:56320
    v_mfma_f32_16x16x32_bf16 v[140:143], v[36:39], a[252:255], v[140:143]
    v_mfma_f32_16x16x32_bf16 v[140:143], v[32:35], a[244:247], v[140:143]
    ds_read_b128 v[24:27], v4 offset:57344
    v_mfma_f32_16x16x32_bf16 v[140:143], v[28:31], a[236:239], v[140:143]
    s_waitcnt lgkmcnt(3)
    v_mfma_f32_16x16x32_bf16 v[148:151], v[40:43], a[236:239], v[148:151]
    ds_read_b128 v[28:31], v4 offset:58368
    v_mfma_f32_16x16x32_bf16 v[148:151], v[44:47], a[244:247], v[148:151]
    buffer_load_dwordx4 v4, s[12:15], s26 offen offset:3072 sc1 lds
    v_mfma_f32_16x16x32_bf16 v[148:151], v[48:51], a[252:255], v[148:151]
    ds_read_b128 v[32:35], v4 offset:59392
    s_add_u32 m0, s27, 118784
    v_mfma_f32_16x16x32_bf16 v[144:147], v[48:51], a[248:251], v[144:147]
    s_add_u32 s26, s26, 4096
    v_mfma_f32_16x16x32_bf16 v[144:147], v[44:47], a[240:243], v[144:147]
    ds_read_b128 v[36:39], v4 offset:60416
    v_mfma_f32_16x16x32_bf16 v[144:147], v[40:43], a[232:235], v[144:147]
    s_waitcnt lgkmcnt(3)
    v_mfma_f32_16x16x32_bf16 v[152:155], v[16:19], a[232:235], v[152:155]
    ds_read_b128 v[40:43], v4 offset:61440
    v_mfma_f32_16x16x32_bf16 v[152:155], v[20:23], a[240:243], v[152:155]
    buffer_load_dwordx4 v4, s[12:15], s26 offen offset:0 sc1 lds
    v_mfma_f32_16x16x32_bf16 v[152:155], v[24:27], a[248:251], v[152:155]
    ds_read_b128 v[44:47], v4 offset:62464
    v_mfma_f32_16x16x32_bf16 v[156:159], v[24:27], a[252:255], v[156:159]
    v_mfma_f32_16x16x32_bf16 v[156:159], v[20:23], a[244:247], v[156:159]
    ds_read_b128 v[48:51], v4 offset:63488
    v_mfma_f32_16x16x32_bf16 v[156:159], v[16:19], a[236:239], v[156:159]
    s_waitcnt lgkmcnt(3)
    v_mfma_f32_16x16x32_bf16 v[164:167], v[28:31], a[236:239], v[164:167]
    ds_read_b128 v[16:19], v4 offset:64512
    v_mfma_f32_16x16x32_bf16 v[164:167], v[32:35], a[244:247], v[164:167]
    v_mfma_f32_16x16x32_bf16 v[164:167], v[36:39], a[252:255], v[164:167]
    ds_read_b128 v[20:23], v5 offset:0
    v_mfma_f32_16x16x32_bf16 v[160:163], v[36:39], a[248:251], v[160:163]
    v_mfma_f32_16x16x32_bf16 v[160:163], v[32:35], a[240:243], v[160:163]
    ds_read_b128 v[24:27], v5 offset:1024
    v_mfma_f32_16x16x32_bf16 v[160:163], v[28:31], a[232:235], v[160:163]
    s_waitcnt vmcnt(6) lgkmcnt(3)
    v_mfma_f32_16x16x32_bf16 v[136:139], v[40:43], v[112:115], v[136:139]
    ds_read_b128 v[28:31], v5 offset:2048
    v_mfma_f32_16x16x32_bf16 v[136:139], v[44:47], v[120:123], v[136:139]
    v_mfma_f32_16x16x32_bf16 v[136:139], v[48:51], v[128:131], v[136:139]
    ds_read_b128 v[32:35], v5 offset:3072
    v_mfma_f32_16x16x32_bf16 v[140:143], v[48:51], v[132:135], v[140:143]
    v_mfma_f32_16x16x32_bf16 v[140:143], v[44:47], v[124:127], v[140:143]
    ds_read_b128 v[36:39], v5 offset:4096
    v_mfma_f32_16x16x32_bf16 v[140:143], v[40:43], v[116:119], v[140:143]
    s_waitcnt lgkmcnt(3)
    v_mfma_f32_16x16x32_bf16 v[148:151], v[16:19], v[116:119], v[148:151]
    ds_read_b128 v[40:43], v5 offset:5120
    v_mfma_f32_16x16x32_bf16 v[148:151], v[20:23], v[124:127], v[148:151]
    v_mfma_f32_16x16x32_bf16 v[148:151], v[24:27], v[132:135], v[148:151]
    ds_read_b128 v[44:47], v5 offset:6144
    s_add_u32 m0, s27, 0
    v_mfma_f32_16x16x32_bf16 v[144:147], v[24:27], v[128:131], v[144:147]
    s_add_u32 s26, s26, 28672
    v_mfma_f32_16x16x32_bf16 v[144:147], v[20:23], v[120:123], v[144:147]
    ds_read_b128 v[48:51], v5 offset:7168
    s_barrier
    v_mfma_f32_16x16x32_bf16 v[144:147], v[16:19], v[112:115], v[144:147]
    s_waitcnt lgkmcnt(3)
    v_mfma_f32_16x16x32_bf16 v[152:155], v[28:31], v[112:115], v[152:155]
    ds_read_b128 v[16:19], v5 offset:8192
    v_mfma_f32_16x16x32_bf16 v[152:155], v[32:35], v[120:123], v[152:155]
    buffer_load_dwordx4 v4, s[12:15], s26 offen offset:0 sc1 lds
    v_mfma_f32_16x16x32_bf16 v[152:155], v[36:39], v[128:131], v[152:155]
    ds_read_b128 v[20:23], v5 offset:9216
    v_mul_f32 v136, v9, v136
    v_mfma_f32_16x16x32_bf16 v[156:159], v[36:39], v[132:135], v[156:159]
    v_mul_f32 v137, v9, v137
    v_mul_f32 v138, v9, v138
    v_mfma_f32_16x16x32_bf16 v[156:159], v[32:35], v[124:127], v[156:159]
    ds_read_b128 v[24:27], v5 offset:10240
    v_mul_f32 v139, v9, v139
    v_mfma_f32_16x16x32_bf16 v[156:159], v[28:31], v[116:119], v[156:159]
    s_waitcnt lgkmcnt(3)
    v_cvt_pk_bf16_f32 v224, v136, v137
    v_cvt_pk_bf16_f32 v225, v138, v139
    v_mfma_f32_16x16x32_bf16 v[164:167], v[40:43], v[116:119], v[164:167]
    ds_read_b128 v[28:31], v5 offset:11264
    v_mul_f32 v140, v10, v140
    v_mfma_f32_16x16x32_bf16 v[164:167], v[44:47], v[124:127], v[164:167]
    buffer_load_dwordx4 v4, s[12:15], s26 offen offset:1024 sc1 lds
    v_mfma_f32_16x16x32_bf16 v[164:167], v[48:51], v[132:135], v[164:167]
    ds_read_b128 v[32:35], v5 offset:12288
    v_mul_f32 v141, v10, v141
    v_mfma_f32_16x16x32_bf16 v[160:163], v[48:51], v[128:131], v[160:163]
    v_mul_f32 v142, v10, v142
    v_mul_f32 v143, v10, v143
    v_mfma_f32_16x16x32_bf16 v[160:163], v[44:47], v[120:123], v[160:163]
    ds_read_b128 v[36:39], v5 offset:13312
    v_cvt_pk_bf16_f32 v226, v140, v141
    v_mfma_f32_16x16x32_bf16 v[160:163], v[40:43], v[112:115], v[160:163]
    s_waitcnt lgkmcnt(3)
    v_cvt_pk_bf16_f32 v227, v142, v143
    v_mfma_f32_16x16x32_bf16 v[168:171], v[16:19], a[0:3], 0
    ds_read_b128 v[40:43], v5 offset:14336
    v_mfma_f32_16x16x32_bf16 v[168:171], v[20:23], a[32:35], v[168:171]
    buffer_load_dwordx4 v4, s[12:15], s26 offen offset:2048 sc1 lds
    v_mfma_f32_16x16x32_bf16 v[168:171], v[24:27], a[64:67], v[168:171]
    ds_read_b128 v[44:47], v5 offset:15360
    v_mfma_f32_16x16x32_bf16 v[172:175], v[24:27], a[68:71], 0
    buffer_store_dwordx4 v[224:227], v4, s[12:15], s49 offen sc1
    v_mfma_f32_16x16x32_bf16 v[172:175], v[20:23], a[36:39], v[172:175]
    ds_read_b128 v[48:51], v5 offset:16384
    v_mfma_f32_16x16x32_bf16 v[172:175], v[16:19], a[4:7], v[172:175]
    s_waitcnt lgkmcnt(3)
    v_mfma_f32_16x16x32_bf16 v[172:175], v[28:31], a[100:103], v[172:175]
    ds_read_b128 v[16:19], v5 offset:17408
    v_mul_f32 v144, v9, v144
    v_mfma_f32_16x16x32_bf16 v[172:175], v[32:35], a[132:135], v[172:175]
    buffer_load_dwordx4 v4, s[12:15], s26 offen offset:3072 sc1 lds
    v_mfma_f32_16x16x32_bf16 v[172:175], v[36:39], a[164:167], v[172:175]
    ds_read_b128 v[20:23], v5 offset:18432
    v_mul_f32 v145, v9, v145
    v_mfma_f32_16x16x32_bf16 v[168:171], v[36:39], a[160:163], v[168:171]
    s_add_u32 m0, s27, 4096
    v_mul_f32 v146, v9, v146
    s_add_u32 s26, s26, 4096
    v_mfma_f32_16x16x32_bf16 v[168:171], v[32:35], a[128:131], v[168:171]
    ds_read_b128 v[24:27], v5 offset:19456
    v_mul_f32 v147, v9, v147
    v_mfma_f32_16x16x32_bf16 v[168:171], v[28:31], a[96:99], v[168:171]
    s_waitcnt lgkmcnt(3)
    v_cvt_pk_bf16_f32 v208, v144, v145
    v_cvt_pk_bf16_f32 v209, v146, v147
    v_mfma_f32_16x16x32_bf16 v[168:171], v[40:43], a[8:11], v[168:171]
    ds_read_b128 v[28:31], v5 offset:20480
    v_mul_f32 v148, v10, v148
    v_mfma_f32_16x16x32_bf16 v[168:171], v[44:47], a[16:19], v[168:171]
    buffer_load_dwordx4 v4, s[12:15], s26 offen offset:0 sc1 lds
    v_mfma_f32_16x16x32_bf16 v[168:171], v[48:51], a[24:27], v[168:171]
    ds_read_b128 v[32:35], v5 offset:21504
    v_mul_f32 v149, v10, v149
hop_8:
    s_cbranch_execz back_8
    v_mfma_f32_16x16x32_bf16 v[172:175], v[48:51], a[28:31], v[172:175]
    v_mul_f32 v150, v10, v150
    v_mul_f32 v151, v10, v151
    v_mfma_f32_16x16x32_bf16 v[172:175], v[44:47], a[20:23], v[172:175]
    ds_read_b128 v[36:39], v5 offset:22528
    v_cvt_pk_bf16_f32 v212, v148, v149
    v_mfma_f32_16x16x32_bf16 v[172:175], v[40:43], a[12:15], v[172:175]
    s_waitcnt lgkmcnt(3)
    v_cvt_pk_bf16_f32 v213, v150, v151
    v_mfma_f32_16x16x32_bf16 v[172:175], v[16:19], a[44:47], v[172:175]
    ds_read_b128 v[40:43], v5 offset:23552
    v_mfma_f32_16x16x32_bf16 v[172:175], v[20:23], a[52:55], v[172:175]
    buffer_load_dwordx4 v4, s[12:15], s26 offen offset:1024 sc1 lds
    v_mfma_f32_16x16x32_bf16 v[172:175], v[24:27], a[60:63], v[172:175]
    ds_read_b128 v[44:47], v5 offset:24576
    v_mfma_f32_16x16x32_bf16 v[168:171], v[24:27], a[56:59], v[168:171]
    v_mfma_f32_16x16x32_bf16 v[168:171], v[20:23], a[48:51], v[168:171]
    ds_read_b128 v[48:51], v5 offset:25600
    v_mul_f32 v152, v9, v152
    v_mfma_f32_16x16x32_bf16 v[168:171], v[16:19], a[40:43], v[168:171]
    s_waitcnt lgkmcnt(3)
    v_mul_f32 v153, v9, v153
    v_mul_f32 v154, v9, v154
    v_mfma_f32_16x16x32_bf16 v[168:171], v[28:31], a[72:75], v[168:171]
    ds_read_b128 v[16:19], v5 offset:26624
    v_mul_f32 v155, v9, v155
    v_mfma_f32_16x16x32_bf16 v[168:171], v[32:35], a[80:83], v[168:171]
    buffer_load_dwordx4 v4, s[12:15], s26 offen offset:2048 sc1 lds
    v_mfma_f32_16x16x32_bf16 v[168:171], v[36:39], a[88:91], v[168:171]
    ds_read_b128 v[20:23], v5 offset:27648
    v_cvt_pk_bf16_f32 v210, v152, v153
    v_mfma_f32_16x16x32_bf16 v[172:175], v[36:39], a[92:95], v[172:175]
    v_cvt_pk_bf16_f32 v211, v154, v155
    v_mfma_f32_16x16x32_bf16 v[172:175], v[32:35], a[84:87], v[172:175]
    ds_read_b128 v[24:27], v5 offset:28672
    v_mfma_f32_16x16x32_bf16 v[172:175], v[28:31], a[76:79], v[172:175]
    s_waitcnt lgkmcnt(3)
    buffer_store_dwordx4 v[208:211], v4, s[12:15], s35 offen offset:0 sc1
    v_mfma_f32_16x16x32_bf16 v[172:175], v[40:43], a[108:111], v[172:175]
    ds_read_b128 v[28:31], v5 offset:29696
    v_mul_f32 v156, v10, v156
    v_mfma_f32_16x16x32_bf16 v[172:175], v[44:47], a[116:119], v[172:175]
    buffer_load_dwordx4 v4, s[12:15], s26 offen offset:3072 sc1 lds
    v_mfma_f32_16x16x32_bf16 v[172:175], v[48:51], a[124:127], v[172:175]
    ds_read_b128 v[32:35], v5 offset:30720
    v_mul_f32 v157, v10, v157
    v_mfma_f32_16x16x32_bf16 v[168:171], v[48:51], a[120:123], v[168:171]
    s_add_u32 m0, s27, 8192
    v_mul_f32 v158, v10, v158
    v_mul_f32 v159, v10, v159
    v_mfma_f32_16x16x32_bf16 v[168:171], v[44:47], a[112:115], v[168:171]
    ds_read_b128 v[36:39], v5 offset:31744
    v_cvt_pk_bf16_f32 v214, v156, v157
    v_mfma_f32_16x16x32_bf16 v[168:171], v[40:43], a[104:107], v[168:171]
    s_waitcnt lgkmcnt(3)
    v_cvt_pk_bf16_f32 v215, v158, v159
    s_add_u32 s26, s26, 4096
    v_mfma_f32_16x16x32_bf16 v[168:171], v[16:19], a[136:139], v[168:171]
    ds_read_b128 v[40:43], v5 offset:32768
    v_mfma_f32_16x16x32_bf16 v[168:171], v[20:23], a[144:147], v[168:171]
    buffer_store_dwordx4 v[212:215], v4, s[12:15], s35 offen offset:1024 sc1
    v_mfma_f32_16x16x32_bf16 v[168:171], v[24:27], a[152:155], v[168:171]
    ds_read_b128 v[44:47], v5 offset:33792
    v_mul_f32 v160, v9, v160
    v_mfma_f32_16x16x32_bf16 v[172:175], v[24:27], a[156:159], v[172:175]
    buffer_load_dwordx4 v4, s[12:15], s26 offen offset:0 sc1 lds
    v_mfma_f32_16x16x32_bf16 v[172:175], v[20:23], a[148:151], v[172:175]
    ds_read_b128 v[48:51], v5 offset:34816
    v_mul_f32 v161, v9, v161
    v_mfma_f32_16x16x32_bf16 v[172:175], v[16:19], a[140:143], v[172:175]
    s_waitcnt lgkmcnt(3)
    v_mul_f32 v162, v9, v162
    v_mul_f32 v163, v9, v163
    v_mfma_f32_16x16x32_bf16 v[172:175], v[28:31], a[172:175], v[172:175]
    ds_read_b128 v[16:19], v5 offset:35840
    v_cvt_pk_bf16_f32 v216, v160, v161
    v_mfma_f32_16x16x32_bf16 v[172:175], v[32:35], a[180:183], v[172:175]
    v_cvt_pk_bf16_f32 v217, v162, v163
    v_mul_f32 v164, v10, v164
    v_mfma_f32_16x16x32_bf16 v[172:175], v[36:39], a[188:191], v[172:175]
    ds_read_b128 v[20:23], v5 offset:36864
    v_mul_f32 v165, v10, v165
    v_mfma_f32_16x16x32_bf16 v[168:171], v[36:39], a[184:187], v[168:171]
    v_mul_f32 v166, v10, v166
    v_mul_f32 v167, v10, v167
    v_mfma_f32_16x16x32_bf16 v[168:171], v[32:35], a[176:179], v[168:171]
    ds_read_b128 v[24:27], v5 offset:37888
    v_cvt_pk_bf16_f32 v220, v164, v165
    v_mfma_f32_16x16x32_bf16 v[168:171], v[28:31], a[168:171], v[168:171]
    s_waitcnt lgkmcnt(3)
    v_cvt_pk_bf16_f32 v221, v166, v167
    v_mfma_f32_16x16x32_bf16 v[168:171], v[40:43], a[200:203], v[168:171]
    ds_read_b128 v[28:31], v5 offset:38912
    v_mfma_f32_16x16x32_bf16 v[168:171], v[44:47], a[208:211], v[168:171]
    v_mfma_f32_16x16x32_bf16 v[168:171], v[48:51], a[216:219], v[168:171]
    ds_read_b128 v[32:35], v5 offset:39936
    v_mfma_f32_16x16x32_bf16 v[172:175], v[48:51], a[220:223], v[172:175]
    v_mfma_f32_16x16x32_bf16 v[172:175], v[44:47], a[212:215], v[172:175]
    ds_read_b128 v[36:39], v5 offset:40960
    v_mfma_f32_16x16x32_bf16 v[172:175], v[40:43], a[204:207], v[172:175]
    s_waitcnt lgkmcnt(3)
    v_mfma_f32_16x16x32_bf16 v[172:175], v[16:19], a[196:199], v[172:175]
    ds_read_b128 v[40:43], v5 offset:41984
    v_mfma_f32_16x16x32_bf16 v[172:175], v[20:23], a[228:231], v[172:175]
    v_mfma_f32_16x16x32_bf16 v[172:175], v[24:27], v[108:111], v[172:175]
    ds_read_b128 v[44:47], v5 offset:43008
    s_add_u32 m0, s27, 36864
    v_mfma_f32_16x16x32_bf16 v[168:171], v[24:27], v[104:107], v[168:171]
    s_add_u32 s26, s26, 28672
    v_mfma_f32_16x16x32_bf16 v[168:171], v[20:23], a[224:227], v[168:171]
    ds_read_b128 v[48:51], v5 offset:44032
    s_waitcnt vmcnt(12)
    s_barrier
    v_mfma_f32_16x16x32_bf16 v[168:171], v[16:19], a[192:195], v[168:171]
    s_waitcnt lgkmcnt(3)
    v_mfma_f32_16x16x32_bf16 v[168:171], v[28:31], a[232:235], v[168:171]
    ds_read_b128 v[16:19], v5 offset:45056
    v_mfma_f32_16x16x32_bf16 v[168:171], v[32:35], a[240:243], v[168:171]
    buffer_load_dwordx4 v4, s[12:15], s26 offen offset:0 sc1 lds
    v_mfma_f32_16x16x32_bf16 v[168:171], v[36:39], a[248:251], v[168:171]
    ds_read_b128 v[20:23], v5 offset:46080
    v_mfma_f32_16x16x32_bf16 v[172:175], v[36:39], a[252:255], v[172:175]
    buffer_load_dword v11, v103, s[12:15], s33 offen sc1
    v_mfma_f32_16x16x32_bf16 v[172:175], v[32:35], a[244:247], v[172:175]
    ds_read_b128 v[24:27], v5 offset:47104
    v_mfma_f32_16x16x32_bf16 v[172:175], v[28:31], a[236:239], v[172:175]
    s_waitcnt lgkmcnt(3)
    v_mfma_f32_16x16x32_bf16 v[172:175], v[40:43], v[116:119], v[172:175]
    ds_read_b128 v[28:31], v5 offset:48128
    v_mfma_f32_16x16x32_bf16 v[172:175], v[44:47], v[124:127], v[172:175]
    buffer_load_dwordx4 v4, s[12:15], s26 offen offset:1024 sc1 lds
    v_mfma_f32_16x16x32_bf16 v[172:175], v[48:51], v[132:135], v[172:175]
    ds_read_b128 v[32:35], v5 offset:49152
    v_mfma_f32_16x16x32_bf16 v[168:171], v[48:51], v[128:131], v[168:171]
    v_mfma_f32_16x16x32_bf16 v[168:171], v[44:47], v[120:123], v[168:171]
    ds_read_b128 v[36:39], v5 offset:50176
    v_mfma_f32_16x16x32_bf16 v[168:171], v[40:43], v[112:115], v[168:171]
    s_waitcnt lgkmcnt(3)
    v_mfma_f32_16x16x32_bf16 v[176:179], v[16:19], a[0:3], 0
    ds_read_b128 v[40:43], v5 offset:51200
    v_mfma_f32_16x16x32_bf16 v[176:179], v[20:23], a[32:35], v[176:179]
    buffer_load_dwordx4 v4, s[12:15], s26 offen offset:2048 sc1 lds
    v_mfma_f32_16x16x32_bf16 v[176:179], v[24:27], a[64:67], v[176:179]
    ds_read_b128 v[44:47], v5 offset:52224
    v_mfma_f32_16x16x32_bf16 v[180:183], v[24:27], a[68:71], 0
    v_mul_f32 v168, v9, v168
    v_mul_f32 v169, v9, v169
    v_mfma_f32_16x16x32_bf16 v[180:183], v[20:23], a[36:39], v[180:183]
    ds_read_b128 v[48:51], v5 offset:53248
    v_mul_f32 v170, v9, v170
    v_mfma_f32_16x16x32_bf16 v[180:183], v[16:19], a[4:7], v[180:183]
    s_waitcnt lgkmcnt(3)
    v_mul_f32 v171, v9, v171
    v_cvt_pk_bf16_f32 v218, v168, v169
    v_mfma_f32_16x16x32_bf16 v[180:183], v[28:31], a[100:103], v[180:183]
    ds_read_b128 v[16:19], v5 offset:54272
    v_cvt_pk_bf16_f32 v219, v170, v171
    v_mfma_f32_16x16x32_bf16 v[180:183], v[32:35], a[132:135], v[180:183]
    buffer_load_dwordx4 v4, s[12:15], s26 offen offset:3072 sc1 lds
    v_mfma_f32_16x16x32_bf16 v[180:183], v[36:39], a[164:167], v[180:183]
    ds_read_b128 v[20:23], v5 offset:55296
    buffer_store_dwordx4 v[216:219], v4, s[12:15], s36 offen offset:0 sc1
    v_mfma_f32_16x16x32_bf16 v[176:179], v[36:39], a[160:163], v[176:179]
    s_add_u32 m0, s27, 40960
    v_mul_f32 v172, v10, v172
    v_mul_f32 v173, v10, v173
    v_mfma_f32_16x16x32_bf16 v[176:179], v[32:35], a[128:131], v[176:179]
    ds_read_b128 v[24:27], v5 offset:56320
    s_add_u32 s26, s26, 4096
    v_mfma_f32_16x16x32_bf16 v[176:179], v[28:31], a[96:99], v[176:179]
    s_waitcnt lgkmcnt(3)
    v_mul_f32 v174, v10, v174
    v_mul_f32 v175, v10, v175
    v_mfma_f32_16x16x32_bf16 v[176:179], v[40:43], a[8:11], v[176:179]
    ds_read_b128 v[28:31], v5 offset:57344
    v_cvt_pk_bf16_f32 v222, v172, v173
    v_mfma_f32_16x16x32_bf16 v[176:179], v[44:47], a[16:19], v[176:179]
    buffer_load_dwordx4 v4, s[12:15], s26 offen offset:0 sc1 lds
    v_mfma_f32_16x16x32_bf16 v[176:179], v[48:51], a[24:27], v[176:179]
    ds_read_b128 v[32:35], v5 offset:58368
    v_cvt_pk_bf16_f32 v223, v174, v175
    v_mfma_f32_16x16x32_bf16 v[180:183], v[48:51], a[28:31], v[180:183]
    buffer_store_dwordx4 v[220:223], v4, s[12:15], s36 offen offset:1024 sc1
    v_mfma_f32_16x16x32_bf16 v[180:183], v[44:47], a[20:23], v[180:183]
    ds_read_b128 v[36:39], v5 offset:59392
    v_mfma_f32_16x16x32_bf16 v[180:183], v[40:43], a[12:15], v[180:183]
    s_waitcnt lgkmcnt(3)
    v_mfma_f32_16x16x32_bf16 v[180:183], v[16:19], a[44:47], v[180:183]
    ds_read_b128 v[40:43], v5 offset:60416
    v_mfma_f32_16x16x32_bf16 v[180:183], v[20:23], a[52:55], v[180:183]
    buffer_load_dwordx4 v4, s[12:15], s26 offen offset:1024 sc1 lds
    v_mfma_f32_16x16x32_bf16 v[180:183], v[24:27], a[60:63], v[180:183]
    ds_read_b128 v[44:47], v5 offset:61440
    v_mfma_f32_16x16x32_bf16 v[176:179], v[24:27], a[56:59], v[176:179]
    v_mfma_f32_16x16x32_bf16 v[176:179], v[20:23], a[48:51], v[176:179]
    ds_read_b128 v[48:51], v5 offset:62464
    v_mfma_f32_16x16x32_bf16 v[176:179], v[16:19], a[40:43], v[176:179]
    s_waitcnt lgkmcnt(3)
    v_mfma_f32_16x16x32_bf16 v[176:179], v[28:31], a[72:75], v[176:179]
    ds_read_b128 v[16:19], v5 offset:63488
    v_mfma_f32_16x16x32_bf16 v[176:179], v[32:35], a[80:83], v[176:179]
    buffer_load_dwordx4 v4, s[12:15], s26 offen offset:2048 sc1 lds
    v_mfma_f32_16x16x32_bf16 v[176:179], v[36:39], a[88:91], v[176:179]
    ds_read_b128 v[20:23], v5 offset:64512
    v_mfma_f32_16x16x32_bf16 v[180:183], v[36:39], a[92:95], v[180:183]
    v_mfma_f32_16x16x32_bf16 v[180:183], v[32:35], a[84:87], v[180:183]
    ds_read_b128 v[24:27], v6 offset:0
    v_mfma_f32_16x16x32_bf16 v[180:183], v[28:31], a[76:79], v[180:183]
    s_waitcnt lgkmcnt(3)
    v_mfma_f32_16x16x32_bf16 v[180:183], v[40:43], a[108:111], v[180:183]
    ds_read_b128 v[28:31], v6 offset:1024
    v_mfma_f32_16x16x32_bf16 v[180:183], v[44:47], a[116:119], v[180:183]
    buffer_load_dwordx4 v4, s[12:15], s26 offen offset:3072 sc1 lds
    v_mfma_f32_16x16x32_bf16 v[180:183], v[48:51], a[124:127], v[180:183]
    ds_read_b128 v[32:35], v6 offset:2048
    s_add_u32 m0, s27, 45056
    v_mfma_f32_16x16x32_bf16 v[176:179], v[48:51], a[120:123], v[176:179]
    s_add_u32 s26, s26, 4096
    v_mfma_f32_16x16x32_bf16 v[176:179], v[44:47], a[112:115], v[176:179]
    ds_read_b128 v[36:39], v6 offset:3072
    v_mfma_f32_16x16x32_bf16 v[176:179], v[40:43], a[104:107], v[176:179]
    s_waitcnt lgkmcnt(3)
    v_mfma_f32_16x16x32_bf16 v[176:179], v[16:19], a[136:139], v[176:179]
    ds_read_b128 v[40:43], v6 offset:4096
    v_mfma_f32_16x16x32_bf16 v[176:179], v[20:23], a[144:147], v[176:179]
    buffer_load_dwordx4 v4, s[12:15], s26 offen offset:0 sc1 lds
    v_mfma_f32_16x16x32_bf16 v[176:179], v[24:27], a[152:155], v[176:179]
    ds_read_b128 v[44:47], v6 offset:5120
    v_mfma_f32_16x16x32_bf16 v[180:183], v[24:27], a[156:159], v[180:183]
    v_mfma_f32_16x16x32_bf16 v[180:183], v[20:23], a[148:151], v[180:183]
    ds_read_b128 v[48:51], v6 offset:6144
    v_mfma_f32_16x16x32_bf16 v[180:183], v[16:19], a[140:143], v[180:183]
    s_waitcnt lgkmcnt(3)
    v_mfma_f32_16x16x32_bf16 v[180:183], v[28:31], a[172:175], v[180:183]
    ds_read_b128 v[16:19], v6 offset:7168
    v_mfma_f32_16x16x32_bf16 v[180:183], v[32:35], a[180:183], v[180:183]
    s_getpc_b64 s[52:53]
pc_52:
    s_lshl_b32 s54, s22, 2
    s_add_u32 s54, s54, s23
    s_lshl_b32 s54, s54, 10
    v_lshrrev_b32 v93, 3, v0
    v_lshl_add_u32 v93, v93, 7, s54
    v_add_u32 v93, pc_52+1024-pc_52, v93
    v_min_u32 v93, code_end-pc_52-4, v93
    global_load_dword v93, v93, s[52:53]
    v_mfma_f32_16x16x32_bf16 v[180:183], v[36:39], a[188:191], v[180:183]
    ds_read_b128 v[20:23], v6 offset:8192
    v_mfma_f32_16x16x32_bf16 v[176:179], v[36:39], a[184:187], v[176:179]
    v_mfma_f32_16x16x32_bf16 v[176:179], v[32:35], a[176:179], v[176:179]
    ds_read_b128 v[24:27], v6 offset:9216
    v_mfma_f32_16x16x32_bf16 v[176:179], v[28:31], a[168:171], v[176:179]
    s_waitcnt lgkmcnt(3)
    v_mfma_f32_16x16x32_bf16 v[176:179], v[40:43], a[200:203], v[176:179]
    ds_read_b128 v[28:31], v6 offset:10240
    v_mfma_f32_16x16x32_bf16 v[176:179], v[44:47], a[208:211], v[176:179]
    v_mfma_f32_16x16x32_bf16 v[176:179], v[48:51], a[216:219], v[176:179]
    ds_read_b128 v[32:35], v6 offset:11264
    v_mfma_f32_16x16x32_bf16 v[180:183], v[48:51], a[220:223], v[180:183]
    v_mfma_f32_16x16x32_bf16 v[180:183], v[44:47], a[212:215], v[180:183]
    ds_read_b128 v[36:39], v6 offset:12288
    v_mfma_f32_16x16x32_bf16 v[180:183], v[40:43], a[204:207], v[180:183]
    s_waitcnt lgkmcnt(3)
    v_mfma_f32_16x16x32_bf16 v[180:183], v[16:19], a[196:199], v[180:183]
    ds_read_b128 v[40:43], v6 offset:13312
    v_mfma_f32_16x16x32_bf16 v[180:183], v[20:23], a[228:231], v[180:183]
    v_mfma_f32_16x16x32_bf16 v[180:183], v[24:27], v[108:111], v[180:183]
    ds_read_b128 v[44:47], v6 offset:14336
    s_add_u32 m0, s27, 73728
    v_mfma_f32_16x16x32_bf16 v[176:179], v[24:27], v[104:107], v[176:179]
    s_add_u32 s26, s26, 28672
    v_mfma_f32_16x16x32_bf16 v[176:179], v[20:23], a[224:227], v[176:179]
    ds_read_b128 v[48:51], v6 offset:15360
    s_waitcnt vmcnt(13)
    s_barrier
    v_mfma_f32_16x16x32_bf16 v[176:179], v[16:19], a[192:195], v[176:179]
    s_waitcnt lgkmcnt(3)
    v_lshrrev_b32 v87, 2, v0
    v_add_u32 v84, s25, v87
    v_mfma_f32_16x16x32_bf16 v[176:179], v[28:31], a[232:235], v[176:179]
    ds_read_b128 v[16:19], v4 offset:0
    v_lshlrev_b32 v84, 6, v84
    v_mfma_f32_16x16x32_bf16 v[176:179], v[32:35], a[240:243], v[176:179]
    buffer_load_dwordx4 v4, s[12:15], s26 offen offset:0 sc1 lds
    v_mfma_f32_16x16x32_bf16 v[176:179], v[36:39], a[248:251], v[176:179]
    ds_read_b128 v[20:23], v4 offset:1024
    v_add_u32 v84, s24, v84
    v_mfma_f32_16x16x32_bf16 v[180:183], v[36:39], a[252:255], v[180:183]
    v_cmp_eq_u32 s[56:57], 0, v84
    v_sub_u32 v85, 0x800, v84
    v_mfma_f32_16x16x32_bf16 v[180:183], v[32:35], a[244:247], v[180:183]
    ds_read_b128 v[24:27], v4 offset:2048
    v_mov_b32 v86, 0x400
    v_mfma_f32_16x16x32_bf16 v[180:183], v[28:31], a[236:239], v[180:183]
    s_waitcnt lgkmcnt(3)
    v_cndmask_b32 v85, v85, v86, s[56:57]
    v_mul_u32_u24 v84, 1152, v84
    v_mfma_f32_16x16x32_bf16 v[180:183], v[40:43], v[116:119], v[180:183]
    ds_read_b128 v[28:31], v4 offset:3072
    v_mul_u32_u24 v85, 1152, v85
    v_mfma_f32_16x16x32_bf16 v[180:183], v[44:47], v[124:127], v[180:183]
    buffer_load_dwordx4 v4, s[12:15], s26 offen offset:1024 sc1 lds
    v_mfma_f32_16x16x32_bf16 v[180:183], v[48:51], v[132:135], v[180:183]
    ds_read_b128 v[32:35], v4 offset:4096
    v_mov_b32 v15, 2
    v_mfma_f32_16x16x32_bf16 v[176:179], v[48:51], v[128:131], v[176:179]
    s_waitcnt vmcnt(7)
    v_sub_u32 v91, v1, v4
    v_lshl_add_u32 v91, v3, 6, v91
    v_mfma_f32_16x16x32_bf16 v[176:179], v[44:47], v[120:123], v[176:179]
    ds_read_b128 v[36:39], v4 offset:5120
    v_lshl_add_u32 v91, v2, 4, v91
    v_mfma_f32_16x16x32_bf16 v[176:179], v[40:43], v[112:115], v[176:179]
    s_waitcnt lgkmcnt(3)
    v_and_b32 v92, 3, v0
    v_sub_u32 v250, v1, v4
    v_mfma_f32_16x16x32_bf16 v[184:187], v[16:19], a[0:3], 0
    ds_read_b128 v[40:43], v4 offset:6144
    v_sub_u32 v244, 3, v2
    v_mfma_f32_16x16x32_bf16 v[184:187], v[20:23], a[32:35], v[184:187]
    buffer_load_dwordx4 v4, s[12:15], s26 offen offset:2048 sc1 lds
    v_mfma_f32_16x16x32_bf16 v[184:187], v[24:27], a[64:67], v[184:187]
    ds_read_b128 v[44:47], v4 offset:7168
    v_lshl_add_u32 v244, v244, 4, v250
    v_mfma_f32_16x16x32_bf16 v[188:191], v[24:27], a[68:71], 0
    buffer_store_dword v15, v13, s[12:15], s33 offen sc1
    v_mfma_f32_16x16x32_bf16 v[188:191], v[20:23], a[36:39], v[188:191]
    ds_read_b128 v[48:51], v4 offset:8192
    v_mul_f32 v176, v9, v176
    v_mfma_f32_16x16x32_bf16 v[188:191], v[16:19], a[4:7], v[188:191]
    s_waitcnt lgkmcnt(3)
    v_mul_f32 v177, v9, v177
    v_mul_f32 v178, v9, v178
    v_mfma_f32_16x16x32_bf16 v[188:191], v[28:31], a[100:103], v[188:191]
    ds_read_b128 v[16:19], v4 offset:9216
    v_mul_f32 v179, v9, v179
    v_mfma_f32_16x16x32_bf16 v[188:191], v[32:35], a[132:135], v[188:191]
    buffer_load_dwordx4 v4, s[12:15], s26 offen offset:3072 sc1 lds
    v_mfma_f32_16x16x32_bf16 v[188:191], v[36:39], a[164:167], v[188:191]
    ds_read_b128 v[20:23], v4 offset:10240
    v_cvt_pk_bf16_f32 v208, v176, v177
    v_mfma_f32_16x16x32_bf16 v[184:187], v[36:39], a[160:163], v[184:187]
    s_add_u32 m0, s27, 77824
    v_cvt_pk_bf16_f32 v209, v178, v179
    v_mul_f32 v180, v10, v180
    v_mfma_f32_16x16x32_bf16 v[184:187], v[32:35], a[128:131], v[184:187]
    ds_read_b128 v[24:27], v4 offset:11264
    s_add_u32 s26, s26, 4096
    v_mfma_f32_16x16x32_bf16 v[184:187], v[28:31], a[96:99], v[184:187]
    s_waitcnt lgkmcnt(3)
    v_mul_f32 v181, v10, v181
    v_mul_f32 v182, v10, v182
    v_mfma_f32_16x16x32_bf16 v[184:187], v[40:43], a[8:11], v[184:187]
    ds_read_b128 v[28:31], v4 offset:12288
    v_mul_f32 v183, v10, v183
    v_mfma_f32_16x16x32_bf16 v[184:187], v[44:47], a[16:19], v[184:187]
    buffer_load_dwordx4 v4, s[12:15], s26 offen offset:0 sc1 lds
    v_mfma_f32_16x16x32_bf16 v[184:187], v[48:51], a[24:27], v[184:187]
    ds_read_b128 v[32:35], v4 offset:13312
    v_cvt_pk_bf16_f32 v212, v180, v181
    v_mfma_f32_16x16x32_bf16 v[188:191], v[48:51], a[28:31], v[188:191]
    s_movk_i32 s52, 80
    v_cvt_pk_bf16_f32 v213, v182, v183
    v_mad_u32_u24 v244, v3, s52, v244
    v_mfma_f32_16x16x32_bf16 v[188:191], v[44:47], a[20:23], v[188:191]
    ds_read_b128 v[36:39], v4 offset:14336
    v_lshl_add_u32 v245, v92, 4, v250
    v_mfma_f32_16x16x32_bf16 v[188:191], v[40:43], a[12:15], v[188:191]
    s_waitcnt lgkmcnt(3)
    v_mad_u32_u24 v245, v87, s52, v245
    v_sub_u32 v246, 4, v2
    v_mfma_f32_16x16x32_bf16 v[188:191], v[16:19], a[44:47], v[188:191]
    ds_read_b128 v[40:43], v4 offset:15360
    v_and_b32 v246, 3, v246
    v_mfma_f32_16x16x32_bf16 v[188:191], v[20:23], a[52:55], v[188:191]
    buffer_load_dwordx4 v4, s[12:15], s26 offen offset:1024 sc1 lds
    v_mfma_f32_16x16x32_bf16 v[188:191], v[24:27], a[60:63], v[188:191]
    ds_read_b128 v[44:47], v4 offset:16384
    v_lshl_add_u32 v246, v246, 4, v250
    v_mfma_f32_16x16x32_bf16 v[184:187], v[24:27], a[56:59], v[184:187]
    v_mad_u32_u24 v246, v3, s52, v246
    s_lshr_b32 s52, s22, 1
    v_mfma_f32_16x16x32_bf16 v[184:187], v[20:23], a[48:51], v[184:187]
    ds_read_b128 v[48:51], v4 offset:17408
    s_mul_i32 s53, s52, 3
    v_mfma_f32_16x16x32_bf16 v[184:187], v[16:19], a[40:43], v[184:187]
    s_waitcnt lgkmcnt(3)
    v_xor_b32 v247, s53, v92
    v_mov_b32 v252, 0
    v_mfma_f32_16x16x32_bf16 v[184:187], v[28:31], a[72:75], v[184:187]
    ds_read_b128 v[16:19], v4 offset:18432
    v_mov_b32 v253, 0
    v_mfma_f32_16x16x32_bf16 v[184:187], v[32:35], a[80:83], v[184:187]
    buffer_load_dwordx4 v4, s[12:15], s26 offen offset:2048 sc1 lds
    v_mfma_f32_16x16x32_bf16 v[184:187], v[36:39], a[88:91], v[184:187]
    ds_read_b128 v[20:23], v4 offset:19456
    v_mov_b32 v254, 0
    v_mfma_f32_16x16x32_bf16 v[188:191], v[36:39], a[92:95], v[188:191]
    v_mov_b32 v255, 0
    s_lshl_b32 s52, s20, 2
    v_mfma_f32_16x16x32_bf16 v[188:191], v[32:35], a[84:87], v[188:191]
    ds_read_b128 v[24:27], v4 offset:20480
    s_add_u32 s52, s52, s23
    v_mfma_f32_16x16x32_bf16 v[188:191], v[28:31], a[76:79], v[188:191]
    s_waitcnt lgkmcnt(3)
    s_lshl_b32 s52, s52, 2
    s_add_u32 s52, s52, s21
    v_mfma_f32_16x16x32_bf16 v[188:191], v[40:43], a[108:111], v[188:191]
    ds_read_b128 v[28:31], v4 offset:21504
    s_lshl_b32 s52, s52, 2
    v_mfma_f32_16x16x32_bf16 v[188:191], v[44:47], a[116:119], v[188:191]
    buffer_load_dwordx4 v4, s[12:15], s26 offen offset:3072 sc1 lds
    v_mfma_f32_16x16x32_bf16 v[188:191], v[48:51], a[124:127], v[188:191]
    ds_read_b128 v[32:35], v4 offset:22528
    s_add_u32 m0, s27, 81920
    v_mfma_f32_16x16x32_bf16 v[184:187], v[48:51], a[120:123], v[184:187]
    v_cmp_gt_u32 vcc, 1, v11
    s_cbranch_vccnz late_32
late_32_ok:
    v_mfma_f32_16x16x32_bf16 v[184:187], v[44:47], a[112:115], v[184:187]
    ds_read_b128 v[36:39], v4 offset:23552
    s_add_u32 s26, s26, 4096
    v_mfma_f32_16x16x32_bf16 v[184:187], v[40:43], a[104:107], v[184:187]
    s_waitcnt lgkmcnt(3)
    s_add_u32 s52, s52, s22
    s_lshl_b32 s52, s52, 8
    v_mfma_f32_16x16x32_bf16 v[184:187], v[16:19], a[136:139], v[184:187]
    ds_read_b128 v[40:43], v4 offset:24576
    s_add_u32 s52, s52, 20971520
    v_mfma_f32_16x16x32_bf16 v[184:187], v[20:23], a[144:147], v[184:187]
    buffer_load_dwordx4 v4, s[12:15], s26 offen offset:0 sc1 lds
    v_mfma_f32_16x16x32_bf16 v[184:187], v[24:27], a[152:155], v[184:187]
    ds_read_b128 v[44:47], v4 offset:25600
    v_lshl_add_u32 v248, v0, 2, s52
    v_mfma_f32_16x16x32_bf16 v[188:191], v[24:27], a[156:159], v[188:191]
    s_lshr_b32 s52, s22, 1
    s_and_b32 s53, s22, 1
    s_lshl_b32 s43, s3, s52
    v_mfma_f32_16x16x32_bf16 v[188:191], v[20:23], a[148:151], v[188:191]
    ds_read_b128 v[48:51], v4 offset:26624
    s_sub_u32 s41, 26, s34
    v_mfma_f32_16x16x32_bf16 v[188:191], v[16:19], a[140:143], v[188:191]
    s_waitcnt lgkmcnt(3)
    s_lshl_b32 s54, s53, 3
    s_sub_u32 s44, 840, s54
    v_mfma_f32_16x16x32_bf16 v[188:191], v[28:31], a[172:175], v[188:191]
    ds_read_b128 v[16:19], v4 offset:27648
    s_add_u32 s54, s54, 256
    v_mfma_f32_16x16x32_bf16 v[188:191], v[32:35], a[180:183], v[188:191]
    s_cmp_eq_u32 s52, 0
    s_cselect_b32 s41, s34, s41
    s_cselect_b32 s44, s54, s44
    v_mfma_f32_16x16x32_bf16 v[188:191], v[36:39], a[188:191], v[188:191]
    ds_read_b128 v[20:23], v4 offset:28672
    s_lshl_b32 s41, s41, 6
    v_mfma_f32_16x16x32_bf16 v[184:187], v[36:39], a[184:187], v[184:187]
    s_mul_i32 s52, s52, 18432
    s_lshl_b32 s53, s53, 10
    s_add_u32 s52, s52, s53
    v_mfma_f32_16x16x32_bf16 v[184:187], v[32:35], a[176:179], v[184:187]
    ds_read_b128 v[24:27], v4 offset:29696
    s_add_u32 s52, s52, 8192
    v_mfma_f32_16x16x32_bf16 v[184:187], v[28:31], a[168:171], v[184:187]
    s_waitcnt lgkmcnt(3)
    s_add_u32 s52, s52, s46
    s_lshl_b32 s53, s34, 11
    v_mfma_f32_16x16x32_bf16 v[184:187], v[40:43], a[200:203], v[184:187]
    ds_read_b128 v[28:31], v4 offset:30720
    s_add_u32 s53, s53, s46
    v_mfma_f32_16x16x32_bf16 v[184:187], v[44:47], a[208:211], v[184:187]
    s_cmp_eq_u32 s43, 0
    s_cselect_b32 s41, s53, s41
    s_cselect_b32 s44, s52, s44
    v_mfma_f32_16x16x32_bf16 v[184:187], v[48:51], a[216:219], v[184:187]
    ds_read_b128 v[32:35], v4 offset:31744
    v_mfma_f32_16x16x32_bf16 v[188:191], v[48:51], a[220:223], v[188:191]
    v_mfma_f32_16x16x32_bf16 v[188:191], v[44:47], a[212:215], v[188:191]
    ds_read_b128 v[36:39], v4 offset:32768
    v_mfma_f32_16x16x32_bf16 v[188:191], v[40:43], a[204:207], v[188:191]
    s_waitcnt lgkmcnt(3)
    v_mfma_f32_16x16x32_bf16 v[188:191], v[16:19], a[196:199], v[188:191]
    ds_read_b128 v[40:43], v4 offset:33792
    v_mfma_f32_16x16x32_bf16 v[188:191], v[20:23], a[228:231], v[188:191]
    v_mfma_f32_16x16x32_bf16 v[188:191], v[24:27], v[108:111], v[188:191]
    ds_read_b128 v[44:47], v4 offset:34816
    v_mfma_f32_16x16x32_bf16 v[184:187], v[24:27], v[104:107], v[184:187]
    v_mfma_f32_16x16x32_bf16 v[184:187], v[20:23], a[224:227], v[184:187]
    ds_read_b128 v[48:51], v4 offset:35840
    s_waitcnt vmcnt(11)
    s_barrier
    v_mfma_f32_16x16x32_bf16 v[184:187], v[16:19], a[192:195], v[184:187]
    s_waitcnt lgkmcnt(3)
    v_mfma_f32_16x16x32_bf16 v[184:187], v[28:31], a[232:235], v[184:187]
    ds_read_b128 v[16:19], v4 offset:36864
    v_mfma_f32_16x16x32_bf16 v[184:187], v[32:35], a[240:243], v[184:187]
    v_mfma_f32_16x16x32_bf16 v[184:187], v[36:39], a[248:251], v[184:187]
    ds_read_b128 v[20:23], v4 offset:37888
    v_mfma_f32_16x16x32_bf16 v[188:191], v[36:39], a[252:255], v[188:191]
    ds_read_b128 v[76:79], v1 offset:0
    v_mfma_f32_16x16x32_bf16 v[188:191], v[32:35], a[244:247], v[188:191]
    ds_read_b128 v[24:27], v4 offset:38912
    v_mfma_f32_16x16x32_bf16 v[188:191], v[28:31], a[236:239], v[188:191]
    s_waitcnt lgkmcnt(4)
    v_mfma_f32_16x16x32_bf16 v[188:191], v[40:43], v[116:119], v[188:191]
    ds_read_b128 v[28:31], v4 offset:39936
    v_mfma_f32_16x16x32_bf16 v[188:191], v[44:47], v[124:127], v[188:191]
    ds_read_b128 v[80:83], v1 offset:1024
    v_mfma_f32_16x16x32_bf16 v[188:191], v[48:51], v[132:135], v[188:191]
    ds_read_b128 v[32:35], v4 offset:40960
    v_mfma_f32_16x16x32_bf16 v[184:187], v[48:51], v[128:131], v[184:187]
    ds_read_b128 v[156:159], v1 offset:2048
    v_mfma_f32_16x16x32_bf16 v[184:187], v[44:47], v[120:123], v[184:187]
    ds_read_b128 v[36:39], v4 offset:41984
    v_mfma_f32_16x16x32_bf16 v[184:187], v[40:43], v[112:115], v[184:187]
    s_waitcnt lgkmcnt(5)
    v_mfma_f32_16x16x32_bf16 v[192:195], v[16:19], a[0:3], 0
    ds_read_b128 v[40:43], v4 offset:43008
    v_mfma_f32_16x16x32_bf16 v[192:195], v[20:23], a[32:35], v[192:195]
    v_mfma_f32_16x16x32_bf16 v[192:195], v[24:27], a[64:67], v[192:195]
    ds_read_b128 v[44:47], v4 offset:44032
    v_mfma_f32_16x16x32_bf16 v[196:199], v[24:27], a[68:71], 0
    s_nop 0
    v_mul_f32 v184, v9, v184
    v_mul_f32 v185, v9, v185
    v_mfma_f32_16x16x32_bf16 v[196:199], v[20:23], a[36:39], v[196:199]
    ds_read_b128 v[48:51], v4 offset:45056
    v_mul_f32 v186, v9, v186
    v_mfma_f32_16x16x32_bf16 v[196:199], v[16:19], a[4:7], v[196:199]
    s_waitcnt lgkmcnt(3)
    v_mul_f32 v187, v9, v187
    v_cvt_pk_bf16_f32 v210, v184, v185
    v_mfma_f32_16x16x32_bf16 v[196:199], v[28:31], a[100:103], v[196:199]
    ds_read_b128 v[16:19], v4 offset:46080
    v_cvt_pk_bf16_f32 v211, v186, v187
    v_mfma_f32_16x16x32_bf16 v[196:199], v[32:35], a[132:135], v[196:199]
    v_mfma_f32_16x16x32_bf16 v[196:199], v[36:39], a[164:167], v[196:199]
    ds_read_b128 v[20:23], v4 offset:47104
    buffer_store_dwordx4 v[208:211], v4, s[12:15], s37 offen offset:0 sc1
    v_mfma_f32_16x16x32_bf16 v[192:195], v[36:39], a[160:163], v[192:195]
    buffer_load_dword v11, v103, s[12:15], s33 offen sc1
    v_mfma_f32_16x16x32_bf16 v[192:195], v[32:35], a[128:131], v[192:195]
    ds_read_b128 v[24:27], v4 offset:48128
    v_mul_f32 v188, v10, v188
    v_mfma_f32_16x16x32_bf16 v[192:195], v[28:31], a[96:99], v[192:195]
    s_waitcnt lgkmcnt(3)
    v_mul_f32 v189, v10, v189
    v_mul_f32 v190, v10, v190
    v_mfma_f32_16x16x32_bf16 v[192:195], v[40:43], a[8:11], v[192:195]
    ds_read_b128 v[28:31], v4 offset:49152
    v_mul_f32 v191, v10, v191
    v_mfma_f32_16x16x32_bf16 v[192:195], v[44:47], a[16:19], v[192:195]
    v_cvt_pk_bf16_f32 v214, v188, v189
    v_cvt_pk_bf16_f32 v215, v190, v191
    v_mfma_f32_16x16x32_bf16 v[192:195], v[48:51], a[24:27], v[192:195]
    ds_read_b128 v[32:35], v4 offset:50176
    v_mfma_f32_16x16x32_bf16 v[196:199], v[48:51], a[28:31], v[196:199]
    buffer_store_dwordx4 v[212:215], v4, s[12:15], s37 offen offset:1024 sc1
    v_mfma_f32_16x16x32_bf16 v[196:199], v[44:47], a[20:23], v[196:199]
    ds_read_b128 v[36:39], v4 offset:51200
    v_mfma_f32_16x16x32_bf16 v[196:199], v[40:43], a[12:15], v[196:199]
    s_waitcnt lgkmcnt(3)
    v_mfma_f32_16x16x32_bf16 v[196:199], v[16:19], a[44:47], v[196:199]
    ds_read_b128 v[40:43], v4 offset:52224
    v_mfma_f32_16x16x32_bf16 v[196:199], v[20:23], a[52:55], v[196:199]
    v_mfma_f32_16x16x32_bf16 v[196:199], v[24:27], a[60:63], v[196:199]
    ds_read_b128 v[44:47], v4 offset:53248
    v_lshlrev_b32 v228, 16, v76
    v_mfma_f32_16x16x32_bf16 v[192:195], v[24:27], a[56:59], v[192:195]
    v_add_f32 v228, v228, v94
    v_and_b32 v229, 0xffff0000, v76
    v_mfma_f32_16x16x32_bf16 v[192:195], v[20:23], a[48:51], v[192:195]
    ds_read_b128 v[48:51], v4 offset:54272
    v_add_f32 v229, v229, v94
    v_mfma_f32_16x16x32_bf16 v[192:195], v[16:19], a[40:43], v[192:195]
    s_waitcnt lgkmcnt(3)
    v_lshlrev_b32 v230, 16, v77
    v_add_f32 v230, v230, v94
    v_mfma_f32_16x16x32_bf16 v[192:195], v[28:31], a[72:75], v[192:195]
    ds_read_b128 v[16:19], v4 offset:55296
    v_and_b32 v231, 0xffff0000, v77
    v_mfma_f32_16x16x32_bf16 v[192:195], v[32:35], a[80:83], v[192:195]
    v_add_f32 v231, v231, v94
    v_lshlrev_b32 v236, 16, v78
    v_mfma_f32_16x16x32_bf16 v[192:195], v[36:39], a[88:91], v[192:195]
    ds_read_b128 v[20:23], v4 offset:56320
    v_add_f32 v236, v236, v94
    v_mfma_f32_16x16x32_bf16 v[196:199], v[36:39], a[92:95], v[196:199]
hop_9:
    s_cbranch_execz back_9
    v_and_b32 v237, 0xffff0000, v78
    v_add_f32 v237, v237, v94
    v_mfma_f32_16x16x32_bf16 v[196:199], v[32:35], a[84:87], v[196:199]
    ds_read_b128 v[24:27], v4 offset:57344
    v_lshlrev_b32 v238, 16, v79
    v_mfma_f32_16x16x32_bf16 v[196:199], v[28:31], a[76:79], v[196:199]
    s_waitcnt lgkmcnt(3)
    v_add_f32 v238, v238, v94
    v_and_b32 v239, 0xffff0000, v79
    v_mfma_f32_16x16x32_bf16 v[196:199], v[40:43], a[108:111], v[196:199]
    ds_read_b128 v[28:31], v4 offset:58368
    v_add_f32 v239, v239, v94
    v_mfma_f32_16x16x32_bf16 v[196:199], v[44:47], a[116:119], v[196:199]
    v_lshlrev_b32 v160, 16, v156
    v_add_f32 v136, v136, v94
    v_mfma_f32_16x16x32_bf16 v[196:199], v[48:51], a[124:127], v[196:199]
    ds_read_b128 v[32:35], v4 offset:59392
    v_add_f32 v136, v136, v160
    v_mfma_f32_16x16x32_bf16 v[192:195], v[48:51], a[120:123], v[192:195]
    v_and_b32 v161, 0xffff0000, v156
    v_add_f32 v137, v137, v94
    v_mfma_f32_16x16x32_bf16 v[192:195], v[44:47], a[112:115], v[192:195]
    ds_read_b128 v[36:39], v4 offset:60416
    v_add_f32 v137, v137, v161
    v_mfma_f32_16x16x32_bf16 v[192:195], v[40:43], a[104:107], v[192:195]
    s_waitcnt lgkmcnt(3)
    v_lshlrev_b32 v162, 16, v157
    v_add_f32 v138, v138, v94
    v_mfma_f32_16x16x32_bf16 v[192:195], v[16:19], a[136:139], v[192:195]
    ds_read_b128 v[40:43], v4 offset:61440
    v_add_f32 v138, v138, v162
    v_mfma_f32_16x16x32_bf16 v[192:195], v[20:23], a[144:147], v[192:195]
    v_and_b32 v163, 0xffff0000, v157
    v_add_f32 v139, v139, v94
    v_mfma_f32_16x16x32_bf16 v[192:195], v[24:27], a[152:155], v[192:195]
    ds_read_b128 v[44:47], v4 offset:62464
    v_add_f32 v139, v139, v163
    v_mfma_f32_16x16x32_bf16 v[196:199], v[24:27], a[156:159], v[196:199]
    v_lshlrev_b32 v232, 16, v80
    v_add_f32 v232, v232, v95
    v_mfma_f32_16x16x32_bf16 v[196:199], v[20:23], a[148:151], v[196:199]
    ds_read_b128 v[48:51], v4 offset:63488
    v_and_b32 v233, 0xffff0000, v80
    v_mfma_f32_16x16x32_bf16 v[196:199], v[16:19], a[140:143], v[196:199]
    s_waitcnt lgkmcnt(3)
    v_add_f32 v233, v233, v95
    v_lshlrev_b32 v234, 16, v81
    v_mfma_f32_16x16x32_bf16 v[196:199], v[28:31], a[172:175], v[196:199]
    ds_read_b128 v[16:19], v4 offset:64512
    v_add_f32 v234, v234, v95
    v_mfma_f32_16x16x32_bf16 v[196:199], v[32:35], a[180:183], v[196:199]
    v_and_b32 v235, 0xffff0000, v81
    v_add_f32 v235, v235, v95
    v_mfma_f32_16x16x32_bf16 v[196:199], v[36:39], a[188:191], v[196:199]
    ds_read_b128 v[20:23], v5 offset:0
    v_lshlrev_b32 v240, 16, v82
    v_mfma_f32_16x16x32_bf16 v[192:195], v[36:39], a[184:187], v[192:195]
    v_add_f32 v240, v240, v95
    v_and_b32 v241, 0xffff0000, v82
    v_mfma_f32_16x16x32_bf16 v[192:195], v[32:35], a[176:179], v[192:195]
    ds_read_b128 v[24:27], v5 offset:1024
    v_add_f32 v241, v241, v95
    v_mfma_f32_16x16x32_bf16 v[192:195], v[28:31], a[168:171], v[192:195]
    s_waitcnt lgkmcnt(3)
    v_lshlrev_b32 v242, 16, v83
    v_add_f32 v242, v242, v95
    v_mfma_f32_16x16x32_bf16 v[192:195], v[40:43], a[200:203], v[192:195]
    ds_read_b128 v[28:31], v5 offset:2048
    v_and_b32 v243, 0xffff0000, v83
    v_mfma_f32_16x16x32_bf16 v[192:195], v[44:47], a[208:211], v[192:195]
    v_add_f32 v243, v243, v95
    v_lshlrev_b32 v160, 16, v158
    v_mfma_f32_16x16x32_bf16 v[192:195], v[48:51], a[216:219], v[192:195]
    ds_read_b128 v[32:35], v5 offset:3072
    v_add_f32 v140, v140, v95
    v_mfma_f32_16x16x32_bf16 v[196:199], v[48:51], a[220:223], v[196:199]
    v_add_f32 v140, v140, v160
    v_and_b32 v161, 0xffff0000, v158
    v_mfma_f32_16x16x32_bf16 v[196:199], v[44:47], a[212:215], v[196:199]
    ds_read_b128 v[36:39], v5 offset:4096
    v_add_f32 v141, v141, v95
    v_mfma_f32_16x16x32_bf16 v[196:199], v[40:43], a[204:207], v[196:199]
    s_waitcnt lgkmcnt(3)
    v_add_f32 v141, v141, v161
    v_lshlrev_b32 v162, 16, v159
    v_mfma_f32_16x16x32_bf16 v[196:199], v[16:19], a[196:199], v[196:199]
    ds_read_b128 v[40:43], v5 offset:5120
    v_add_f32 v142, v142, v95
    v_mfma_f32_16x16x32_bf16 v[196:199], v[20:23], a[228:231], v[196:199]
    v_add_f32 v142, v142, v162
    v_and_b32 v163, 0xffff0000, v159
    v_mfma_f32_16x16x32_bf16 v[196:199], v[24:27], v[108:111], v[196:199]
    ds_read_b128 v[44:47], v5 offset:6144
    v_add_f32 v143, v143, v95
    v_mfma_f32_16x16x32_bf16 v[192:195], v[24:27], v[104:107], v[192:195]
    v_add_f32 v143, v143, v163
    v_mfma_f32_16x16x32_bf16 v[192:195], v[20:23], a[224:227], v[192:195]
    ds_read_b128 v[48:51], v5 offset:7168
    s_waitcnt vmcnt(3)
    s_barrier
    v_mfma_f32_16x16x32_bf16 v[192:195], v[16:19], a[192:195], v[192:195]
    s_waitcnt lgkmcnt(3)
    v_mfma_f32_16x16x32_bf16 v[192:195], v[28:31], a[232:235], v[192:195]
    ds_read_b128 v[16:19], v5 offset:8192
    v_mfma_f32_16x16x32_bf16 v[192:195], v[32:35], a[240:243], v[192:195]
    s_waitcnt vmcnt(1)
    v_cmp_gt_u32 vcc, 2, v11
    s_cbranch_vccnz late_33
late_33_ok:
    v_mfma_f32_16x16x32_bf16 v[192:195], v[36:39], a[248:251], v[192:195]
    ds_read_b128 v[20:23], v5 offset:9216
    v_mov_b32 v15, 3
    v_mfma_f32_16x16x32_bf16 v[196:199], v[36:39], a[252:255], v[196:199]
    s_waitcnt vmcnt(0)
    v_mfma_f32_16x16x32_bf16 v[196:199], v[32:35], a[244:247], v[196:199]
    ds_read_b128 v[24:27], v5 offset:10240
    v_mfma_f32_16x16x32_bf16 v[196:199], v[28:31], a[236:239], v[196:199]
    s_waitcnt lgkmcnt(3)
    v_mfma_f32_16x16x32_bf16 v[196:199], v[40:43], v[116:119], v[196:199]
    ds_read_b128 v[28:31], v5 offset:11264
    v_mfma_f32_16x16x32_bf16 v[196:199], v[44:47], v[124:127], v[196:199]
    buffer_store_dword v15, v13, s[12:15], s33 offen sc1
    buffer_load_dwordx4 v[52:55], v4, s[12:15], s38 offen offset:0 sc1
    v_mfma_f32_16x16x32_bf16 v[196:199], v[48:51], v[132:135], v[196:199]
    ds_read_b128 v[32:35], v5 offset:12288
    v_mfma_f32_16x16x32_bf16 v[192:195], v[48:51], v[128:131], v[192:195]
    buffer_load_dwordx4 v[56:59], v4, s[12:15], s38 offen offset:1024 sc1
    v_mfma_f32_16x16x32_bf16 v[192:195], v[44:47], v[120:123], v[192:195]
    ds_read_b128 v[36:39], v5 offset:13312
    v_mfma_f32_16x16x32_bf16 v[192:195], v[40:43], v[112:115], v[192:195]
    s_waitcnt lgkmcnt(3)
    v_mfma_f32_16x16x32_bf16 v[200:203], v[16:19], a[0:3], 0
    ds_read_b128 v[40:43], v5 offset:14336
    v_mfma_f32_16x16x32_bf16 v[200:203], v[20:23], a[32:35], v[200:203]
    buffer_load_dwordx4 v[60:63], v4, s[12:15], s38 offen offset:2048 sc1
    buffer_load_dwordx4 v[64:67], v4, s[12:15], s38 offen offset:3072 sc1
    v_mfma_f32_16x16x32_bf16 v[200:203], v[24:27], a[64:67], v[200:203]
    ds_read_b128 v[44:47], v5 offset:15360
    v_mfma_f32_16x16x32_bf16 v[204:207], v[24:27], a[68:71], 0
    s_cmp_lg_u32 s21, s23
    s_cbranch_scc1 nosingle_53
    buffer_load_dwordx4 v[144:147], v4, s[12:15], s39 offen offset:0 sc1
    buffer_load_dwordx4 v[148:151], v4, s[12:15], s39 offen offset:1024 sc1
    buffer_load_dwordx4 v[152:155], v4, s[12:15], s39 offen offset:2048 sc1
nosingle_53:
    v_mfma_f32_16x16x32_bf16 v[204:207], v[20:23], a[36:39], v[204:207]
    ds_read_b128 v[48:51], v5 offset:16384
    v_mfma_f32_16x16x32_bf16 v[204:207], v[16:19], a[4:7], v[204:207]
    s_waitcnt lgkmcnt(3)
    v_mfma_f32_16x16x32_bf16 v[204:207], v[28:31], a[100:103], v[204:207]
    ds_read_b128 v[16:19], v5 offset:17408
    v_fma_f32 v192, v9, v192, v228
    v_mfma_f32_16x16x32_bf16 v[204:207], v[32:35], a[132:135], v[204:207]
    v_fma_f32 v193, v9, v193, v229
    v_fma_f32 v194, v9, v194, v230
    v_mfma_f32_16x16x32_bf16 v[204:207], v[36:39], a[164:167], v[204:207]
    ds_read_b128 v[20:23], v5 offset:18432
    v_fma_f32 v195, v9, v195, v231
    v_mfma_f32_16x16x32_bf16 v[200:203], v[36:39], a[160:163], v[200:203]
    v_fma_f32 v196, v10, v196, v232
    v_fma_f32 v197, v10, v197, v233
    v_mfma_f32_16x16x32_bf16 v[200:203], v[32:35], a[128:131], v[200:203]
    ds_read_b128 v[24:27], v5 offset:19456
    v_fma_f32 v198, v10, v198, v234
    v_mfma_f32_16x16x32_bf16 v[200:203], v[28:31], a[96:99], v[200:203]
    s_waitcnt lgkmcnt(3)
    v_fma_f32 v199, v10, v199, v235
    v_mfma_f32_16x16x32_bf16 v[200:203], v[40:43], a[8:11], v[200:203]
    ds_read_b128 v[28:31], v5 offset:20480
    v_mfma_f32_16x16x32_bf16 v[200:203], v[44:47], a[16:19], v[200:203]
    v_mfma_f32_16x16x32_bf16 v[200:203], v[48:51], a[24:27], v[200:203]
    ds_read_b128 v[32:35], v5 offset:21504
    v_mfma_f32_16x16x32_bf16 v[204:207], v[48:51], a[28:31], v[204:207]
    v_mfma_f32_16x16x32_bf16 v[204:207], v[44:47], a[20:23], v[204:207]
    ds_read_b128 v[36:39], v5 offset:22528
    v_mfma_f32_16x16x32_bf16 v[204:207], v[40:43], a[12:15], v[204:207]
    s_waitcnt lgkmcnt(3)
    v_mfma_f32_16x16x32_bf16 v[204:207], v[16:19], a[44:47], v[204:207]
    ds_read_b128 v[40:43], v5 offset:23552
    v_mfma_f32_16x16x32_bf16 v[204:207], v[20:23], a[52:55], v[204:207]
    buffer_load_dwordx4 v[68:71], v4, s[12:15], s45 offen offset:0 sc1
    v_mfma_f32_16x16x32_bf16 v[204:207], v[24:27], a[60:63], v[204:207]
    ds_read_b128 v[44:47], v5 offset:24576
    v_mfma_f32_16x16x32_bf16 v[200:203], v[24:27], a[56:59], v[200:203]
    buffer_load_dwordx4 v[72:75], v4, s[12:15], s45 offen offset:1024 sc1
    v_mfma_f32_16x16x32_bf16 v[200:203], v[20:23], a[48:51], v[200:203]
    ds_read_b128 v[48:51], v5 offset:25600
    v_mfma_f32_16x16x32_bf16 v[200:203], v[16:19], a[40:43], v[200:203]
    s_waitcnt lgkmcnt(3)
    v_mfma_f32_16x16x32_bf16 v[200:203], v[28:31], a[72:75], v[200:203]
    ds_read_b128 v[16:19], v5 offset:26624
    v_mfma_f32_16x16x32_bf16 v[200:203], v[32:35], a[80:83], v[200:203]
    v_mfma_f32_16x16x32_bf16 v[200:203], v[36:39], a[88:91], v[200:203]
    ds_read_b128 v[20:23], v5 offset:27648
    v_mfma_f32_16x16x32_bf16 v[204:207], v[36:39], a[92:95], v[204:207]
    v_mfma_f32_16x16x32_bf16 v[204:207], v[32:35], a[84:87], v[204:207]
    ds_read_b128 v[24:27], v5 offset:28672
    v_mfma_f32_16x16x32_bf16 v[204:207], v[28:31], a[76:79], v[204:207]
    s_waitcnt lgkmcnt(3)
    v_mfma_f32_16x16x32_bf16 v[204:207], v[40:43], a[108:111], v[204:207]
    ds_read_b128 v[28:31], v5 offset:29696
    v_mfma_f32_16x16x32_bf16 v[204:207], v[44:47], a[116:119], v[204:207]
    v_mfma_f32_16x16x32_bf16 v[204:207], v[48:51], a[124:127], v[204:207]
    ds_read_b128 v[32:35], v5 offset:30720
    v_mfma_f32_16x16x32_bf16 v[200:203], v[48:51], a[120:123], v[200:203]
    v_mfma_f32_16x16x32_bf16 v[200:203], v[44:47], a[112:115], v[200:203]
    ds_read_b128 v[36:39], v5 offset:31744
    v_mfma_f32_16x16x32_bf16 v[200:203], v[40:43], a[104:107], v[200:203]
    s_waitcnt lgkmcnt(3)
    v_mfma_f32_16x16x32_bf16 v[200:203], v[16:19], a[136:139], v[200:203]
    ds_read_b128 v[40:43], v5 offset:32768
    v_mfma_f32_16x16x32_bf16 v[200:203], v[20:23], a[144:147], v[200:203]
    v_mfma_f32_16x16x32_bf16 v[200:203], v[24:27], a[152:155], v[200:203]
    ds_read_b128 v[44:47], v5 offset:33792
    v_mfma_f32_16x16x32_bf16 v[204:207], v[24:27], a[156:159], v[204:207]
    v_mfma_f32_16x16x32_bf16 v[204:207], v[20:23], a[148:151], v[204:207]
    ds_read_b128 v[48:51], v5 offset:34816
    v_mfma_f32_16x16x32_bf16 v[204:207], v[16:19], a[140:143], v[204:207]
    s_waitcnt lgkmcnt(3)
    v_mfma_f32_16x16x32_bf16 v[204:207], v[28:31], a[172:175], v[204:207]
    ds_read_b128 v[16:19], v5 offset:35840
    v_mfma_f32_16x16x32_bf16 v[204:207], v[32:35], a[180:183], v[204:207]
    v_mfma_f32_16x16x32_bf16 v[204:207], v[36:39], a[188:191], v[204:207]
    ds_read_b128 v[20:23], v5 offset:36864
    v_mfma_f32_16x16x32_bf16 v[200:203], v[36:39], a[184:187], v[200:203]
    v_mfma_f32_16x16x32_bf16 v[200:203], v[32:35], a[176:179], v[200:203]
    ds_read_b128 v[24:27], v5 offset:37888
    v_mfma_f32_16x16x32_bf16 v[200:203], v[28:31], a[168:171], v[200:203]
    s_waitcnt lgkmcnt(3)
    v_mfma_f32_16x16x32_bf16 v[200:203], v[40:43], a[200:203], v[200:203]
    ds_read_b128 v[28:31], v5 offset:38912
    v_mfma_f32_16x16x32_bf16 v[200:203], v[44:47], a[208:211], v[200:203]
    v_mfma_f32_16x16x32_bf16 v[200:203], v[48:51], a[216:219], v[200:203]
    ds_read_b128 v[32:35], v5 offset:39936
    v_mfma_f32_16x16x32_bf16 v[204:207], v[48:51], a[220:223], v[204:207]
    v_mfma_f32_16x16x32_bf16 v[204:207], v[44:47], a[212:215], v[204:207]
    ds_read_b128 v[36:39], v5 offset:40960
    v_mfma_f32_16x16x32_bf16 v[204:207], v[40:43], a[204:207], v[204:207]
    s_waitcnt lgkmcnt(3)
    v_mfma_f32_16x16x32_bf16 v[204:207], v[16:19], a[196:199], v[204:207]
    ds_read_b128 v[40:43], v5 offset:41984
    v_mfma_f32_16x16x32_bf16 v[204:207], v[20:23], a[228:231], v[204:207]
    v_mfma_f32_16x16x32_bf16 v[204:207], v[24:27], v[108:111], v[204:207]
    ds_read_b128 v[44:47], v5 offset:43008
    v_mfma_f32_16x16x32_bf16 v[200:203], v[24:27], v[104:107], v[200:203]
    v_mfma_f32_16x16x32_bf16 v[200:203], v[20:23], a[224:227], v[200:203]
    ds_read_b128 v[48:51], v5 offset:44032
    v_mfma_f32_16x16x32_bf16 v[200:203], v[16:19], a[192:195], v[200:203]
    s_waitcnt lgkmcnt(3)
    v_mfma_f32_16x16x32_bf16 v[200:203], v[28:31], a[232:235], v[200:203]
    v_mfma_f32_16x16x32_bf16 v[200:203], v[32:35], a[240:243], v[200:203]
    v_mfma_f32_16x16x32_bf16 v[200:203], v[36:39], a[248:251], v[200:203]
    v_mfma_f32_16x16x32_bf16 v[204:207], v[36:39], a[252:255], v[204:207]
    v_mfma_f32_16x16x32_bf16 v[204:207], v[32:35], a[244:247], v[204:207]
    v_mfma_f32_16x16x32_bf16 v[204:207], v[28:31], a[236:239], v[204:207]
    s_waitcnt lgkmcnt(0)
    v_mfma_f32_16x16x32_bf16 v[204:207], v[40:43], v[116:119], v[204:207]
    s_waitcnt vmcnt(0)
    v_mfma_f32_16x16x32_bf16 v[204:207], v[44:47], v[124:127], v[204:207]
    s_cmp_lg_u32 s21, s23
    s_cbranch_scc1 nosingle_54
    s_waitcnt vmcnt(2)
    v_mfma_f32_16x16x32_bf16 v[136:139], v[98:101], v[144:147], v[136:139]
    v_mfma_f32_16x16x32_bf16 v[140:143], v[96:99], v[144:147], v[140:143]
    v_mfma_f32_16x16x32_bf16 v[136:139], v[98:101], v[148:151], v[136:139]
    v_mfma_f32_16x16x32_bf16 v[140:143], v[96:99], v[148:151], v[140:143]
    v_mfma_f32_16x16x32_bf16 v[136:139], v[98:101], v[152:155], v[136:139]
    v_mfma_f32_16x16x32_bf16 v[140:143], v[96:99], v[152:155], v[140:143]
    s_nop 3
    s_mov_b32 s42, s41
    s_mov_b32 s41, s44
    s_cmp_eq_u32 s43, 2
    s_cbranch_scc1 rev_56
    v_cvt_pk_bf16_f32 v216, v136, v137
    v_cvt_pk_bf16_f32 v217, v138, v139
    v_cvt_pk_bf16_f32 v218, v140, v141
    v_cvt_pk_bf16_f32 v219, v142, v143
    s_cmp_eq_u32 s43, 1
    s_cbranch_scc1 lay1_55
    buffer_store_dwordx4 v[216:219], v4, s[12:15], s41 offen sc1
    v_add_f32 v252, v252, v136
    v_fmac_f32 v253, v136, v136
    v_add_f32 v254, v254, v140
    v_fmac_f32 v255, v140, v140
    v_add_f32 v252, v252, v137
    v_fmac_f32 v253, v137, v137
    v_add_f32 v254, v254, v141
    v_fmac_f32 v255, v141, v141
    v_add_f32 v252, v252, v138
    v_fmac_f32 v253, v138, v138
    v_add_f32 v254, v254, v142
    v_fmac_f32 v255, v142, v142
    v_add_f32 v252, v252, v139
    v_fmac_f32 v253, v139, v139
    v_add_f32 v254, v254, v143
    v_fmac_f32 v255, v143, v143
    s_branch sdone_57
rev_56:
    v_cvt_pk_bf16_f32 v216, v136, v139
    v_cvt_pk_bf16_f32 v217, v138, v137
    v_cvt_pk_bf16_f32 v218, v140, v143
    v_cvt_pk_bf16_f32 v219, v142, v141
lay1_55:
    ds_write_b128 v91, v[216:219]
    ds_read_b128 v[216:219], v1
    v_lshl_add_u32 v86, v247, 4, v84
    v_lshl_add_u32 v87, v247, 4, v85
    s_waitcnt lgkmcnt(0)
    buffer_store_dwordx2 v[216:217], v86, s[16:19], s41 offen sc1
    buffer_store_dwordx2 v[218:219], v87, s[16:19], s41 offen sc1
sdone_57:
    s_mov_b32 s41, s42
nosingle_54:
    v_mfma_f32_16x16x32_bf16 v[204:207], v[48:51], v[132:135], v[204:207]
    v_mfma_f32_16x16x32_bf16 v[200:203], v[48:51], v[128:131], v[200:203]
    v_mfma_f32_16x16x32_bf16 v[200:203], v[44:47], v[120:123], v[200:203]
    v_mfma_f32_16x16x32_bf16 v[200:203], v[40:43], v[112:115], v[200:203]
    v_mfma_f32_16x16x32_bf16 v[236:239], v[96:99], v[52:55], v[236:239]
    v_mfma_f32_16x16x32_bf16 v[240:243], v[96:99], v[56:59], v[240:243]
    v_mfma_f32_16x16x32_bf16 v[236:239], v[96:99], v[60:63], v[236:239]
    v_mfma_f32_16x16x32_bf16 v[240:243], v[96:99], v[64:67], v[240:243]
    v_mfma_f32_16x16x32_bf16 v[192:195], v[98:101], v[52:55], v[192:195]
    v_mfma_f32_16x16x32_bf16 v[196:199], v[98:101], v[56:59], v[196:199]
    v_max3_u32 v88, v68, v69, v70
    v_max3_u32 v89, v71, v72, v73
    v_mfma_f32_16x16x32_bf16 v[192:195], v[98:101], v[60:63], v[192:195]
    v_max3_u32 v88, v88, v74, v75
    v_max_u32 v88, v88, v89
    v_mfma_f32_16x16x32_bf16 v[196:199], v[98:101], v[64:67], v[196:199]
    v_cmp_eq_u32 vcc, -1, v88
    s_cbranch_vccnz retry_58
retry_58_ok:
    v_mfma_f32_16x16x32_bf16 v[236:239], v[96:99], v[68:71], v[236:239]
    v_mfma_f32_16x16x32_bf16 v[240:243], v[96:99], v[72:75], v[240:243]
    v_mfma_f32_16x16x32_bf16 v[192:195], v[98:101], v[68:71], v[192:195]
    v_mfma_f32_16x16x32_bf16 v[196:199], v[98:101], v[72:75], v[196:199]
    s_nop 4
    v_fma_f32 v200, v9, v200, v236
    v_fma_f32 v201, v9, v201, v237
    v_fma_f32 v202, v9, v202, v238
    v_fma_f32 v203, v9, v203, v239
    v_fma_f32 v204, v10, v204, v240
    v_fma_f32 v205, v10, v205, v241
    v_fma_f32 v206, v10, v206, v242
    v_fma_f32 v207, v10, v207, v243
    s_cmp_eq_u32 s43, 2
    s_cbranch_scc1 rev_60
    v_cvt_pk_bf16_f32 v208, v192, v193
    v_cvt_pk_bf16_f32 v209, v194, v195
    v_cvt_pk_bf16_f32 v210, v200, v201
    v_cvt_pk_bf16_f32 v211, v202, v203
    v_cvt_pk_bf16_f32 v212, v196, v197
    v_cvt_pk_bf16_f32 v213, v198, v199
    v_cvt_pk_bf16_f32 v214, v204, v205
    v_cvt_pk_bf16_f32 v215, v206, v207
    s_cmp_eq_u32 s43, 1
    s_cbranch_scc1 lay1_59
    buffer_store_dwordx4 v[208:211], v4, s[12:15], s41 offen offset:0 sc1
    buffer_store_dwordx4 v[212:215], v4, s[12:15], s41 offen offset:1024 sc1
    v_add_f32 v252, v252, v192
    v_fmac_f32 v253, v192, v192
    v_add_f32 v254, v254, v196
    v_fmac_f32 v255, v196, v196
    v_add_f32 v252, v252, v193
    v_fmac_f32 v253, v193, v193
    v_add_f32 v254, v254, v197
    v_fmac_f32 v255, v197, v197
    v_add_f32 v252, v252, v194
    v_fmac_f32 v253, v194, v194
    v_add_f32 v254, v254, v198
    v_fmac_f32 v255, v198, v198
    v_add_f32 v252, v252, v195
    v_fmac_f32 v253, v195, v195
    v_add_f32 v254, v254, v199
    v_fmac_f32 v255, v199, v199
    v_add_f32 v252, v252, v200
    v_fmac_f32 v253, v200, v200
    v_add_f32 v254, v254, v204
    v_fmac_f32 v255, v204, v204
    v_add_f32 v252, v252, v201
    v_fmac_f32 v253, v201, v201
    v_add_f32 v254, v254, v205
    v_fmac_f32 v255, v205, v205
    v_add_f32 v252, v252, v202
    v_fmac_f32 v253, v202, v202
    v_add_f32 v254, v254, v206
    v_fmac_f32 v255, v206, v206
    v_add_f32 v252, v252, v203
    v_fmac_f32 v253, v203, v203
    v_add_f32 v254, v254, v207
    v_fmac_f32 v255, v207, v207
    s_nop 0
    v_permlane32_swap_b32 v252, v254
    v_permlane32_swap_b32 v253, v255
    v_add_f32 v252, v252, v254
    v_add_f32 v253, v253, v255
    s_nop 1
    v_permlane16_swap_b32 v252, v253
    v_add_f32 v252, v252, v253
    buffer_store_dword v252, v248, s[12:15], 0 offen sc1
    s_branch sdone_61
lay1_59:
    ds_write_b128 v91, v[208:211] offset:0
    ds_write_b128 v91, v[212:215] offset:1024
    ds_read_b128 v[208:211], v1 offset:0
    ds_read_b128 v[212:215], v1 offset:1024
    s_branch rev_60_st
rev_60:
    v_cvt_pk_bf16_f32 v208, v200, v195
    v_cvt_pk_bf16_f32 v209, v194, v193
    v_cvt_pk_bf16_f32 v210, v202, v201
    v_cvt_pk_bf16_f32 v211, v203, v192
    ds_write_b64 v244, v[208:209] offset:8
    ds_write_b32 v244, v210 offset:4
    ds_write_b16 v244, v211 offset:2
    ds_write_b16_d16_hi v246, v211 offset:0
    v_cvt_pk_bf16_f32 v212, v204, v199
    v_cvt_pk_bf16_f32 v213, v198, v197
    v_cvt_pk_bf16_f32 v214, v206, v205
    v_cvt_pk_bf16_f32 v215, v207, v196
    ds_write_b64 v244, v[212:213] offset:1288
    ds_write_b32 v244, v214 offset:1284
    ds_write_b16 v244, v215 offset:1282
    ds_write_b16_d16_hi v246, v215 offset:1280
    ds_read_b128 v[208:211], v245 offset:0
    ds_read_b128 v[212:215], v245 offset:1280
rev_60_st:
    v_lshl_add_u32 v86, v92, 4, v84
    v_lshl_add_u32 v87, v92, 4, v85
    s_waitcnt lgkmcnt(1)
    buffer_store_dwordx4 v[208:211], v86, s[16:19], s41 offen sc1
    s_waitcnt lgkmcnt(0)
    buffer_store_dwordx4 v[212:215], v87, s[16:19], s41 offen sc1
sdone_61:
    s_cmp_eq_u32 s3, 0
    s_cbranch_scc1 more_62
exit_1:
    s_endpgm
more_62:
    s_mov_b32 s3, 1
    s_mov_b32 s97, 19136512
    s_mov_b32 s98, 16879616
    s_mov_b32 s100, 0
    v_mov_b32 v98, 147456
    v_lshl_add_u32 v98, v3, 3, v98
    ds_read_b64 v[96:97], v98
    s_lshl_b32 s53, s21, 2
    s_add_u32 s53, s53, s22
    s_lshl_b32 s53, s53, 5
    s_lshl_b32 s52, s20, 11
    s_add_u32 s52, s52, 16842752
    s_add_u32 s53, s53, s52
    s_lshl_b32 s54, s21, 9
    s_add_u32 s52, s52, s54
    v_mov_b32 v183, 1
    v_lshlrev_b32 v6, 9, v0
    v_lshlrev_b32 v1, 5, v0
    s_mov_b32 s48, s46
    s_add_u32 s49, s46, 18432
    s_mul_i32 s34, s20, 9
    s_add_u32 s34, s34, s96
    s_mul_hi_u32 s36, s34, 0x1c71c71d
    s_mul_i32 s37, s36, 9
    s_sub_u32 s37, s34, s37
    s_lshr_b32 s38, s36, 2
    s_and_b32 s36, s36, 3
    s_mul_i32 s45, s37, 11
    s_lshr_b32 s45, s45, 5
    s_mul_i32 s47, s45, 3
    s_sub_u32 s47, s37, s47
    s_cmp_ge_u32 s37, 6
    s_cselect_b32 s45, 9, s45
    s_cmp_ge_u32 s37, 7
    s_cselect_b32 s39, 3, 2
    s_add_u32 s39, s39, s37
    s_add_u32 s41, s38, 1
    s_mul_i32 s42, s38, 3981312
    s_add_u32 s42, s42, 663552
    s_mov_b32 s44, 995328
    v_mov_b32 v23, s45
    v_mov_b32 v24, s47
    v_mov_b32 v25, s39
    v_cmp_lt_u32 vcc, 11, v3
    v_lshl_add_u32 v16, v3, 1, 18
    v_lshl_add_u32 v17, v3, 1, 4
    v_cndmask_b32 v16, v16, v17, vcc
    v_subrev_u32 v28, 4, v3
    v_cmp_gt_u32 vcc, 8, v28
    v_and_b32 v17, 1, v3
    v_add_u32 v17, 26, v17
    v_cndmask_b32 v16, v16, v17, vcc
    v_lshrrev_b32 v28, 1, v28
    v_lshlrev_b32 v28, 6, v28
    v_cndmask_b32 v28, 0, v28, vcc
    s_lshl_b32 s43, s23, 8
    s_add_u32 s42, s42, s43
    v_lshrrev_b32 v17, 1, v16
    v_and_b32 v18, 1, v16
    v_mul_u32_u24 v19, 57, v16
    v_lshrrev_b32 v19, 9, v19
    v_mul_u32_u24 v20, 9, v19
    v_add_u32 v20, 1, v20
    v_lshrrev_b32 v20, 1, v20
    v_sub_u32 v20, v17, v20
    v_cmp_lt_u32 vcc, 3, v20
    v_subrev_u32 v20, s41, v20
    v_and_b32 v20, 3, v20
    v_lshl_add_u32 v20, v20, 1, v18
    v_add_u32 v20, 1, v20
    v_cndmask_b32 v20, v20, 0, vcc
    v_sub_u32 v21, s36, v19
    v_and_b32 v21, 3, v21
    v_cmp_eq_u32 vcc, 0, v21
    v_subrev_u32 v21, 1, v21
    s_nop 0
    v_cndmask_b32 v21, v21, v24, vcc
    v_cndmask_b32 v22, v25, v23, vcc
    v_cmp_gt_u32 vcc, 9, v22
    v_mad_u32_u24 v26, v22, 3, v20
    v_mul_u32_u24 v27, 9, v20
    v_cndmask_b32 v26, v26, v27, vcc
    v_cmp_gt_u32 vcc, 4, v20
    v_mul_u32_u24 v27, 12, v20
    s_nop 0
    v_cndmask_b32 v26, v27, v26, vcc
    v_add_u32 v26, v26, v22
    v_mad_u32_u24 v20, v26, 3, v21
    v_lshlrev_b32 v20, 10, v20
    v_mad_u32_u24 v20, v19, s44, v20
    v_add3_u32 v182, s42, v20, v28
    s_lshl_b32 s99, s38, 8
    s_add_u32 s99, s99, 16875520
    s_and_b32 s41, s23, 1
    s_lshl_b32 s41, s41, 3
    s_lshl_b32 s42, s96, 5
    s_add_u32 s41, s41, s42
    v_and_b32 v57, 7, v0
    v_xor_b32 v57, v57, v2
    v_lshlrev_b32 v57, 4, v57
    v_lshrrev_b32 v56, 5, v0
    v_lshlrev_b32 v56, 4, v56
    v_bfe_u32 v58, v0, 3, 2
    v_add3_u32 v56, v56, v58, s41
    v_cmp_eq_u32 vcc, 0, v56
    v_add_u32 v59, 4, v56
    v_mov_b32 v58, 0x120
    v_cndmask_b32 v56, v56, v58, vcc
    s_movk_i32 s41, 1152
    v_mad_u32_u24 v168, v56, s41, v57
    v_xor_b32 v57, 64, v57
    v_mad_u32_u24 v169, v59, s41, v57
    s_lshl_b32 s55, s23, 11
    v_mov_b32 v12, 0x3f803f80
    v_mov_b32 v13, 0x3f803f80
    v_mov_b32 v14, 0x3f803f80
    v_mov_b32 v15, 0x3f803f80
    v_lshrrev_b32 v48, 1, v3
    v_xor_b32 v48, v48, v2
    v_lshlrev_b32 v48, 4, v48
    v_lshl_add_u32 v48, v3, 7, v48
    v_add_u32 v176, 110592, v48
    v_xor_b32 v177, 64, v176
    v_mul_u32_u24 v7, 80, v2
    v_mul_u32_u24 v8, 144, v3
    v_add_u32 v8, 151552, v8
    s_lshl_b32 s41, s23, 5
    v_lshl_add_u32 v9, v2, 3, v8
    v_add_u32 v9, s41, v9
    v_lshl_add_u32 v8, v2, 4, v8
    v_cmp_eq_u32 vcc, 0, v2
    v_mov_b32 v53, 0x3f80
    v_accvgpr_write_b32 a89, 0
    v_accvgpr_write_b32 a90, 0
    v_accvgpr_write_b32 a91, 0
    v_cndmask_b32 v53, 0, v53, vcc
    v_accvgpr_write_b32 a88, v53
    v_and_b32 v10, 1, v3
    v_lshlrev_b32 v53, 15, v10
    v_cndmask_b32 v5, 0, v53, vcc
    v_lshlrev_b32 v10, 30, v10
    s_mov_b32 s47, 0x80008000
    s_waitcnt vmcnt(0) lgkmcnt(0)
    s_barrier
    s_cmp_lg_u32 s23, 0
    s_cbranch_scc1 nosig_63
    s_mov_b64 exec, 15
    buffer_store_dword v183, v6, s[12:15], s53 offen sc1
    s_mov_b64 exec, -1
nosig_63:
    s_cmp_eq_u32 s96, 9
    s_cbranch_scc1 noslice_64
    s_add_u32 m0, s55, 110592
    s_nop 0
    buffer_load_dwordx4 v168, s[8:11], 0 offen offset:0 lds
    s_add_u32 m0, s55, 111616
    s_nop 0
    buffer_load_dwordx4 v169, s[8:11], 0 offen offset:0 lds
    s_add_u32 m0, s55, 118656
    s_nop 0
    buffer_load_dwordx4 v168, s[8:11], 0 offen offset:128 lds
    s_add_u32 m0, s55, 119680
    s_nop 0
    buffer_load_dwordx4 v169, s[8:11], 0 offen offset:128 lds
    s_add_u32 m0, s55, 126720
    s_nop 0
    buffer_load_dwordx4 v168, s[8:11], 0 offen offset:256 lds
    s_add_u32 m0, s55, 127744
    s_nop 0
    buffer_load_dwordx4 v169, s[8:11], 0 offen offset:256 lds
    s_add_u32 m0, s55, 134784
    s_nop 0
    buffer_load_dwordx4 v168, s[8:11], 0 offen offset:384 lds
    s_add_u32 m0, s55, 135808
    s_nop 0
    buffer_load_dwordx4 v169, s[8:11], 0 offen offset:384 lds
    s_add_u32 m0, s55, 142848
    s_nop 0
    buffer_load_dwordx4 v168, s[8:11], 0 offen offset:512 lds
    s_add_u32 m0, s55, 143872
    s_nop 0
    buffer_load_dwordx4 v169, s[8:11], 0 offen offset:512 lds
    s_lshl_b32 s31, s23, 2
    v_lshrrev_b32 v164, 2, v3
    v_add_u32 v164, s31, v164
    v_cmp_eq_u32 s[42:43], 0, v164
    v_and_b32 v165, 2, v3
    v_lshl_add_u32 v164, v165, 4, v164
    v_and_b32 v166, 1, v3
    v_cmp_eq_u32 s[58:59], 1, v166
    v_sub_u32 v167, 64, v164
    v_lshlrev_b32 v165, 3, v165
    v_cndmask_b32 v164, v164, v167, s[58:59]
    v_lshl_add_u32 v165, v166, 5, v165
    v_cndmask_b32 v164, v164, v165, s[42:43]
    v_cmp_eq_u32 s[42:43], s20, 0
    v_lshlrev_b32 v165, 9, v2
    v_add_u32 v165, s20, v165
    v_cndmask_b32 v166, 32, 16, s[42:43]
    v_add_u32 v166, v166, v165
    v_and_b32 v168, 1, v2
    v_lshlrev_b32 v168, 9, v168
    v_lshrrev_b32 v167, 1, v2
    v_lshl_add_u32 v168, v167, 5, v168
    v_cndmask_b32 v165, v165, v168, s[42:43]
    v_cvt_f32_u32 v167, v164
    v_mul_f32 v167, 0x3d000000, v167
    v_mul_u32_u24 v168, v164, v165
    v_and_b32 v168, 0x7ff, v168
    v_cvt_f32_u32 v168, v168
    v_mul_f32 v168, 0x3a000000, v168
    v_cos_f32 v170, v168
    v_sin_f32 v172, v168
    v_add_f32 v168, v168, v167
    v_cos_f32 v171, v168
    v_sin_f32 v173, v168
    v_add_f32 v168, v168, v167
    v_cvt_pk_bf16_f32 v16, v170, v171
    v_cvt_pk_bf16_f32 v24, v172, v173
    v_cvt_pk_bf16_f32 v32, -v172, -v173
    v_mov_b32 v40, v16
    v_cos_f32 v170, v168
    v_sin_f32 v172, v168
    v_add_f32 v168, v168, v167
    v_cos_f32 v171, v168
    v_sin_f32 v173, v168
    v_add_f32 v168, v168, v167
    v_cvt_pk_bf16_f32 v17, v170, v171
    v_cvt_pk_bf16_f32 v25, v172, v173
    v_cvt_pk_bf16_f32 v33, -v172, -v173
    v_mov_b32 v41, v17
    v_cos_f32 v170, v168
    v_sin_f32 v172, v168
    v_add_f32 v168, v168, v167
    v_cos_f32 v171, v168
    v_sin_f32 v173, v168
    v_add_f32 v168, v168, v167
    v_cvt_pk_bf16_f32 v18, v170, v171
hop_10:
    s_cbranch_execz back_10
    v_cvt_pk_bf16_f32 v26, v172, v173
    v_cvt_pk_bf16_f32 v34, -v172, -v173
    v_mov_b32 v42, v18
    v_cos_f32 v170, v168
    v_sin_f32 v172, v168
    v_add_f32 v168, v168, v167
    v_cos_f32 v171, v168
    v_sin_f32 v173, v168
    v_cvt_pk_bf16_f32 v19, v170, v171
    v_cvt_pk_bf16_f32 v27, v172, v173
    v_cvt_pk_bf16_f32 v35, -v172, -v173
    v_mov_b32 v43, v19
    v_mul_u32_u24 v168, v164, v166
    v_and_b32 v168, 0x7ff, v168
noslice_64:
    s_cmp_lg_u32 s23, 0
    s_cbranch_scc1 nopoll_65
    s_mov_b32 s40, 0
    s_mov_b64 exec, 0xffff
spin_66:
    buffer_load_dword v11, v1, s[12:15], s52 offen sc1
    s_add_u32 s40, s40, 1
    s_waitcnt vmcnt(0)
    v_cmp_gt_u32 vcc, 1, v11
    s_cbranch_vccz spin_66_x
    s_cmp_lt_u32 s40, 2097152
    s_cbranch_scc1 spin_66
spin_66_x:
    s_mov_b64 exec, -1
nopoll_65:
    s_waitcnt vmcnt(0)
    s_barrier
    s_cmp_lg_u32 s96, 9
    s_cbranch_scc1 slice_67
    s_add_u32 s48, s48, 4096
    buffer_load_dwordx4 a[16:19], v4, s[12:15], s48 offen offset:0 sc1
    buffer_load_dwordx4 a[20:23], v4, s[12:15], s48 offen offset:1024 sc1
    s_add_u32 s49, s49, 4096
    buffer_load_dwordx4 v[200:203], v4, s[12:15], s49 offen offset:0 sc1
    buffer_load_dwordx4 v[204:207], v4, s[12:15], s49 offen offset:1024 sc1
    buffer_load_dwordx4 a[24:27], v4, s[12:15], s48 offen offset:2048 sc1
    buffer_load_dwordx4 a[28:31], v4, s[12:15], s48 offen offset:3072 sc1
    buffer_load_dwordx4 v[208:211], v4, s[12:15], s49 offen offset:2048 sc1
    buffer_load_dwordx4 v[212:215], v4, s[12:15], s49 offen offset:3072 sc1
    s_add_u32 s48, s48, 4096
    buffer_load_dwordx2 a[32:33], v4, s[12:15], s48 offen offset:0 sc1
    buffer_load_dwordx2 a[34:35], v4, s[12:15], s48 offen offset:1024 sc1
    buffer_load_dwordx2 a[36:37], v4, s[12:15], s48 offen offset:8 sc1
    buffer_load_dwordx2 a[38:39], v4, s[12:15], s48 offen offset:1032 sc1
    s_add_u32 s49, s49, 4096
    buffer_load_dwordx2 v[216:217], v4, s[12:15], s49 offen offset:0 sc1
    buffer_load_dwordx2 v[218:219], v4, s[12:15], s49 offen offset:1024 sc1
    buffer_load_dwordx2 v[220:221], v4, s[12:15], s49 offen offset:8 sc1
    buffer_load_dwordx2 v[222:223], v4, s[12:15], s49 offen offset:1032 sc1
    buffer_load_dwordx4 a[40:43], v4, s[12:15], s48 offen offset:2048 sc1
    buffer_load_dwordx4 a[44:47], v4, s[12:15], s48 offen offset:3072 sc1
    buffer_load_dwordx4 v[224:227], v4, s[12:15], s49 offen offset:2048 sc1
    buffer_load_dwordx4 v[228:231], v4, s[12:15], s49 offen offset:3072 sc1
    s_add_u32 s48, s48, 4096
    buffer_load_dwordx4 a[48:51], v4, s[12:15], s48 offen offset:0 sc1
    buffer_load_dwordx4 a[52:55], v4, s[12:15], s48 offen offset:1024 sc1
    s_add_u32 s49, s49, 4096
    buffer_load_dwordx4 v[232:235], v4, s[12:15], s49 offen offset:0 sc1
    buffer_load_dwordx4 v[236:239], v4, s[12:15], s49 offen offset:1024 sc1
    buffer_load_dwordx4 a[56:59], v4, s[12:15], s48 offen offset:2048 sc1
    buffer_load_dwordx4 a[60:63], v4, s[12:15], s48 offen offset:3072 sc1
    buffer_load_dwordx4 v[240:243], v4, s[12:15], s49 offen offset:2048 sc1
    buffer_load_dwordx4 v[244:247], v4, s[12:15], s49 offen offset:3072 sc1
    s_add_u32 s48, s48, 4096
    buffer_load_dwordx4 a[64:67], v4, s[12:15], s48 offen offset:0 sc1
    buffer_load_dwordx4 a[68:71], v4, s[12:15], s48 offen offset:1024 sc1
    s_add_u32 s49, s49, 4096
    buffer_load_dwordx4 v[248:251], v4, s[12:15], s49 offen offset:0 sc1
    buffer_load_dwordx4 v[252:255], v4, s[12:15], s49 offen offset:1024 sc1
    s_add_u32 s48, s48, -16384
    buffer_load_dwordx4 a[0:3], v4, s[12:15], s48 offen offset:0 sc1
    buffer_load_dwordx4 a[4:7], v4, s[12:15], s48 offen offset:1024 sc1
    s_add_u32 s49, s49, -16384
    buffer_load_dwordx4 v[184:187], v4, s[12:15], s49 offen offset:0 sc1
    buffer_load_dwordx4 v[188:191], v4, s[12:15], s49 offen offset:1024 sc1
    buffer_load_dwordx4 a[8:11], v4, s[12:15], s48 offen offset:2048 sc1
    buffer_load_dwordx4 a[12:15], v4, s[12:15], s48 offen offset:3072 sc1
    buffer_load_dwordx4 v[192:195], v4, s[12:15], s49 offen offset:2048 sc1
    buffer_load_dwordx4 v[196:199], v4, s[12:15], s49 offen offset:3072 sc1
    s_mov_b32 s101, 0
    s_branch wait_4
slice_67:
    buffer_load_dwordx4 a[0:3], v4, s[12:15], s48 offen offset:0 sc1
    buffer_load_dwordx4 a[4:7], v4, s[12:15], s48 offen offset:1024 sc1
    buffer_load_dwordx4 v[184:187], v4, s[12:15], s49 offen offset:0 sc1
    buffer_load_dwordx4 v[188:191], v4, s[12:15], s49 offen offset:1024 sc1
    s_lshl_b32 s31, s20, 2
    s_add_u32 s31, s31, s23
    s_lshl_b32 s31, s31, 12
    s_add_u32 s31, s31, 20971520
    buffer_load_dwordx4 v[144:147], v4, s[12:15], s31 offen offset:0 sc1
    buffer_load_dwordx4 v[148:151], v4, s[12:15], s31 offen offset:1024 sc1
    buffer_load_dwordx4 v[152:155], v4, s[12:15], s31 offen offset:2048 sc1
    buffer_load_dwordx4 v[156:159], v4, s[12:15], s31 offen offset:3072 sc1
    buffer_load_dwordx4 a[8:11], v4, s[12:15], s48 offen offset:2048 sc1
    buffer_load_dwordx4 a[12:15], v4, s[12:15], s48 offen offset:3072 sc1
    buffer_load_dwordx4 v[192:195], v4, s[12:15], s49 offen offset:2048 sc1
    buffer_load_dwordx4 v[196:199], v4, s[12:15], s49 offen offset:3072 sc1
    s_add_u32 s48, s48, 4096
    buffer_load_dwordx4 a[16:19], v4, s[12:15], s48 offen offset:0 sc1
    buffer_load_dwordx4 a[20:23], v4, s[12:15], s48 offen offset:1024 sc1
    s_add_u32 s49, s49, 4096
    buffer_load_dwordx4 v[200:203], v4, s[12:15], s49 offen offset:0 sc1
    buffer_load_dwordx4 v[204:207], v4, s[12:15], s49 offen offset:1024 sc1
    v_cvt_f32_u32 v168, v168
    v_mul_f32 v168, 0x3a000000, v168
    v_cos_f32 v170, v168
    v_sin_f32 v172, v168
    v_add_f32 v168, v168, v167
    v_cos_f32 v171, v168
    v_sin_f32 v173, v168
    v_add_f32 v168, v168, v167
    v_cvt_pk_bf16_f32 v20, v170, v171
    v_cvt_pk_bf16_f32 v28, v172, v173
    v_cvt_pk_bf16_f32 v36, -v172, -v173
    v_mov_b32 v44, v20
    v_cos_f32 v170, v168
    v_sin_f32 v172, v168
    v_add_f32 v168, v168, v167
    v_cos_f32 v171, v168
    v_sin_f32 v173, v168
    v_add_f32 v168, v168, v167
    v_cvt_pk_bf16_f32 v21, v170, v171
    v_cvt_pk_bf16_f32 v29, v172, v173
    v_cvt_pk_bf16_f32 v37, -v172, -v173
    v_mov_b32 v45, v21
    v_cos_f32 v170, v168
    v_sin_f32 v172, v168
    v_add_f32 v168, v168, v167
    v_cos_f32 v171, v168
    v_sin_f32 v173, v168
    v_add_f32 v168, v168, v167
    v_cvt_pk_bf16_f32 v22, v170, v171
    v_cvt_pk_bf16_f32 v30, v172, v173
    v_cvt_pk_bf16_f32 v38, -v172, -v173
    v_mov_b32 v46, v22
    v_cos_f32 v170, v168
    v_sin_f32 v172, v168
    v_add_f32 v168, v168, v167
    v_cos_f32 v171, v168
    v_sin_f32 v173, v168
    v_cvt_pk_bf16_f32 v23, v170, v171
    v_cvt_pk_bf16_f32 v31, v172, v173
    v_cvt_pk_bf16_f32 v39, -v172, -v173
    v_mov_b32 v47, v23
    s_cmp_lg_u32 s20, 0
    s_cbranch_scc1 nsp_68
    v_mov_b32 v36, v20
    v_mov_b32 v44, v28
    v_mov_b32 v20, 0
    v_mov_b32 v28, 0
    v_mov_b32 v32, 0
    v_mov_b32 v40, 0
    v_mov_b32 v37, v21
    v_mov_b32 v45, v29
    v_mov_b32 v21, 0
    v_mov_b32 v29, 0
    v_mov_b32 v33, 0
    v_mov_b32 v41, 0
    v_mov_b32 v38, v22
    v_mov_b32 v46, v30
    v_mov_b32 v22, 0
    v_mov_b32 v30, 0
    v_mov_b32 v34, 0
    v_mov_b32 v42, 0
    v_mov_b32 v39, v23
    v_mov_b32 v47, v31
    v_mov_b32 v23, 0
    v_mov_b32 v31, 0
    v_mov_b32 v35, 0
    v_mov_b32 v43, 0
    v_and_b32 v169, 1, v164
    v_lshlrev_b32 v169, 15, v169
    v_or_b32 v169, 0x3f80, v169
    v_and_b32 v170, 0xffff0000, v24
    v_or_b32 v169, v169, v170
    v_cmp_eq_u32 s[42:43], 0, v2
    s_nop 1
    v_cndmask_b32 v24, v24, v169, s[42:43]
nsp_68:
    ds_read_b128 v[128:131], v176 offset:0
    ds_read_b128 v[132:135], v176 offset:2048
    ds_read_b128 a[72:75], v176 offset:0
    ds_read_b128 a[76:79], v176 offset:2048
    ds_read_b128 v[104:107], v176 offset:4096
    ds_read_b128 v[108:111], v176 offset:6144
    s_waitcnt vmcnt(12)
    v_mfma_f32_16x16x32_bf16 a[92:95], a[0:3], a[88:91], 0
    ds_read_b128 a[80:83], v177 offset:0
    v_mfma_f32_16x16x32_bf16 a[96:99], a[4:7], a[88:91], 0
    s_waitcnt lgkmcnt(1)
    v_xor_b32 v128, v128, v5
    v_xor_b32 v132, v132, v5
    v_mfma_f32_16x16x32_bf16 v[48:51], a[0:3], a[72:75], 0
    ds_read_b128 a[84:87], v177 offset:2048
    buffer_load_dwordx4 a[24:27], v4, s[12:15], s48 offen offset:2048 sc1
    v_mfma_f32_16x16x32_bf16 v[48:51], v[184:187], v[128:131], v[48:51]
    buffer_load_dwordx4 a[28:31], v4, s[12:15], s48 offen offset:3072 sc1
    v_mfma_f32_16x16x32_bf16 v[64:67], a[4:7], a[72:75], 0
    ds_read_b128 v[112:115], v177 offset:4096
    v_xor_b32 v120, s47, v104
    v_mfma_f32_16x16x32_bf16 v[64:67], v[188:191], v[128:131], v[64:67]
    v_xor_b32 v121, s47, v105
    v_xor_b32 v122, s47, v106
    v_mfma_f32_16x16x32_bf16 v[52:55], a[0:3], a[76:79], 0
    ds_read_b128 v[116:119], v177 offset:6144
    v_xor_b32 v123, s47, v107
    v_mfma_f32_16x16x32_bf16 v[52:55], v[184:187], v[132:135], v[52:55]
    buffer_load_dwordx4 v[208:211], v4, s[12:15], s49 offen offset:2048 sc1
    v_mfma_f32_16x16x32_bf16 v[68:71], a[4:7], a[76:79], 0
    v_xor_b32 v124, s47, v108
    v_xor_b32 v125, s47, v109
    v_mfma_f32_16x16x32_bf16 v[68:71], v[188:191], v[132:135], v[68:71]
    v_xor_b32 v126, s47, v110
    v_xor_b32 v127, s47, v111
    v_mfma_f32_16x16x32_bf16 v[56:59], a[0:3], v[104:107], 0
    buffer_load_dwordx4 v[212:215], v4, s[12:15], s49 offen offset:3072 sc1
    v_mfma_f32_16x16x32_bf16 v[72:75], a[4:7], v[104:107], 0
    s_add_u32 s48, s48, 4096
    v_mfma_f32_16x16x32_bf16 v[60:63], a[0:3], v[108:111], 0
    v_mfma_f32_16x16x32_bf16 v[76:79], a[4:7], v[108:111], 0
    v_mfma_f32_16x16x32_bf16 v[56:59], v[184:187], v[120:123], v[56:59]
    buffer_load_dwordx2 a[32:33], v4, s[12:15], s48 offen offset:0 sc1
    v_mfma_f32_16x16x32_bf16 v[72:75], v[188:191], v[120:123], v[72:75]
    v_mfma_f32_16x16x32_bf16 v[60:63], v[184:187], v[124:127], v[60:63]
    v_mfma_f32_16x16x32_bf16 v[76:79], v[188:191], v[124:127], v[76:79]
    s_waitcnt vmcnt(9)
    s_waitcnt lgkmcnt(0)
    v_mfma_f32_16x16x32_bf16 v[48:51], a[8:11], a[80:83], v[48:51]
    ds_read_b128 a[72:75], v176 offset:8192
    v_xor_b32 v120, s47, v112
    v_mfma_f32_16x16x32_bf16 v[48:51], v[192:195], a[80:83], v[48:51]
    buffer_load_dwordx2 a[34:35], v4, s[12:15], s48 offen offset:1024 sc1
    v_mfma_f32_16x16x32_bf16 v[64:67], a[12:15], a[80:83], v[64:67]
    ds_read_b128 a[76:79], v176 offset:10240
    v_xor_b32 v121, s47, v113
    v_mfma_f32_16x16x32_bf16 v[64:67], v[196:199], a[80:83], v[64:67]
    buffer_load_dwordx2 a[36:37], v4, s[12:15], s48 offen offset:8 sc1
    v_mfma_f32_16x16x32_bf16 v[52:55], a[8:11], a[84:87], v[52:55]
    ds_read_b128 v[104:107], v176 offset:12288
    v_xor_b32 v122, s47, v114
    v_mfma_f32_16x16x32_bf16 v[52:55], v[192:195], a[84:87], v[52:55]
    s_lshl_b32 s44, s23, 8
    v_xor_b32 v123, s47, v115
    v_xor_b32 v124, s47, v116
    v_mfma_f32_16x16x32_bf16 v[68:71], a[12:15], a[84:87], v[68:71]
    ds_read_b128 v[108:111], v176 offset:14336
    v_xor_b32 v125, s47, v117
    v_mfma_f32_16x16x32_bf16 v[68:71], v[196:199], a[84:87], v[68:71]
    buffer_load_dwordx2 a[38:39], v4, s[12:15], s48 offen offset:1032 sc1
    v_mfma_f32_16x16x32_bf16 v[56:59], a[8:11], v[112:115], v[56:59]
    s_add_u32 s44, s44, 161024
    v_xor_b32 v126, s47, v118
    v_xor_b32 v127, s47, v119
    v_mfma_f32_16x16x32_bf16 v[72:75], a[12:15], v[112:115], v[72:75]
    s_add_u32 s49, s49, 4096
    v_lshlrev_b32 v160, 2, v2
    v_lshl_add_u32 v160, v3, 4, v160
    v_mfma_f32_16x16x32_bf16 v[60:63], a[8:11], v[116:119], v[60:63]
    buffer_load_dwordx2 v[216:217], v4, s[12:15], s49 offen offset:0 sc1
    v_mfma_f32_16x16x32_bf16 v[76:79], a[12:15], v[116:119], v[76:79]
    v_add_u32 v160, s44, v160
    v_lshl_add_u32 v161, v2, 4, s44
    v_mfma_f32_16x16x32_bf16 v[56:59], v[192:195], v[120:123], v[56:59]
    v_add_f32 v144, v144, v152
    v_add_f32 v145, v145, v153
    v_mfma_f32_16x16x32_bf16 v[72:75], v[196:199], v[120:123], v[72:75]
    buffer_load_dwordx2 v[218:219], v4, s[12:15], s49 offen offset:1024 sc1
    v_mfma_f32_16x16x32_bf16 v[60:63], v[192:195], v[124:127], v[60:63]
    v_add_f32 v146, v146, v154
    v_add_f32 v147, v147, v155
    v_mfma_f32_16x16x32_bf16 v[76:79], v[196:199], v[124:127], v[76:79]
    s_waitcnt vmcnt(10)
    s_waitcnt lgkmcnt(0)
    v_add_f32 v148, v148, v156
    v_mfma_f32_16x16x32_bf16 v[48:51], a[16:19], a[72:75], v[48:51]
    ds_read_b128 a[80:83], v177 offset:8192
    v_xor_b32 v120, s47, v104
    v_mfma_f32_16x16x32_bf16 v[48:51], v[200:203], a[72:75], v[48:51]
    buffer_load_dwordx2 v[220:221], v4, s[12:15], s49 offen offset:8 sc1
    v_mfma_f32_16x16x32_bf16 v[64:67], a[20:23], a[72:75], v[64:67]
    ds_read_b128 a[84:87], v177 offset:10240
    v_xor_b32 v121, s47, v105
    v_mfma_f32_16x16x32_bf16 v[64:67], v[204:207], a[72:75], v[64:67]
    v_add_f32 v149, v149, v157
    v_xor_b32 v122, s47, v106
    v_mfma_f32_16x16x32_bf16 v[52:55], a[16:19], a[76:79], v[52:55]
    ds_read_b128 v[112:115], v177 offset:12288
    v_add_f32 v150, v150, v158
    v_mfma_f32_16x16x32_bf16 v[52:55], v[200:203], a[76:79], v[52:55]
    v_xor_b32 v123, s47, v107
    v_add_f32 v151, v151, v159
    v_mfma_f32_16x16x32_bf16 v[68:71], a[20:23], a[76:79], v[68:71]
    ds_read_b128 v[116:119], v177 offset:14336
    v_xor_b32 v124, s47, v108
    buffer_load_dwordx2 v[222:223], v4, s[12:15], s49 offen offset:1032 sc1
    v_mfma_f32_16x16x32_bf16 v[68:71], v[204:207], a[76:79], v[68:71]
    v_add_f32 v144, v144, v148
    v_xor_b32 v125, s47, v109
    v_mfma_f32_16x16x32_bf16 v[56:59], a[16:19], v[104:107], v[56:59]
    v_add_f32 v145, v145, v149
    v_xor_b32 v126, s47, v110
    v_mfma_f32_16x16x32_bf16 v[72:75], a[20:23], v[104:107], v[72:75]
    v_add_f32 v146, v146, v150
    v_xor_b32 v127, s47, v111
    v_mfma_f32_16x16x32_bf16 v[60:63], a[16:19], v[108:111], v[60:63]
    buffer_load_dwordx4 a[40:43], v4, s[12:15], s48 offen offset:2048 sc1
    v_add_f32 v147, v147, v151
    v_mfma_f32_16x16x32_bf16 v[76:79], a[20:23], v[108:111], v[76:79]
    v_permlane32_swap_b32 v144, v146
    v_permlane32_swap_b32 v145, v147
    v_mfma_f32_16x16x32_bf16 v[56:59], v[200:203], v[120:123], v[56:59]
    buffer_load_dwordx4 a[44:47], v4, s[12:15], s48 offen offset:3072 sc1
    v_mfma_f32_16x16x32_bf16 v[72:75], v[204:207], v[120:123], v[72:75]
    v_add_f32 v144, v144, v146
    v_add_f32 v145, v145, v147
    v_mfma_f32_16x16x32_bf16 v[60:63], v[200:203], v[124:127], v[60:63]
    s_nop 0
    v_permlane16_swap_b32 v144, v145
    v_add_f32 v144, v144, v145
    v_mfma_f32_16x16x32_bf16 v[76:79], v[204:207], v[124:127], v[76:79]
    s_waitcnt vmcnt(10)
    s_waitcnt lgkmcnt(0)
    v_mfma_f32_16x16x32_bf16 v[48:51], a[24:27], a[80:83], v[48:51]
    ds_read_b128 a[72:75], v176 offset:16384
    v_xor_b32 v120, s47, v112
    v_mfma_f32_16x16x32_bf16 v[48:51], v[208:211], a[80:83], v[48:51]
    ds_write_b32 v160, v144
    buffer_load_dwordx4 v[224:227], v4, s[12:15], s49 offen offset:2048 sc1
    v_mfma_f32_16x16x32_bf16 v[64:67], a[28:31], a[80:83], v[64:67]
    ds_read_b128 a[76:79], v176 offset:18432
    v_xor_b32 v121, s47, v113
    v_mfma_f32_16x16x32_bf16 v[64:67], v[212:215], a[80:83], v[64:67]
    ds_read_b128 v[80:83], v161 offset:0
    v_xor_b32 v122, s47, v114
    v_mfma_f32_16x16x32_bf16 v[52:55], a[24:27], a[84:87], v[52:55]
    ds_read_b128 v[104:107], v176 offset:20480
    buffer_load_dwordx4 v[228:231], v4, s[12:15], s49 offen offset:3072 sc1
    v_mfma_f32_16x16x32_bf16 v[52:55], v[208:211], a[84:87], v[52:55]
    ds_read_b128 v[128:131], v161 offset:64
    v_xor_b32 v123, s47, v115
    v_mfma_f32_16x16x32_bf16 v[68:71], a[28:31], a[84:87], v[68:71]
    ds_read_b128 v[108:111], v176 offset:22528
    ds_read_b128 v[84:87], v161 offset:128
    ds_read_b128 v[132:135], v161 offset:192
    v_xor_b32 v124, s47, v116
    v_mfma_f32_16x16x32_bf16 v[68:71], v[212:215], a[84:87], v[68:71]
    s_add_u32 s48, s48, 4096
    v_xor_b32 v125, s47, v117
    v_xor_b32 v126, s47, v118
    v_mfma_f32_16x16x32_bf16 v[56:59], a[24:27], v[112:115], v[56:59]
    buffer_load_dwordx4 a[48:51], v4, s[12:15], s48 offen offset:0 sc1
    v_mfma_f32_16x16x32_bf16 v[72:75], a[28:31], v[112:115], v[72:75]
    v_xor_b32 v127, s47, v119
    v_mfma_f32_16x16x32_bf16 v[60:63], a[24:27], v[116:119], v[60:63]
    buffer_load_dwordx4 a[52:55], v4, s[12:15], s48 offen offset:1024 sc1
    v_mfma_f32_16x16x32_bf16 v[76:79], a[28:31], v[116:119], v[76:79]
    s_add_u32 s49, s49, 4096
    v_mfma_f32_16x16x32_bf16 v[56:59], v[208:211], v[120:123], v[56:59]
    s_waitcnt lgkmcnt(0)
    s_mov_b32 s44, 0x3ae38e39
    v_mov_b32 v11, 0x3727c5ac
    v_mfma_f32_16x16x32_bf16 v[72:75], v[212:215], v[120:123], v[72:75]
    buffer_load_dwordx4 v[232:235], v4, s[12:15], s49 offen offset:0 sc1
    v_mfma_f32_16x16x32_bf16 v[60:63], v[208:211], v[124:127], v[60:63]
    v_mul_f32 v80, s44, v80
    v_mul_f32 v81, s44, v81
    v_mfma_f32_16x16x32_bf16 v[76:79], v[212:215], v[124:127], v[76:79]
    s_waitcnt vmcnt(7)
    v_mul_f32 v82, s44, v82
    v_mul_f32 v83, s44, v83
    v_mfma_f32_16x16x32_bf16 v[48:51], a[32:35], a[72:75], v[48:51]
    ds_read_b128 a[80:83], v177 offset:16384
    v_xor_b32 v120, s47, v104
    v_mfma_f32_16x16x32_bf16 v[48:51], v[216:219], a[72:75], v[48:51]
    buffer_load_dwordx4 v[236:239], v4, s[12:15], s49 offen offset:1024 sc1
    v_mfma_f32_16x16x32_bf16 v[64:67], a[36:39], a[72:75], v[64:67]
    ds_read_b128 a[84:87], v177 offset:18432
    v_xor_b32 v121, s47, v105
    v_mfma_f32_16x16x32_bf16 v[64:67], v[220:223], a[72:75], v[64:67]
    v_xor_b32 v122, s47, v106
    v_xor_b32 v123, s47, v107
    v_mfma_f32_16x16x32_bf16 v[52:55], a[32:35], a[76:79], v[52:55]
    ds_read_b128 v[112:115], v177 offset:20480
    v_xor_b32 v124, s47, v108
    v_mfma_f32_16x16x32_bf16 v[52:55], v[216:219], a[76:79], v[52:55]
    buffer_load_dwordx4 a[56:59], v4, s[12:15], s48 offen offset:2048 sc1
    v_mfma_f32_16x16x32_bf16 v[68:71], a[36:39], a[76:79], v[68:71]
    ds_read_b128 v[116:119], v177 offset:22528
    v_xor_b32 v125, s47, v109
    v_mfma_f32_16x16x32_bf16 v[68:71], v[220:223], a[76:79], v[68:71]
    buffer_load_dwordx4 a[60:63], v4, s[12:15], s48 offen offset:3072 sc1
    v_mfma_f32_16x16x32_bf16 v[56:59], a[32:35], v[104:107], v[56:59]
    v_xor_b32 v126, s47, v110
    v_xor_b32 v127, s47, v111
    v_mfma_f32_16x16x32_bf16 v[72:75], a[36:39], v[104:107], v[72:75]
    v_mul_f32 v84, s44, v84
    v_mul_f32 v85, s44, v85
    v_mfma_f32_16x16x32_bf16 v[60:63], a[32:35], v[108:111], v[60:63]
    v_mul_f32 v86, s44, v86
    v_mul_f32 v87, s44, v87
    v_mfma_f32_16x16x32_bf16 v[76:79], a[36:39], v[108:111], v[76:79]
    buffer_load_dwordx4 v[240:243], v4, s[12:15], s49 offen offset:2048 sc1
    v_mfma_f32_16x16x32_bf16 v[56:59], v[216:219], v[120:123], v[56:59]
    v_fma_f32 v136, -v80, v80, v11
    v_fma_f32 v137, -v81, v81, v11
    v_mfma_f32_16x16x32_bf16 v[72:75], v[220:223], v[120:123], v[72:75]
    v_fma_f32 v138, -v82, v82, v11
    v_fma_f32 v139, -v83, v83, v11
    v_mfma_f32_16x16x32_bf16 v[60:63], v[216:219], v[124:127], v[60:63]
    buffer_load_dwordx4 v[244:247], v4, s[12:15], s49 offen offset:3072 sc1
    v_mfma_f32_16x16x32_bf16 v[76:79], v[220:223], v[124:127], v[76:79]
    s_waitcnt vmcnt(8)
    s_waitcnt lgkmcnt(0)
    s_add_u32 s48, s48, 4096
    v_mfma_f32_16x16x32_bf16 v[48:51], a[40:43], a[80:83], v[48:51]
    ds_read_b128 a[72:75], v176 offset:24576
    v_xor_b32 v120, s47, v112
    v_mfma_f32_16x16x32_bf16 v[48:51], v[224:227], a[80:83], v[48:51]
    v_xor_b32 v121, s47, v113
    v_xor_b32 v122, s47, v114
    v_mfma_f32_16x16x32_bf16 v[64:67], a[44:47], a[80:83], v[64:67]
    ds_read_b128 a[76:79], v176 offset:26624
    v_xor_b32 v123, s47, v115
    v_mfma_f32_16x16x32_bf16 v[64:67], v[228:231], a[80:83], v[64:67]
    buffer_load_dwordx4 a[64:67], v4, s[12:15], s48 offen offset:0 sc1
    v_mfma_f32_16x16x32_bf16 v[52:55], a[40:43], a[84:87], v[52:55]
    ds_read_b128 v[104:107], v176 offset:28672
    v_fma_f32 v140, -v84, v84, v11
    v_mfma_f32_16x16x32_bf16 v[52:55], v[224:227], a[84:87], v[52:55]
    buffer_load_dwordx4 a[68:71], v4, s[12:15], s48 offen offset:1024 sc1
    v_mfma_f32_16x16x32_bf16 v[68:71], a[44:47], a[84:87], v[68:71]
    ds_read_b128 v[108:111], v176 offset:30720
    v_xor_b32 v124, s47, v116
    v_mfma_f32_16x16x32_bf16 v[68:71], v[228:231], a[84:87], v[68:71]
    s_add_u32 s49, s49, 4096
    v_fma_f32 v141, -v85, v85, v11
    v_xor_b32 v125, s47, v117
    v_mfma_f32_16x16x32_bf16 v[56:59], a[40:43], v[112:115], v[56:59]
    v_fma_f32 v142, -v86, v86, v11
    v_xor_b32 v126, s47, v118
    v_mfma_f32_16x16x32_bf16 v[72:75], a[44:47], v[112:115], v[72:75]
    v_xor_b32 v127, s47, v119
    v_fma_f32 v143, -v87, v87, v11
    v_mfma_f32_16x16x32_bf16 v[60:63], a[40:43], v[116:119], v[60:63]
    buffer_load_dwordx4 v[248:251], v4, s[12:15], s49 offen offset:0 sc1
    v_mfma_f32_16x16x32_bf16 v[76:79], a[44:47], v[116:119], v[76:79]
    v_fma_f32 v128, v128, s44, v136
    v_max_f32 v128, v128, v11
    v_mfma_f32_16x16x32_bf16 v[56:59], v[224:227], v[120:123], v[56:59]
    buffer_load_dwordx4 v[252:255], v4, s[12:15], s49 offen offset:1024 sc1
    v_mfma_f32_16x16x32_bf16 v[72:75], v[228:231], v[120:123], v[72:75]
    v_rsq_f32 v128, v128
    v_mfma_f32_16x16x32_bf16 v[60:63], v[224:227], v[124:127], v[60:63]
    v_fma_f32 v129, v129, s44, v137
    v_max_f32 v129, v129, v11
    v_mfma_f32_16x16x32_bf16 v[76:79], v[228:231], v[124:127], v[76:79]
    s_waitcnt vmcnt(8)
    s_waitcnt lgkmcnt(0)
    v_fma_f32 v130, v130, s44, v138
    v_mfma_f32_16x16x32_bf16 v[48:51], a[48:51], a[72:75], v[48:51]
    ds_read_b128 a[80:83], v177 offset:24576
    v_xor_b32 v120, s47, v104
    v_mfma_f32_16x16x32_bf16 v[48:51], v[232:235], a[72:75], v[48:51]
    v_rsq_f32 v129, v129
    v_mfma_f32_16x16x32_bf16 v[64:67], a[52:55], a[72:75], v[64:67]
    ds_read_b128 a[84:87], v177 offset:26624
    s_mov_b64 exec, 0xffff
    buffer_load_dwordx4 v[178:181], v182, s[12:15], 0 offen sc1
    s_mov_b64 exec, -1
    v_mfma_f32_16x16x32_bf16 v[64:67], v[236:239], a[72:75], v[64:67]
    v_xor_b32 v121, s47, v105
    v_xor_b32 v122, s47, v106
    v_mfma_f32_16x16x32_bf16 v[52:55], a[48:51], a[76:79], v[52:55]
    ds_read_b128 v[112:115], v177 offset:28672
    v_max_f32 v130, v130, v11
    v_mfma_f32_16x16x32_bf16 v[52:55], v[232:235], a[76:79], v[52:55]
    v_xor_b32 v123, s47, v107
    v_xor_b32 v124, s47, v108
    v_mfma_f32_16x16x32_bf16 v[68:71], a[52:55], a[76:79], v[68:71]
    ds_read_b128 v[116:119], v177 offset:30720
    v_rsq_f32 v130, v130
    v_mfma_f32_16x16x32_bf16 v[68:71], v[236:239], a[76:79], v[68:71]
    v_xor_b32 v125, s47, v109
    v_fma_f32 v131, v131, s44, v139
    v_mfma_f32_16x16x32_bf16 v[56:59], a[48:51], v[104:107], v[56:59]
    v_xor_b32 v126, s47, v110
    v_max_f32 v131, v131, v11
    v_mfma_f32_16x16x32_bf16 v[72:75], a[52:55], v[104:107], v[72:75]
    v_xor_b32 v127, s47, v111
    v_fma_f32 v132, v132, s44, v140
    v_mfma_f32_16x16x32_bf16 v[60:63], a[48:51], v[108:111], v[60:63]
    v_rsq_f32 v131, v131
    v_mfma_f32_16x16x32_bf16 v[76:79], a[52:55], v[108:111], v[76:79]
    v_max_f32 v132, v132, v11
    v_fma_f32 v133, v133, s44, v141
    v_mfma_f32_16x16x32_bf16 v[56:59], v[232:235], v[120:123], v[56:59]
    v_rsq_f32 v132, v132
    v_mfma_f32_16x16x32_bf16 v[72:75], v[236:239], v[120:123], v[72:75]
    v_max_f32 v133, v133, v11
    v_fma_f32 v134, v134, s44, v142
    v_mfma_f32_16x16x32_bf16 v[60:63], v[232:235], v[124:127], v[60:63]
    v_rsq_f32 v133, v133
    v_mfma_f32_16x16x32_bf16 v[76:79], v[236:239], v[124:127], v[76:79]
    s_waitcnt vmcnt(5)
    s_waitcnt lgkmcnt(0)
    v_max_f32 v134, v134, v11
    v_mfma_f32_16x16x32_bf16 v[48:51], a[56:59], a[80:83], v[48:51]
    ds_read_b128 a[72:75], v176 offset:32768
    v_xor_b32 v120, s47, v112
    v_mfma_f32_16x16x32_bf16 v[48:51], v[240:243], a[80:83], v[48:51]
    v_rsq_f32 v134, v134
    v_mfma_f32_16x16x32_bf16 v[64:67], a[60:63], a[80:83], v[64:67]
    ds_read_b128 a[76:79], v176 offset:34816
    v_xor_b32 v121, s47, v113
    v_mfma_f32_16x16x32_bf16 v[64:67], v[244:247], a[80:83], v[64:67]
    v_xor_b32 v122, s47, v114
    v_xor_b32 v123, s47, v115
    v_mfma_f32_16x16x32_bf16 v[52:55], a[56:59], a[84:87], v[52:55]
    ds_read_b128 v[104:107], v176 offset:36864
    v_xor_b32 v124, s47, v116
    v_mfma_f32_16x16x32_bf16 v[52:55], v[240:243], a[84:87], v[52:55]
    v_xor_b32 v125, s47, v117
    v_xor_b32 v126, s47, v118
    v_mfma_f32_16x16x32_bf16 v[68:71], a[60:63], a[84:87], v[68:71]
    ds_read_b128 v[108:111], v176 offset:38912
    v_xor_b32 v127, s47, v119
    v_mfma_f32_16x16x32_bf16 v[68:71], v[244:247], a[84:87], v[68:71]
    v_fma_f32 v135, v135, s44, v143
    v_max_f32 v135, v135, v11
    v_mfma_f32_16x16x32_bf16 v[56:59], a[56:59], v[112:115], v[56:59]
    v_rsq_f32 v135, v135
    v_mfma_f32_16x16x32_bf16 v[72:75], a[60:63], v[112:115], v[72:75]
    v_mul_f32 v88, v80, v128
    v_mul_f32 v89, v81, v129
    v_mfma_f32_16x16x32_bf16 v[60:63], a[56:59], v[116:119], v[60:63]
    v_mul_f32 v90, v82, v130
    v_mul_f32 v91, v83, v131
    v_mfma_f32_16x16x32_bf16 v[76:79], a[60:63], v[116:119], v[76:79]
    v_mul_f32 v92, v84, v132
    v_mul_f32 v93, v85, v133
    v_mfma_f32_16x16x32_bf16 v[56:59], v[240:243], v[120:123], v[56:59]
    v_mul_f32 v94, v86, v134
    v_mul_f32 v95, v87, v135
    v_mfma_f32_16x16x32_bf16 v[72:75], v[244:247], v[120:123], v[72:75]
    v_add_f32 v136, v88, v92
    v_add_f32 v137, v89, v93
    v_mfma_f32_16x16x32_bf16 v[60:63], v[240:243], v[124:127], v[60:63]
    v_add_f32 v138, v90, v94
    v_add_f32 v139, v91, v95
    v_mfma_f32_16x16x32_bf16 v[76:79], v[244:247], v[124:127], v[76:79]
    s_waitcnt vmcnt(1)
    s_waitcnt lgkmcnt(0)
    v_mfma_f32_16x16x32_bf16 v[48:51], a[64:67], a[72:75], v[48:51]
    v_xor_b32 v120, s47, v104
    v_xor_b32 v121, s47, v105
    v_mfma_f32_16x16x32_bf16 v[48:51], v[248:251], a[72:75], v[48:51]
    v_xor_b32 v122, s47, v106
    v_xor_b32 v123, s47, v107
    v_mfma_f32_16x16x32_bf16 v[64:67], a[68:71], a[72:75], v[64:67]
    v_xor_b32 v124, s47, v108
    v_xor_b32 v125, s47, v109
    v_mfma_f32_16x16x32_bf16 v[64:67], v[252:255], a[72:75], v[64:67]
    v_xor_b32 v126, s47, v110
    v_xor_b32 v127, s47, v111
    v_mfma_f32_16x16x32_bf16 v[52:55], a[64:67], a[76:79], v[52:55]
    v_mfma_f32_16x16x32_bf16 v[52:55], v[248:251], a[76:79], v[52:55]
    v_mfma_f32_16x16x32_bf16 v[68:71], a[68:71], a[76:79], v[68:71]
    v_mfma_f32_16x16x32_bf16 v[68:71], v[252:255], a[76:79], v[68:71]
    v_mfma_f32_16x16x32_bf16 v[56:59], a[64:67], v[104:107], v[56:59]
    v_mfma_f32_16x16x32_bf16 v[72:75], a[68:71], v[104:107], v[72:75]
    v_mfma_f32_16x16x32_bf16 v[60:63], a[64:67], v[108:111], v[60:63]
    v_mul_f32 v144, v128, v48
    v_mul_f32 v145, v129, v49
    v_mfma_f32_16x16x32_bf16 v[76:79], a[68:71], v[108:111], v[76:79]
    v_mul_f32 v146, v130, v50
    v_mul_f32 v147, v131, v51
    v_mfma_f32_16x16x32_bf16 v[56:59], v[248:251], v[120:123], v[56:59]
    v_fma_f32 v144, v132, v64, v144
    v_fma_f32 v145, v133, v65, v145
    v_mfma_f32_16x16x32_bf16 v[72:75], v[252:255], v[120:123], v[72:75]
    v_fma_f32 v146, v134, v66, v146
    v_fma_f32 v147, v135, v67, v147
    v_mfma_f32_16x16x32_bf16 v[60:63], v[248:251], v[124:127], v[60:63]
    v_fma_f32 v144, -v136, v96, v144
    v_fma_f32 v145, -v137, v96, v145
    v_mfma_f32_16x16x32_bf16 v[76:79], v[252:255], v[124:127], v[76:79]
    v_fma_f32 v146, -v138, v96, v146
    v_fma_f32 v147, -v139, v96, v147
    v_mul_f32 v148, v128, v52
    v_mul_f32 v149, v129, v53
    v_mul_f32 v150, v130, v54
    v_mul_f32 v151, v131, v55
    v_fma_f32 v148, v132, v68, v148
    v_fma_f32 v149, v133, v69, v149
    v_fma_f32 v150, v134, v70, v150
    v_fma_f32 v151, v135, v71, v151
    v_fma_f32 v148, -v136, v97, v148
    v_fma_f32 v149, -v137, v97, v149
    v_fma_f32 v150, -v138, v97, v150
    v_fma_f32 v151, -v139, v97, v151
    s_mov_b32 s100, 3
    s_branch tail_5
late_24:
    s_mov_b32 s40, 0
spin_69:
    buffer_load_dword v11, v9, s[12:15], s41 offen sc1
    s_add_u32 s40, s40, 1
    s_waitcnt vmcnt(0)
    v_cmp_gt_u32 vcc, 1, v11
    s_cbranch_vccz spin_69_x
    s_cmp_lt_u32 s40, 2097152
    s_cbranch_scc1 spin_69
spin_69_x:
    s_branch late_24_ok
late_25:
    s_mov_b32 s40, 0
spin_70:
    s_sleep 8
    buffer_load_dword v11, v92, s[12:15], s41 offen sc1
    s_add_u32 s40, s40, 1
    s_waitcnt vmcnt(0)
    v_cmp_gt_u32 vcc, 14, v11
    s_cbranch_vccz spin_70_x
    s_cmp_lt_u32 s40, 2097152
    s_cbranch_scc1 spin_70
spin_70_x:
    s_branch late_25_ok
late_26:
    s_mov_b32 s40, 0
spin_71:
    s_sleep 8
    buffer_load_dword v11, off, s[12:15], s41 sc1
    s_add_u32 s40, s40, 1
    s_waitcnt vmcnt(0)
    v_cmp_gt_u32 vcc, s42, v11
    s_cbranch_vccz spin_71_x
    s_cmp_lt_u32 s40, 2097152
    s_cbranch_scc1 spin_71
spin_71_x:
    s_branch late_26_ok
late_27:
    s_mov_b32 s40, 0
spin_72:
    buffer_load_dword v11, v102, s[12:15], s32 offen sc1
    s_add_u32 s40, s40, 1
    s_waitcnt vmcnt(0)
    v_cmp_gt_u32 vcc, 1, v11
    s_cbranch_vccz spin_72_x
    s_cmp_lt_u32 s40, 2097152
    s_cbranch_scc1 spin_72
spin_72_x:
    s_branch late_27_ok
late_28:
    s_mov_b32 s40, 0
spin_73:
    buffer_load_dword v11, v102, s[12:15], s32 offen sc1
    s_add_u32 s40, s40, 1
    s_waitcnt vmcnt(0)
    v_cmp_gt_u32 vcc, 2, v11
    s_cbranch_vccz spin_73_x
    s_cmp_lt_u32 s40, 2097152
    s_cbranch_scc1 spin_73
spin_73_x:
    s_branch late_28_ok
late_29:
    s_mov_b32 s40, 0
spin_74:
    buffer_load_dword v11, v102, s[12:15], s32 offen sc1
    s_add_u32 s40, s40, 1
    s_waitcnt vmcnt(0)
    v_cmp_gt_u32 vcc, 3, v11
    s_cbranch_vccz spin_74_x
    s_cmp_lt_u32 s40, 2097152
    s_cbranch_scc1 spin_74
spin_74_x:
    s_branch late_29_ok
late_30:
    s_mov_b32 s40, 0
spin_75:
    buffer_load_dword v11, v102, s[12:15], s32 offen sc1
    s_add_u32 s40, s40, 1
    s_waitcnt vmcnt(0)
    v_cmp_gt_u32 vcc, 4, v11
    s_cbranch_vccz spin_75_x
    s_cmp_lt_u32 s40, 2097152
    s_cbranch_scc1 spin_75
spin_75_x:
    s_branch late_30_ok
late_31:
    s_mov_b32 s40, 0
spin_76:
    buffer_load_dword v11, v102, s[12:15], s32 offen sc1
    s_add_u32 s40, s40, 1
    s_waitcnt vmcnt(0)
    v_cmp_gt_u32 vcc, 5, v11
    s_cbranch_vccz spin_76_x
    s_cmp_lt_u32 s40, 2097152
    s_cbranch_scc1 spin_76
spin_76_x:
    s_branch late_31_ok
late_32:
    s_mov_b32 s40, 0
spin_77:
    buffer_load_dword v11, v103, s[12:15], s33 offen sc1
    s_add_u32 s40, s40, 1
    s_waitcnt vmcnt(0)
    v_cmp_gt_u32 vcc, 1, v11
    s_cbranch_vccz spin_77_x
    s_cmp_lt_u32 s40, 2097152
    s_cbranch_scc1 spin_77
spin_77_x:
    s_branch late_32_ok
late_33:
    s_mov_b32 s40, 0
spin_78:
    buffer_load_dword v11, v103, s[12:15], s33 offen sc1
    s_add_u32 s40, s40, 1
    s_waitcnt vmcnt(0)
    v_cmp_gt_u32 vcc, 2, v11
    s_cbranch_vccz spin_78_x
    s_cmp_lt_u32 s40, 2097152
    s_cbranch_scc1 spin_78
spin_78_x:
    s_branch late_33_ok
retry_58:
    s_mov_b32 s40, 0
retry_58_lp:
    buffer_load_dwordx4 v[68:71], v4, s[12:15], s45 offen offset:0 sc1
    buffer_load_dwordx4 v[72:75], v4, s[12:15], s45 offen offset:1024 sc1
    buffer_load_dword v11, v103, s[12:15], s33 offen sc1
    s_waitcnt vmcnt(0)
    v_max3_u32 v88, v68, v69, v70
    v_max3_u32 v89, v71, v72, v73
    v_max3_u32 v88, v88, v74, v75
    v_max_u32 v88, v88, v89
    v_cmp_eq_u32 vcc, -1, v88
    s_cbranch_vccz retry_58_ok
    s_cmp_ge_u32 s40, 2097152
    s_cbranch_scc1 retry_58_ok
    v_cmp_gt_u32 vcc, v14, v11
    s_add_u32 s40, s40, 1
    s_cbranch_vccnz retry_58_lp
    s_mov_b32 s40, 2097152
    s_branch retry_58_lp
code_end:
.section .rodata,"a"
.p2align 6
.amdhsa_kernel interleave_layers__spectral_fnet__swiglu_ffn__prompt_kernel
  .amdhsa_next_free_vgpr 512
  .amdhsa_next_free_sgpr 102
  .amdhsa_accum_offset 256
  .amdhsa_group_segment_fixed_size 0
  .amdhsa_kernarg_size 96
  .amdhsa_user_sgpr_count 2
  .amdhsa_user_sgpr_kernarg_segment_ptr 1
  .amdhsa_system_sgpr_workgroup_id_x 1
.end_amdhsa_kernel
.text
```
